```python
import torch

def _softmax(x, axis=-1):
    return torch.softmax(x, dim=axis)
def _gelu(x):
    return torch.nn.functional.gelu(x, approximate="tanh")
def _silu(x):
    return torch.nn.functional.silu(x)
def _sigmoid(x):
    return torch.sigmoid(x)
def _layernorm(x, axis=-1, eps=1e-5):
    m = x.mean(dim=axis, keepdim=True)
    v = x.var(dim=axis, keepdim=True, unbiased=False)
    return (x - m) / torch.sqrt(v + eps)
def _scatter_add(tgt, idx, src, axis=0):
    return tgt.clone().index_add_(axis, idx, src)
def _segment_sum(src, seg, n):
    out = torch.zeros((n,) + src.shape[1:], dtype=src.dtype)
    return out.index_add_(0, seg, src)
def _pad(x, pw):
    flat = tuple(v for pair in reversed(pw) for v in pair)
    return torch.nn.functional.pad(x, flat)

kernel_name = 'interleave_layers__linear_attn_block__swiglu_ffn__prompt'

def setup_inputs():

    _w = (lambda a: (lambda t: t.to(torch.bfloat16) if t.is_floating_point() else t)(torch.as_tensor(a)))
    def _A_setup():
        B, S, D = 1, 2048, 1024
        return {
            "x": _w((lambda *s: torch.randn(*s, dtype=torch.bfloat16) * 0.05)(B, S, D)),
            "wqkv": _w((lambda *s: torch.randn(*s, dtype=torch.bfloat16) * 0.05)(D, 3 * D)),
            "wo": _w((lambda *s: torch.randn(*s, dtype=torch.bfloat16) * 0.05)(D, D)),
        }
    _A_in = _A_setup()

    def _B_setup():
        B, S, D, F = 1, 2048, 1024, 3584
        return {
            "x": _w((lambda *s: torch.randn(*s, dtype=torch.bfloat16) * 0.05)(B, S, D)),
            "w_gate": _w((lambda *s: torch.randn(*s, dtype=torch.bfloat16) * 0.05)(D, F)),
            "w_up": _w((lambda *s: torch.randn(*s, dtype=torch.bfloat16) * 0.05)(D, F)),
            "w_down": _w((lambda *s: torch.randn(*s, dtype=torch.bfloat16) * 0.05)(F, D)),
        }
    _B_in = _B_setup()

    return {
        "A_x": _A_in["x"],
        "A_wqkv": _A_in["wqkv"],
        "A_wo": _A_in["wo"],
        "B_x": _B_in["x"],
        "B_w_gate": _B_in["w_gate"],
        "B_w_up": _B_in["w_up"],
        "B_w_down": _B_in["w_down"],
    }

def reference(A_x, A_wqkv, A_wo, B_x, B_w_gate, B_w_up, B_w_down):
    def _A_ref(x, wqkv, wo):
        B, S, D = x.shape
        H = 32; Dh = D // H
        qkv = (lambda x, *d: x.permute(*d))((x @ wqkv).reshape(B, S, 3, H, Dh), 2, 0, 3, 1, 4)
        q, k, v = qkv[0], qkv[1], qkv[2]
        phi = lambda t: torch.where(t > 0, t + 1, torch.exp(t)) + 1e-6
        pq, pk = phi(q), phi(k)
        kv = torch.einsum("bhsd,bhse->bhde", pk, v)
        z = torch.einsum("bhsd->bhd", pk)
        num = torch.einsum("bhqd,bhde->bhqe", pq, kv)
        den = torch.einsum("bhqd,bhd->bhq", pq, z)[..., None] + 1e-6
        o = num / den
        return (lambda x, *d: x.permute(*d))(o, 0, 2, 1, 3).reshape(B, S, D) @ wo

    def _B_ref(x, w_gate, w_up, w_down):
        g = _silu(x @ w_gate)
        u = x @ w_up
        return (g * u) @ w_down

    x = A_x
    x = x + _A_ref(_layernorm(x, axis=-1), A_wqkv, A_wo)
    x = x + _B_ref(_layernorm(x, axis=-1), B_w_gate, B_w_up, B_w_down)
    x = x + _A_ref(_layernorm(x, axis=-1), A_wqkv, A_wo)
    x = x + _B_ref(_layernorm(x, axis=-1), B_w_gate, B_w_up, B_w_down)
    return x
```

```asm
; @launch grid=(256,1,1) block=(512,1,1) lds=163840
.amdgcn_target "amdgcn-amd-amdhsa--gfx950"
.text

.p2align 8
.globl interleave_layers__linear_attn_block__swiglu_ffn__prompt_kernel
.type interleave_layers__linear_attn_block__swiglu_ffn__prompt_kernel,@function
interleave_layers__linear_attn_block__swiglu_ffn__prompt_kernel:
    s_cmp_ge_u32 s2, 256
    s_cbranch_scc1 interleave_layers__linear_attn_block__swiglu_ffn__prompt_kernel_end
    s_load_dwordx4 s[4:7], s[0:1], 0
    s_load_dwordx2 s[28:29], s[0:1], 72
    s_load_dwordx2 s[30:31], s[0:1], 64
    v_lshrrev_b32 v1, 6, v0
    s_mov_b32 s98, 0
    s_movk_i32 s99, 8
    s_mov_b32 s78, 0
    v_readfirstlane_b32 s3, v1
    v_and_b32 v5, 63, v0
    v_lshlrev_b32 v1, 4, v5
    s_cmp_ge_u32 s3, 4
    s_cbranch_scc1 ps_cs
    s_lshl_b32 s33, s2, 2
    s_add_u32 s33, s33, s3
    s_lshr_b32 s35, s33, 4
    s_and_b32 s34, s33, 15
    v_and_b32 v2, 15, v0
    v_lshlrev_b32 v2, 11, v2
    v_bfe_u32 v3, v0, 5, 1
    v_lshl_add_u32 v2, v3, 4, v2
    v_bfe_u32 v3, v0, 4, 1
    v_lshl_add_u32 v2, v3, 5, v2
    s_lshl_b32 s36, s35, 16
    s_lshl_b32 s37, s34, 7
    s_add_u32 s36, s36, s37
    s_add_u32 s37, s36, 32768
    s_lshl_b32 s38, s33, 12
    s_waitcnt lgkmcnt(0)
    s_mov_b32 s8, s4
    s_mov_b32 s9, s5
    s_mov_b32 s10, 4194304
    s_mov_b32 s11, 0x00020000
    buffer_load_dwordx4 v[16:19], v2, s[8:11], s36 offen offset:0 nt
    buffer_load_dwordx4 v[24:27], v2, s[8:11], s36 offen offset:64 nt
    buffer_load_dwordx4 v[20:23], v2, s[8:11], s37 offen offset:0 nt
    buffer_load_dwordx4 v[28:31], v2, s[8:11], s37 offen offset:64 nt
    s_add_u32 s80, s28, 31457280
    s_addc_u32 s81, s29, 0
    s_mov_b32 s82, 32768
    s_mov_b32 s83, 0x00020000
    s_add_u32 s12, s28, s38
    s_addc_u32 s13, s29, 0
    s_mov_b32 s14, 4096
    s_mov_b32 s15, 0x00020000
    s_mov_b32 s88, s28
    s_mov_b32 s89, s29
    s_mov_b32 s90, 0
    s_mov_b32 s91, 0x00020000
    v_pk_mov_b32 v[130:131], 0, 0
    v_pk_mov_b32 v[132:133], 0, 0
    v_pk_mov_b32 v[134:135], 0, 0
    v_pk_mov_b32 v[140:141], 0, 0
    s_mov_b32 s24, s30
    s_mov_b32 s25, s31
    s_mov_b32 s26, 256
    s_mov_b32 s27, 0x00020000
    s_lshl_b32 s36, s33, 8
    s_add_u32 s16, s28, 32505856
    s_addc_u32 s17, s29, 0
    s_mov_b32 s18, 262144
    s_mov_b32 s19, 0x00020000
    v_lshrrev_b32 v4, 2, v1
    s_and_b32 s38, s2, 0xf0
    s_waitcnt vmcnt(0)
    v_permlane16_swap_b32 v16, v18
    v_permlane16_swap_b32 v17, v19
    v_permlane16_swap_b32 v20, v22
    v_permlane16_swap_b32 v21, v23
    v_permlane16_swap_b32 v24, v26
    v_permlane16_swap_b32 v25, v27
    v_permlane16_swap_b32 v28, v30
    v_permlane16_swap_b32 v29, v31
    s_nop 1
    buffer_store_dwordx4 v[16:19], v1, s[12:15], 0 offen offset:0 sc1
    buffer_store_dwordx4 v[20:23], v1, s[12:15], 0 offen offset:1024 sc1
    buffer_store_dwordx4 v[24:27], v1, s[12:15], 0 offen offset:2048 sc1
    buffer_store_dwordx4 v[28:31], v1, s[12:15], 0 offen offset:3072 sc1
    v_mov_b32 v12, 0x3f803f80
    v_mov_b32 v8, 0
    v_mov_b32 v9, 0
    v_mov_b32 v10, 0
    v_mov_b32 v11, 0
    v_dot2_f32_bf16 v8, v16, v12, v8
    v_dot2_f32_bf16 v9, v16, v16, v9
    v_dot2_f32_bf16 v8, v17, v12, v8
    v_dot2_f32_bf16 v9, v17, v17, v9
    v_dot2_f32_bf16 v8, v18, v12, v8
    v_dot2_f32_bf16 v9, v18, v18, v9
    v_dot2_f32_bf16 v8, v19, v12, v8
    v_dot2_f32_bf16 v9, v19, v19, v9
    v_dot2_f32_bf16 v10, v20, v12, v10
    v_dot2_f32_bf16 v11, v20, v20, v11
    v_dot2_f32_bf16 v10, v21, v12, v10
    v_dot2_f32_bf16 v11, v21, v21, v11
    v_dot2_f32_bf16 v10, v22, v12, v10
    v_dot2_f32_bf16 v11, v22, v22, v11
    v_dot2_f32_bf16 v10, v23, v12, v10
    v_dot2_f32_bf16 v11, v23, v23, v11
    v_dot2_f32_bf16 v8, v24, v12, v8
    v_dot2_f32_bf16 v9, v24, v24, v9
    v_dot2_f32_bf16 v8, v25, v12, v8
    v_dot2_f32_bf16 v9, v25, v25, v9
    v_dot2_f32_bf16 v8, v26, v12, v8
    v_dot2_f32_bf16 v9, v26, v26, v9
    v_dot2_f32_bf16 v8, v27, v12, v8
    v_dot2_f32_bf16 v9, v27, v27, v9
    v_dot2_f32_bf16 v10, v28, v12, v10
    v_dot2_f32_bf16 v11, v28, v28, v11
    v_dot2_f32_bf16 v10, v29, v12, v10
    v_dot2_f32_bf16 v11, v29, v29, v11
    v_dot2_f32_bf16 v10, v30, v12, v10
    v_dot2_f32_bf16 v11, v30, v30, v11
    v_dot2_f32_bf16 v10, v31, v12, v10
    v_dot2_f32_bf16 v11, v31, v31, v11
    s_nop 3
    v_permlane32_swap_b32 v8, v9
    v_permlane32_swap_b32 v10, v11
    s_nop 1
    v_add_f32 v8, v8, v9
    v_add_f32 v10, v10, v11
    s_nop 1
    v_permlane16_swap_b32 v8, v10
    s_nop 1
    v_add_f32 v8, v8, v10
    buffer_store_dword v8, v4, s[16:19], s36 offen sc1
    s_barrier
    s_waitcnt vmcnt(0)
    s_barrier
    s_cmp_lg_u32 s3, 0
    s_cbranch_scc1 ps_x1
    s_mov_b64 exec, 1
    v_mov_b32 v1, 0
    v_mov_b32 v2, 1
    buffer_atomic_add v2, v1, s[24:27], s38 offen sc1
    s_mov_b64 exec, -1
ps_x1:
    s_branch pq
ps_cs:
    s_lshr_b32 s45, s2, 2
    s_and_b32 s46, s2, 3
    v_lshrrev_b32 v2, 3, v5
    v_mul_u32_u24 v2, 6144, v2
    v_and_b32 v3, 7, v5
    v_lshl_add_u32 v2, v3, 4, v2
    s_lshl_b32 s36, s46, 2
    s_add_u32 s36, s36, s3
    s_sub_u32 s36, s36, 4
    s_mul_i32 s36, s36, 393216
    s_lshl_b32 s37, s45, 7
    s_add_u32 s36, s36, s37
    s_cmp_lt_u32 s2, 192
    s_cselect_b32 s22, 6291456, 0
    s_mov_b32 s23, 0x00020000
    s_waitcnt lgkmcnt(0)
    s_mov_b32 s20, s6
    s_mov_b32 s21, s7
    s_add_u32 s80, s28, 31457280
    s_addc_u32 s81, s29, 0
    s_mov_b32 s82, 32768
    s_mov_b32 s83, 0x00020000
    v_mov_b32 v40, 0
    v_mul_u32_u24 v41, 256, v5
    s_lshl_b32 s47, s2, 2
    s_add_u32 s47, s47, s3
    s_add_u32 s47, s47, 252
    s_and_b32 s47, s47, 1023
    s_mul_i32 s47, s47, 16384
    buffer_store_dword v40, v41, s[80:83], s47 offen sc1
    s_load_dwordx2 s[4:5], s[0:1], 8
    s_and_b32 s31, s2, 7
    s_lshr_b32 s32, s2, 3
    s_and_b32 s16, s31, 1
    s_lshl_b32 s16, s16, 3
    s_lshr_b32 s17, s32, 2
    s_add_u32 s16, s16, s17
    s_lshr_b32 s17, s31, 1
    s_lshl_b32 s17, s17, 2
    s_and_b32 s32, s32, 3
    s_add_u32 s17, s17, s32
    v_and_b32 v136, 63, v0
    v_lshrrev_b32 v137, 3, v136
    v_mul_u32_u24 v130, 6144, v137
    v_and_b32 v138, 7, v136
    v_and_b32 v137, 6, v137
    v_xor_b32 v138, v138, v137
    v_lshl_add_u32 v130, v138, 4, v130
    s_and_b32 s32, s3, 3
    s_lshl_b32 s40, s32, 10
    s_mul_i32 s31, s32, 49152
    s_lshl_b32 s32, s17, 7
    s_add_u32 s31, s31, s32
    v_add_u32 v130, s31, v130
    v_add_u32 v131, 198656, v130
    v_add_u32 v132, 4096, v130
    v_add_u32 v133, 200704, v130
    v_mov_b32 v134, v130
    v_add_u32 v135, 196608, v130
    v_add_u32 v130, 2048, v130
    s_add_u32 s35, s16, s17
    s_and_b32 s35, s35, 3
    s_mov_b32 s39, 0
    s_mov_b32 s38, 0
    s_waitcnt lgkmcnt(0)
    s_mov_b32 s8, s4
    s_mov_b32 s9, s5
    s_mov_b32 s10, 6291456
    s_mov_b32 s11, 0x00020000
    s_and_b32 s31, s39, 3
    s_cmp_eq_u32 s31, s35
    s_cselect_b32 s31, 3, -1
    s_add_u32 s41, s39, s31
    s_add_u32 s31, s41, 16
    s_min_u32 s41, s41, s31
    s_sub_u32 s31, s41, 16
    s_min_u32 s41, s41, s31
    s_mul_i32 s41, s41, 393216
    s_add_u32 s31, s40, s38
    s_add_u32 m0, s31, 0
    s_nop 0
    buffer_load_dwordx4 v130, s[8:11], s41 offen lds
    s_add_u32 m0, s31, 4096
    s_nop 0
    buffer_load_dwordx4 v131, s[8:11], s41 offen lds
    s_add_u32 m0, s31, 8192
    s_nop 0
    buffer_load_dwordx4 v132, s[8:11], s41 offen lds
    s_add_u32 m0, s31, 12288
    s_nop 0
    buffer_load_dwordx4 v133, s[8:11], s41 offen lds
    s_add_u32 m0, s31, 16384
    s_nop 0
    buffer_load_dwordx4 v134, s[8:11], s41 offen lds
    s_add_u32 m0, s31, 20480
    s_nop 0
    buffer_load_dwordx4 v135, s[8:11], s41 offen lds
    s_add_u32 s38, s38, 24576
    s_cmp_eq_u32 s38, 98304
    s_cselect_b32 s38, 0, s38
    s_add_u32 s39, s39, 1
    s_barrier
    buffer_load_dwordx4 v[160:163], v2, s[20:23], s36 offen
    s_add_u32 s36, s36, 49152
    buffer_load_dwordx4 v[164:167], v2, s[20:23], s36 offen
    s_add_u32 s36, s36, 49152
    buffer_load_dwordx4 v[168:171], v2, s[20:23], s36 offen
    s_add_u32 s36, s36, 49152
    buffer_load_dwordx4 v[172:175], v2, s[20:23], s36 offen
    s_add_u32 s36, s36, 49152
    buffer_load_dwordx4 v[176:179], v2, s[20:23], s36 offen
    s_add_u32 s36, s36, 49152
    buffer_load_dwordx4 v[180:183], v2, s[20:23], s36 offen
    s_add_u32 s36, s36, 49152
    buffer_load_dwordx4 v[184:187], v2, s[20:23], s36 offen
    s_add_u32 s36, s36, 49152
    buffer_load_dwordx4 v[188:191], v2, s[20:23], s36 offen
    s_add_u32 s36, s36, 49152
    s_barrier
    s_and_b32 s31, s39, 3
    s_cmp_eq_u32 s31, s35
    s_cselect_b32 s31, 3, -1
    s_add_u32 s41, s39, s31
    s_add_u32 s31, s41, 16
    s_min_u32 s41, s41, s31
    s_sub_u32 s31, s41, 16
    s_min_u32 s41, s41, s31
    s_mul_i32 s41, s41, 393216
    s_add_u32 s31, s40, s38
    s_add_u32 m0, s31, 0
    s_nop 0
    buffer_load_dwordx4 v130, s[8:11], s41 offen lds
    s_add_u32 m0, s31, 4096
    s_nop 0
    buffer_load_dwordx4 v131, s[8:11], s41 offen lds
    s_add_u32 m0, s31, 8192
    s_nop 0
    buffer_load_dwordx4 v132, s[8:11], s41 offen lds
    s_add_u32 m0, s31, 12288
    s_nop 0
    buffer_load_dwordx4 v133, s[8:11], s41 offen lds
    s_add_u32 m0, s31, 16384
    s_nop 0
    buffer_load_dwordx4 v134, s[8:11], s41 offen lds
    s_add_u32 m0, s31, 20480
    s_nop 0
    buffer_load_dwordx4 v135, s[8:11], s41 offen lds
    s_add_u32 s38, s38, 24576
    s_cmp_eq_u32 s38, 98304
    s_cselect_b32 s38, 0, s38
    s_add_u32 s39, s39, 1
    s_and_b32 s31, s39, 3
    s_cmp_eq_u32 s31, s35
    s_cselect_b32 s31, 3, -1
    s_add_u32 s41, s39, s31
    s_add_u32 s31, s41, 16
    s_min_u32 s41, s41, s31
    s_sub_u32 s31, s41, 16
    s_min_u32 s41, s41, s31
    s_mul_i32 s41, s41, 393216
    s_add_u32 s31, s40, s38
    s_add_u32 m0, s31, 0
    s_nop 0
    buffer_load_dwordx4 v130, s[8:11], s41 offen lds
    s_add_u32 m0, s31, 4096
    s_nop 0
    buffer_load_dwordx4 v131, s[8:11], s41 offen lds
    s_add_u32 m0, s31, 8192
    s_nop 0
    buffer_load_dwordx4 v132, s[8:11], s41 offen lds
    s_add_u32 m0, s31, 12288
    s_nop 0
    buffer_load_dwordx4 v133, s[8:11], s41 offen lds
    s_add_u32 m0, s31, 16384
    s_nop 0
    buffer_load_dwordx4 v134, s[8:11], s41 offen lds
    s_add_u32 m0, s31, 20480
    s_nop 0
    buffer_load_dwordx4 v135, s[8:11], s41 offen lds
    s_add_u32 s38, s38, 24576
    s_cmp_eq_u32 s38, 98304
    s_cselect_b32 s38, 0, s38
    s_add_u32 s39, s39, 1
    s_mov_b32 s88, s28
    s_mov_b32 s89, s29
    s_mov_b32 s90, 0
    s_mov_b32 s91, 0x00020000
    v_pk_mov_b32 v[140:141], 0, 0
pq:
    s_and_b32 s31, s2, 7
    s_lshr_b32 s32, s2, 3
    s_and_b32 s33, s31, 1
    s_lshl_b32 s33, s33, 3
    s_lshr_b32 s34, s32, 2
    s_add_u32 s33, s33, s34
    s_lshr_b32 s34, s31, 1
    s_lshl_b32 s34, s34, 2
    s_and_b32 s32, s32, 3
    s_add_u32 s34, s34, s32
    s_and_b32 s31, s33, 7
    s_and_b32 s32, s33, 8
    s_lshl_b32 s32, s32, 3
    s_add_u32 s31, s31, s32
    s_lshl_b32 s100, s98, 6
    s_add_u32 s100, s100, s31
    s_add_u32 s100, s31, 56
    s_mul_i32 s101, s98, 16
    s_mul_i32 s100, s100, 256
    s_cmp_ge_u32 s3, 4
    s_cbranch_scc1 pq_idle
    v_and_b32 v9, 63, v0
    v_lshlrev_b32 v9, 4, v9
    v_and_b32 v16, 63, v0
    v_lshrrev_b32 v17, 3, v16
    v_mul_u32_u24 v19, 6144, v17
    v_and_b32 v18, 7, v16
    v_and_b32 v17, 6, v17
    v_xor_b32 v18, v18, v17
    v_lshl_add_u32 v19, v18, 4, v19
    v_and_b32 v17, 3, v16
    v_lshlrev_b32 v1, 3, v17
    v_lshrrev_b32 v17, 2, v16
    v_lshl_add_u32 v1, v17, 7, v1
    v_bfe_u32 v17, v16, 3, 2
    v_lshl_add_u32 v1, v17, 5, v1
    v_xor_b32 v2, 32, v1
    v_xor_b32 v3, 64, v1
    v_xor_b32 v4, 96, v1
    v_add_u32 v5, 49152, v1
    v_add_u32 v6, 49152, v2
    v_add_u32 v7, 49152, v3
    v_add_u32 v8, 49152, v4
    s_add_u32 s36, s33, s34
    s_and_b32 s36, s36, 3
    s_mov_b32 s96, 0
    s_cmp_eq_u32 s36, 0
    s_cselect_b32 s92, 3, -1
    s_cmp_eq_u32 s36, 1
    s_cselect_b32 s93, 3, -1
    s_cmp_eq_u32 s36, 2
    s_cselect_b32 s94, 3, -1
    s_cmp_eq_u32 s36, 3
    s_cselect_b32 s95, 3, -1
    s_add_u32 s84, s96, s92
    s_add_u32 s97, s84, 16
    s_min_u32 s84, s84, s97
    s_sub_u32 s97, s84, 16
    s_min_u32 s84, s84, s97
    s_cmp_ge_u32 s96, 16
    s_cselect_b32 s84, 16, s84
    s_add_u32 s96, s96, 1
    s_add_u32 s85, s96, s93
    s_add_u32 s97, s85, 16
    s_min_u32 s85, s85, s97
    s_sub_u32 s97, s85, 16
    s_min_u32 s85, s85, s97
    s_cmp_ge_u32 s96, 16
    s_cselect_b32 s85, 16, s85
    s_add_u32 s96, s96, 1
    s_lshl_b32 s35, s33, 2
    s_add_u32 s35, s35, s3
    s_lshl_b32 s36, s35, 16
    s_add_u32 s12, s28, s36
    s_addc_u32 s13, s29, 0
    s_mov_b32 s14, 65536
    s_mov_b32 s15, 0x00020000
    s_waitcnt vmcnt(0)
    s_barrier
    ds_read_b64_tr_b16 v[128:129], v1 offset:16384
    ds_read_b64_tr_b16 v[130:131], v1 offset:18432
    ds_read_b64_tr_b16 v[132:133], v2 offset:16384
    ds_read_b64_tr_b16 v[134:135], v2 offset:18432
    ds_read_b64_tr_b16 v[136:137], v3 offset:16384
    ds_read_b64_tr_b16 v[138:139], v3 offset:18432
    ds_read_b64_tr_b16 v[140:141], v4 offset:16384
    ds_read_b64_tr_b16 v[142:143], v4 offset:18432
    v_pk_mov_b32 v[32:33], 0, 0
    v_pk_mov_b32 v[34:35], 0, 0
    v_pk_mov_b32 v[36:37], 0, 0
    v_pk_mov_b32 v[38:39], 0, 0
    v_pk_mov_b32 v[40:41], 0, 0
    v_pk_mov_b32 v[42:43], 0, 0
    v_pk_mov_b32 v[44:45], 0, 0
    v_pk_mov_b32 v[46:47], 0, 0
    v_pk_mov_b32 v[48:49], 0, 0
    v_pk_mov_b32 v[50:51], 0, 0
    v_pk_mov_b32 v[52:53], 0, 0
    v_pk_mov_b32 v[54:55], 0, 0
    v_pk_mov_b32 v[56:57], 0, 0
    v_pk_mov_b32 v[58:59], 0, 0
    v_pk_mov_b32 v[60:61], 0, 0
    v_pk_mov_b32 v[62:63], 0, 0
    v_pk_mov_b32 v[64:65], 0, 0
    v_pk_mov_b32 v[66:67], 0, 0
    v_pk_mov_b32 v[68:69], 0, 0
    v_pk_mov_b32 v[70:71], 0, 0
    v_pk_mov_b32 v[72:73], 0, 0
    v_pk_mov_b32 v[74:75], 0, 0
    v_pk_mov_b32 v[76:77], 0, 0
    v_pk_mov_b32 v[78:79], 0, 0
    v_pk_mov_b32 v[80:81], 0, 0
    v_pk_mov_b32 v[82:83], 0, 0
    v_pk_mov_b32 v[84:85], 0, 0
    v_pk_mov_b32 v[86:87], 0, 0
    v_pk_mov_b32 v[88:89], 0, 0
    v_pk_mov_b32 v[90:91], 0, 0
    v_pk_mov_b32 v[92:93], 0, 0
    v_pk_mov_b32 v[94:95], 0, 0
    v_pk_mov_b32 v[96:97], 0, 0
    v_pk_mov_b32 v[98:99], 0, 0
    v_pk_mov_b32 v[100:101], 0, 0
    v_pk_mov_b32 v[102:103], 0, 0
    v_pk_mov_b32 v[104:105], 0, 0
    v_pk_mov_b32 v[106:107], 0, 0
    v_pk_mov_b32 v[108:109], 0, 0
    v_pk_mov_b32 v[110:111], 0, 0
    v_pk_mov_b32 v[112:113], 0, 0
    v_pk_mov_b32 v[114:115], 0, 0
    v_pk_mov_b32 v[116:117], 0, 0
    v_pk_mov_b32 v[118:119], 0, 0
    v_pk_mov_b32 v[120:121], 0, 0
    v_pk_mov_b32 v[122:123], 0, 0
    v_pk_mov_b32 v[124:125], 0, 0
    v_pk_mov_b32 v[126:127], 0, 0
    s_lshl_b32 s38, s3, 9
    s_add_u32 s38, s38, 157696
    s_sub_u32 s39, 159744, s38
    v_and_b32 v26, 31, v16
    v_lshl_add_u32 v26, v26, 2, s38
    v_and_b32 v28, 15, v16
    v_lshl_add_u32 v28, v28, 2, s38
    v_lshrrev_b32 v27, 5, v16
    v_lshl_add_u32 v27, v27, 6, v28
    v_lshrrev_b32 v29, 4, v16
    v_lshl_add_u32 v29, v29, 4, s38
    v_add_u32 v24, s39, v26
    v_add_u32 v25, s39, v27
    s_and_b32 s47, s2, 7
    s_lshr_b32 s44, s2, 3
    s_lshr_b32 s45, s47, 1
    s_lshl_b32 s45, s45, 2
    s_lshr_b32 s46, s44, 3
    s_add_u32 s45, s45, s46
    s_and_b32 s46, s47, 1
    s_and_b32 s44, s44, 7
    s_lshl_b32 s44, s44, 1
    s_add_u32 s46, s46, s44
    s_lshl_b32 s45, s45, 2
    s_add_u32 s45, s45, s3
    s_lshl_b32 s45, s45, 16
    s_lshl_b32 s46, s46, 12
    s_add_u32 s45, s45, s46
    s_add_u32 s48, s28, s45
    s_addc_u32 s49, s29, 0
    s_mov_b32 s50, 4096
    s_mov_b32 s51, 0x00020000
    s_mov_b32 s47, 0x358637bd
    s_mul_i32 s36, s35, 229376
    s_lshl_b32 s37, s34, 12
    s_add_u32 s36, s36, s37
    s_add_u32 s36, s36, 12582912
    s_add_u32 s20, s28, s36
    s_addc_u32 s21, s29, 0
    s_mov_b32 s22, 4096
    s_mov_b32 s23, 0x00020000
    s_mul_i32 s39, s98, 5242880
    s_lshl_b32 s38, s34, 16
    s_lshl_b32 s40, s3, 10
    s_add_u32 s38, s38, s40
    s_add_u32 s38, s38, 28311552
    s_add_u32 s38, s38, s39
    s_add_u32 s24, s28, s38
    s_addc_u32 s25, s29, 0
    s_mov_b32 s26, 65536
    s_mov_b32 s27, 0x00020000
    s_lshl_b32 s37, s34, 4
    s_add_u32 s37, s37, s33
    s_lshl_b32 s38, s37, 8
    s_add_u32 s38, s38, 30408704
    s_add_u32 s38, s38, s39
    s_add_u32 s16, s28, s38
    s_addc_u32 s17, s29, 0
    s_mov_b32 s18, 256
    s_mov_b32 s19, 0x00020000
    s_lshl_b32 s44, s33, 12
    s_add_u32 s40, s40, 98304
    s_lshl_b32 s36, s3, 13
    s_add_u32 s37, s36, 98304
    s_lshl_b32 s38, s3, 8
    s_add_u32 s38, s38, 155648
    v_add_u32 v10, s40, v9
    v_add_u32 v11, s37, v9
    v_and_b32 v12, 0xf0, v9
    v_lshrrev_b32 v12, 2, v12
    v_add_u32 v12, s38, v12
    v_lshrrev_b32 v13, 2, v9
    v_add_u32 v14, 155648, v13
    v_lshrrev_b32 v15, 8, v9
    v_lshlrev_b32 v15, 4, v15
    v_add_u32 v15, 156672, v15
    v_mov_b32 v216, 0x3f803f80
    v_mov_b32 v217, 0x3f803f80
    v_mov_b32 v218, 0x3f803f80
    v_mov_b32 v219, 0x3f803f80
    s_barrier
    s_mul_i32 s42, s84, 4096
    buffer_load_dwordx4 v[160:163], v9, s[12:15], s42 offen sc1
    buffer_load_dwordx4 v[164:167], v9, s[12:15], s42 offen offset:1024 sc1
    buffer_load_dwordx4 v[168:171], v9, s[12:15], s42 offen offset:2048 sc1
    buffer_load_dwordx4 v[172:175], v9, s[12:15], s42 offen offset:3072 sc1
    s_mul_i32 s42, s85, 4096
    buffer_load_dwordx4 v[176:179], v9, s[12:15], s42 offen sc1
    buffer_load_dwordx4 v[180:183], v9, s[12:15], s42 offen offset:1024 sc1
    buffer_load_dwordx4 v[184:187], v9, s[12:15], s42 offen offset:2048 sc1
    buffer_load_dwordx4 v[188:191], v9, s[12:15], s42 offen offset:3072 sc1
    s_mov_b32 s43, 4
    .p2align 6
pq_loop:
    s_waitcnt vmcnt(7) lgkmcnt(4)
    v_mfma_f32_16x16x32_bf16 v[32:35], v[128:131], v[160:163], v[32:35]
    s_add_u32 s86, s96, s94
    ds_read_b64_tr_b16 v[144:145], v1 offset:0
    s_waitcnt vmcnt(6)
    v_mfma_f32_16x16x32_bf16 v[40:43], v[128:131], v[164:167], v[40:43]
    s_add_u32 s97, s86, 16
    ds_read_b64_tr_b16 v[146:147], v1 offset:2048
    v_mfma_f32_16x16x32_bf16 v[36:39], v[132:135], v[160:163], v[36:39]
    s_min_u32 s86, s86, s97
    ds_read_b64_tr_b16 v[148:149], v2 offset:0
    v_mfma_f32_16x16x32_bf16 v[44:47], v[132:135], v[164:167], v[44:47]
    s_sub_u32 s97, s86, 16
    ds_read_b64_tr_b16 v[150:151], v2 offset:2048
    s_waitcnt lgkmcnt(4)
    v_mfma_f32_16x16x32_bf16 v[48:51], v[136:139], v[160:163], v[48:51]
    s_min_u32 s86, s86, s97
    ds_read_b64_tr_b16 v[152:153], v3 offset:0
    v_mfma_f32_16x16x32_bf16 v[56:59], v[136:139], v[164:167], v[56:59]
    s_cmp_ge_u32 s96, 16
    s_cselect_b32 s86, 16, s86
    ds_read_b64_tr_b16 v[154:155], v3 offset:2048
    v_mfma_f32_16x16x32_bf16 v[52:55], v[140:143], v[160:163], v[52:55]
    s_add_u32 s96, s96, 1
    s_mul_i32 s42, s86, 4096
    ds_read_b64_tr_b16 v[156:157], v4 offset:0
    v_mfma_f32_16x16x32_bf16 v[60:63], v[140:143], v[164:167], v[60:63]
    ds_read_b64_tr_b16 v[158:159], v4 offset:2048
    s_waitcnt lgkmcnt(4)
    v_mfma_f32_16x16x32_bf16 v[64:67], v[160:163], v[144:147], v[64:67]
    ds_read_b64_tr_b16 v[128:129], v1 offset:8192
    v_mfma_f32_16x16x32_bf16 v[68:71], v[164:167], v[144:147], v[68:71]
    ds_read_b64_tr_b16 v[130:131], v1 offset:10240
    v_mfma_f32_16x16x32_bf16 v[72:75], v[160:163], v[148:151], v[72:75]
    ds_read_b64_tr_b16 v[132:133], v2 offset:8192
    v_mfma_f32_16x16x32_bf16 v[76:79], v[164:167], v[148:151], v[76:79]
    ds_read_b64_tr_b16 v[134:135], v2 offset:10240
    s_waitcnt lgkmcnt(4)
    v_mfma_f32_16x16x32_bf16 v[80:83], v[160:163], v[152:155], v[80:83]
    ds_read_b64_tr_b16 v[136:137], v3 offset:8192
    v_mfma_f32_16x16x32_bf16 v[84:87], v[164:167], v[152:155], v[84:87]
    ds_read_b64_tr_b16 v[138:139], v3 offset:10240
    v_mfma_f32_16x16x32_bf16 v[88:91], v[160:163], v[156:159], v[88:91]
    ds_read_b64_tr_b16 v[140:141], v4 offset:8192
    v_mfma_f32_16x16x32_bf16 v[92:95], v[164:167], v[156:159], v[92:95]
    ds_read_b64_tr_b16 v[142:143], v4 offset:10240
    s_waitcnt lgkmcnt(4)
    v_mfma_f32_16x16x32_bf16 v[96:99], v[160:163], v[128:131], v[96:99]
    ds_read_b64_tr_b16 v[144:145], v1 offset:20480
    v_mfma_f32_16x16x32_bf16 v[100:103], v[164:167], v[128:131], v[100:103]
    ds_read_b64_tr_b16 v[146:147], v1 offset:22528
    v_mfma_f32_16x16x32_bf16 v[104:107], v[160:163], v[132:135], v[104:107]
    ds_read_b64_tr_b16 v[148:149], v2 offset:20480
    v_mfma_f32_16x16x32_bf16 v[108:111], v[164:167], v[132:135], v[108:111]
    ds_read_b64_tr_b16 v[150:151], v2 offset:22528
    s_waitcnt lgkmcnt(4)
    v_mfma_f32_16x16x32_bf16 v[112:115], v[160:163], v[136:139], v[112:115]
    ds_read_b64_tr_b16 v[152:153], v3 offset:20480
    v_mfma_f32_16x16x32_bf16 v[116:119], v[164:167], v[136:139], v[116:119]
    ds_read_b64_tr_b16 v[154:155], v3 offset:22528
    v_mfma_f32_16x16x32_bf16 v[120:123], v[160:163], v[140:143], v[120:123]
    ds_read_b64_tr_b16 v[156:157], v4 offset:20480
    buffer_load_dwordx4 v[160:163], v9, s[12:15], s42 offen sc1
    v_mfma_f32_16x16x32_bf16 v[124:127], v[164:167], v[140:143], v[124:127]
    ds_read_b64_tr_b16 v[158:159], v4 offset:22528
    buffer_load_dwordx4 v[164:167], v9, s[12:15], s42 offen offset:1024 sc1
    s_waitcnt vmcnt(7) lgkmcnt(4)
    v_mfma_f32_16x16x32_bf16 v[32:35], v[144:147], v[168:171], v[32:35]
    ds_read_b64_tr_b16 v[128:129], v1 offset:4096
    s_waitcnt vmcnt(6)
    v_mfma_f32_16x16x32_bf16 v[40:43], v[144:147], v[172:175], v[40:43]
    ds_read_b64_tr_b16 v[130:131], v1 offset:6144
    v_mfma_f32_16x16x32_bf16 v[36:39], v[148:151], v[168:171], v[36:39]
    ds_read_b64_tr_b16 v[132:133], v2 offset:4096
    v_mfma_f32_16x16x32_bf16 v[44:47], v[148:151], v[172:175], v[44:47]
    ds_read_b64_tr_b16 v[134:135], v2 offset:6144
    s_waitcnt lgkmcnt(4)
    v_mfma_f32_16x16x32_bf16 v[48:51], v[152:155], v[168:171], v[48:51]
    ds_read_b64_tr_b16 v[136:137], v3 offset:4096
    v_mfma_f32_16x16x32_bf16 v[56:59], v[152:155], v[172:175], v[56:59]
    ds_read_b64_tr_b16 v[138:139], v3 offset:6144
    v_mfma_f32_16x16x32_bf16 v[52:55], v[156:159], v[168:171], v[52:55]
    ds_read_b64_tr_b16 v[140:141], v4 offset:4096
    v_mfma_f32_16x16x32_bf16 v[60:63], v[156:159], v[172:175], v[60:63]
    ds_read_b64_tr_b16 v[142:143], v4 offset:6144
    s_waitcnt lgkmcnt(4)
    v_mfma_f32_16x16x32_bf16 v[64:67], v[168:171], v[128:131], v[64:67]
    ds_read_b64_tr_b16 v[144:145], v1 offset:12288
    v_mfma_f32_16x16x32_bf16 v[68:71], v[172:175], v[128:131], v[68:71]
    ds_read_b64_tr_b16 v[146:147], v1 offset:14336
    v_mfma_f32_16x16x32_bf16 v[72:75], v[168:171], v[132:135], v[72:75]
    ds_read_b64_tr_b16 v[148:149], v2 offset:12288
    v_mfma_f32_16x16x32_bf16 v[76:79], v[172:175], v[132:135], v[76:79]
    ds_read_b64_tr_b16 v[150:151], v2 offset:14336
    s_waitcnt lgkmcnt(4)
    v_mfma_f32_16x16x32_bf16 v[80:83], v[168:171], v[136:139], v[80:83]
    ds_read_b64_tr_b16 v[152:153], v3 offset:12288
    v_mfma_f32_16x16x32_bf16 v[84:87], v[172:175], v[136:139], v[84:87]
    ds_read_b64_tr_b16 v[154:155], v3 offset:14336
    v_mfma_f32_16x16x32_bf16 v[88:91], v[168:171], v[140:143], v[88:91]
    ds_read_b64_tr_b16 v[156:157], v4 offset:12288
    v_mfma_f32_16x16x32_bf16 v[92:95], v[172:175], v[140:143], v[92:95]
    ds_read_b64_tr_b16 v[158:159], v4 offset:14336
    s_waitcnt lgkmcnt(4)
    v_mfma_f32_16x16x32_bf16 v[96:99], v[168:171], v[144:147], v[96:99]
    s_barrier
    ds_read_b64_tr_b16 v[128:129], v1 offset:40960
    v_mfma_f32_16x16x32_bf16 v[100:103], v[172:175], v[144:147], v[100:103]
    ds_read_b64_tr_b16 v[130:131], v1 offset:43008
    v_mfma_f32_16x16x32_bf16 v[104:107], v[168:171], v[148:151], v[104:107]
    ds_read_b64_tr_b16 v[132:133], v2 offset:40960
    v_mfma_f32_16x16x32_bf16 v[108:111], v[172:175], v[148:151], v[108:111]
    ds_read_b64_tr_b16 v[134:135], v2 offset:43008
    s_waitcnt lgkmcnt(4)
    v_mfma_f32_16x16x32_bf16 v[112:115], v[168:171], v[152:155], v[112:115]
    ds_read_b64_tr_b16 v[136:137], v3 offset:40960
    v_mfma_f32_16x16x32_bf16 v[116:119], v[172:175], v[152:155], v[116:119]
    ds_read_b64_tr_b16 v[138:139], v3 offset:43008
    v_mfma_f32_16x16x32_bf16 v[120:123], v[168:171], v[156:159], v[120:123]
    ds_read_b64_tr_b16 v[140:141], v4 offset:40960
    buffer_load_dwordx4 v[168:171], v9, s[12:15], s42 offen offset:2048 sc1
    v_mfma_f32_16x16x32_bf16 v[124:127], v[172:175], v[156:159], v[124:127]
    ds_read_b64_tr_b16 v[142:143], v4 offset:43008
    buffer_load_dwordx4 v[172:175], v9, s[12:15], s42 offen offset:3072 sc1
    s_waitcnt vmcnt(7) lgkmcnt(4)
    v_mfma_f32_16x16x32_bf16 v[32:35], v[128:131], v[176:179], v[32:35]
    s_add_u32 s87, s96, s95
    ds_read_b64_tr_b16 v[144:145], v1 offset:24576
    s_waitcnt vmcnt(6)
    v_mfma_f32_16x16x32_bf16 v[40:43], v[128:131], v[180:183], v[40:43]
    s_add_u32 s97, s87, 16
    ds_read_b64_tr_b16 v[146:147], v1 offset:26624
    v_mfma_f32_16x16x32_bf16 v[36:39], v[132:135], v[176:179], v[36:39]
    s_min_u32 s87, s87, s97
    ds_read_b64_tr_b16 v[148:149], v2 offset:24576
    v_mfma_f32_16x16x32_bf16 v[44:47], v[132:135], v[180:183], v[44:47]
    s_sub_u32 s97, s87, 16
    ds_read_b64_tr_b16 v[150:151], v2 offset:26624
    s_waitcnt lgkmcnt(4)
    v_mfma_f32_16x16x32_bf16 v[48:51], v[136:139], v[176:179], v[48:51]
    s_min_u32 s87, s87, s97
    ds_read_b64_tr_b16 v[152:153], v3 offset:24576
    v_mfma_f32_16x16x32_bf16 v[56:59], v[136:139], v[180:183], v[56:59]
    s_cmp_ge_u32 s96, 16
    s_cselect_b32 s87, 16, s87
    ds_read_b64_tr_b16 v[154:155], v3 offset:26624
    v_mfma_f32_16x16x32_bf16 v[52:55], v[140:143], v[176:179], v[52:55]
    s_add_u32 s96, s96, 1
    s_mul_i32 s42, s87, 4096
    ds_read_b64_tr_b16 v[156:157], v4 offset:24576
    v_mfma_f32_16x16x32_bf16 v[60:63], v[140:143], v[180:183], v[60:63]
    ds_read_b64_tr_b16 v[158:159], v4 offset:26624
    s_waitcnt lgkmcnt(4)
    v_mfma_f32_16x16x32_bf16 v[64:67], v[176:179], v[144:147], v[64:67]
    ds_read_b64_tr_b16 v[128:129], v1 offset:32768
    v_mfma_f32_16x16x32_bf16 v[68:71], v[180:183], v[144:147], v[68:71]
    ds_read_b64_tr_b16 v[130:131], v1 offset:34816
    v_mfma_f32_16x16x32_bf16 v[72:75], v[176:179], v[148:151], v[72:75]
    ds_read_b64_tr_b16 v[132:133], v2 offset:32768
    v_mfma_f32_16x16x32_bf16 v[76:79], v[180:183], v[148:151], v[76:79]
    ds_read_b64_tr_b16 v[134:135], v2 offset:34816
    s_waitcnt lgkmcnt(4)
    v_mfma_f32_16x16x32_bf16 v[80:83], v[176:179], v[152:155], v[80:83]
    ds_read_b64_tr_b16 v[136:137], v3 offset:32768
    v_mfma_f32_16x16x32_bf16 v[84:87], v[180:183], v[152:155], v[84:87]
    ds_read_b64_tr_b16 v[138:139], v3 offset:34816
    v_mfma_f32_16x16x32_bf16 v[88:91], v[176:179], v[156:159], v[88:91]
    ds_read_b64_tr_b16 v[140:141], v4 offset:32768
    v_mfma_f32_16x16x32_bf16 v[92:95], v[180:183], v[156:159], v[92:95]
    ds_read_b64_tr_b16 v[142:143], v4 offset:34816
    s_waitcnt lgkmcnt(4)
    v_mfma_f32_16x16x32_bf16 v[96:99], v[176:179], v[128:131], v[96:99]
    ds_read_b64_tr_b16 v[144:145], v1 offset:45056
    v_mfma_f32_16x16x32_bf16 v[100:103], v[180:183], v[128:131], v[100:103]
    ds_read_b64_tr_b16 v[146:147], v1 offset:47104
    v_mfma_f32_16x16x32_bf16 v[104:107], v[176:179], v[132:135], v[104:107]
    ds_read_b64_tr_b16 v[148:149], v2 offset:45056
    v_mfma_f32_16x16x32_bf16 v[108:111], v[180:183], v[132:135], v[108:111]
    ds_read_b64_tr_b16 v[150:151], v2 offset:47104
    s_waitcnt lgkmcnt(4)
    v_mfma_f32_16x16x32_bf16 v[112:115], v[176:179], v[136:139], v[112:115]
    ds_read_b64_tr_b16 v[152:153], v3 offset:45056
    v_mfma_f32_16x16x32_bf16 v[116:119], v[180:183], v[136:139], v[116:119]
    ds_read_b64_tr_b16 v[154:155], v3 offset:47104
    v_mfma_f32_16x16x32_bf16 v[120:123], v[176:179], v[140:143], v[120:123]
    ds_read_b64_tr_b16 v[156:157], v4 offset:45056
    buffer_load_dwordx4 v[176:179], v9, s[12:15], s42 offen sc1
    v_mfma_f32_16x16x32_bf16 v[124:127], v[180:183], v[140:143], v[124:127]
    ds_read_b64_tr_b16 v[158:159], v4 offset:47104
    buffer_load_dwordx4 v[180:183], v9, s[12:15], s42 offen offset:1024 sc1
    s_waitcnt vmcnt(7) lgkmcnt(4)
    v_mfma_f32_16x16x32_bf16 v[32:35], v[144:147], v[184:187], v[32:35]
    ds_read_b64_tr_b16 v[128:129], v1 offset:28672
    s_waitcnt vmcnt(6)
    v_mfma_f32_16x16x32_bf16 v[40:43], v[144:147], v[188:191], v[40:43]
    ds_read_b64_tr_b16 v[130:131], v1 offset:30720
    v_mfma_f32_16x16x32_bf16 v[36:39], v[148:151], v[184:187], v[36:39]
    ds_read_b64_tr_b16 v[132:133], v2 offset:28672
    v_mfma_f32_16x16x32_bf16 v[44:47], v[148:151], v[188:191], v[44:47]
    ds_read_b64_tr_b16 v[134:135], v2 offset:30720
    s_waitcnt lgkmcnt(4)
    v_mfma_f32_16x16x32_bf16 v[48:51], v[152:155], v[184:187], v[48:51]
    ds_read_b64_tr_b16 v[136:137], v3 offset:28672
    v_mfma_f32_16x16x32_bf16 v[56:59], v[152:155], v[188:191], v[56:59]
    ds_read_b64_tr_b16 v[138:139], v3 offset:30720
    v_mfma_f32_16x16x32_bf16 v[52:55], v[156:159], v[184:187], v[52:55]
    ds_read_b64_tr_b16 v[140:141], v4 offset:28672
    v_mfma_f32_16x16x32_bf16 v[60:63], v[156:159], v[188:191], v[60:63]
    ds_read_b64_tr_b16 v[142:143], v4 offset:30720
    s_waitcnt lgkmcnt(4)
    v_mfma_f32_16x16x32_bf16 v[64:67], v[184:187], v[128:131], v[64:67]
    ds_read_b64_tr_b16 v[144:145], v1 offset:36864
    v_mfma_f32_16x16x32_bf16 v[68:71], v[188:191], v[128:131], v[68:71]
    ds_read_b64_tr_b16 v[146:147], v1 offset:38912
    v_mfma_f32_16x16x32_bf16 v[72:75], v[184:187], v[132:135], v[72:75]
    ds_read_b64_tr_b16 v[148:149], v2 offset:36864
    v_mfma_f32_16x16x32_bf16 v[76:79], v[188:191], v[132:135], v[76:79]
    ds_read_b64_tr_b16 v[150:151], v2 offset:38912
    s_waitcnt lgkmcnt(4)
    v_mfma_f32_16x16x32_bf16 v[80:83], v[184:187], v[136:139], v[80:83]
    ds_read_b64_tr_b16 v[152:153], v3 offset:36864
    v_mfma_f32_16x16x32_bf16 v[84:87], v[188:191], v[136:139], v[84:87]
    ds_read_b64_tr_b16 v[154:155], v3 offset:38912
    v_mfma_f32_16x16x32_bf16 v[88:91], v[184:187], v[140:143], v[88:91]
    ds_read_b64_tr_b16 v[156:157], v4 offset:36864
    v_mfma_f32_16x16x32_bf16 v[92:95], v[188:191], v[140:143], v[92:95]
    ds_read_b64_tr_b16 v[158:159], v4 offset:38912
    s_waitcnt lgkmcnt(4)
    v_mfma_f32_16x16x32_bf16 v[96:99], v[184:187], v[144:147], v[96:99]
    s_barrier
    ds_read_b64_tr_b16 v[128:129], v5 offset:16384
    v_mfma_f32_16x16x32_bf16 v[100:103], v[188:191], v[144:147], v[100:103]
    ds_read_b64_tr_b16 v[130:131], v5 offset:18432
    v_mfma_f32_16x16x32_bf16 v[104:107], v[184:187], v[148:151], v[104:107]
    ds_read_b64_tr_b16 v[132:133], v6 offset:16384
    v_mfma_f32_16x16x32_bf16 v[108:111], v[188:191], v[148:151], v[108:111]
    ds_read_b64_tr_b16 v[134:135], v6 offset:18432
    s_waitcnt lgkmcnt(4)
    v_mfma_f32_16x16x32_bf16 v[112:115], v[184:187], v[152:155], v[112:115]
    ds_read_b64_tr_b16 v[136:137], v7 offset:16384
    v_mfma_f32_16x16x32_bf16 v[116:119], v[188:191], v[152:155], v[116:119]
    ds_read_b64_tr_b16 v[138:139], v7 offset:18432
    v_mfma_f32_16x16x32_bf16 v[120:123], v[184:187], v[156:159], v[120:123]
    ds_read_b64_tr_b16 v[140:141], v8 offset:16384
    buffer_load_dwordx4 v[184:187], v9, s[12:15], s42 offen offset:2048 sc1
    v_mfma_f32_16x16x32_bf16 v[124:127], v[188:191], v[156:159], v[124:127]
    ds_read_b64_tr_b16 v[142:143], v8 offset:18432
    buffer_load_dwordx4 v[188:191], v9, s[12:15], s42 offen offset:3072 sc1
    s_waitcnt vmcnt(7) lgkmcnt(4)
    v_mfma_f32_16x16x32_bf16 v[32:35], v[128:131], v[160:163], v[32:35]
    s_add_u32 s84, s96, s92
    ds_read_b64_tr_b16 v[144:145], v5 offset:0
    s_waitcnt vmcnt(6)
    v_mfma_f32_16x16x32_bf16 v[40:43], v[128:131], v[164:167], v[40:43]
    s_add_u32 s97, s84, 16
    ds_read_b64_tr_b16 v[146:147], v5 offset:2048
    v_mfma_f32_16x16x32_bf16 v[36:39], v[132:135], v[160:163], v[36:39]
    s_min_u32 s84, s84, s97
    ds_read_b64_tr_b16 v[148:149], v6 offset:0
    v_mfma_f32_16x16x32_bf16 v[44:47], v[132:135], v[164:167], v[44:47]
    s_sub_u32 s97, s84, 16
    ds_read_b64_tr_b16 v[150:151], v6 offset:2048
    s_waitcnt lgkmcnt(4)
    v_mfma_f32_16x16x32_bf16 v[48:51], v[136:139], v[160:163], v[48:51]
    s_min_u32 s84, s84, s97
    ds_read_b64_tr_b16 v[152:153], v7 offset:0
    v_mfma_f32_16x16x32_bf16 v[56:59], v[136:139], v[164:167], v[56:59]
    s_cmp_ge_u32 s96, 16
    s_cselect_b32 s84, 16, s84
    ds_read_b64_tr_b16 v[154:155], v7 offset:2048
    v_mfma_f32_16x16x32_bf16 v[52:55], v[140:143], v[160:163], v[52:55]
    s_add_u32 s96, s96, 1
    s_mul_i32 s42, s84, 4096
    ds_read_b64_tr_b16 v[156:157], v8 offset:0
    v_mfma_f32_16x16x32_bf16 v[60:63], v[140:143], v[164:167], v[60:63]
    ds_read_b64_tr_b16 v[158:159], v8 offset:2048
    s_waitcnt lgkmcnt(4)
    v_mfma_f32_16x16x32_bf16 v[64:67], v[160:163], v[144:147], v[64:67]
    ds_read_b64_tr_b16 v[128:129], v5 offset:8192
    v_mfma_f32_16x16x32_bf16 v[68:71], v[164:167], v[144:147], v[68:71]
    ds_read_b64_tr_b16 v[130:131], v5 offset:10240
    v_mfma_f32_16x16x32_bf16 v[72:75], v[160:163], v[148:151], v[72:75]
    ds_read_b64_tr_b16 v[132:133], v6 offset:8192
    v_mfma_f32_16x16x32_bf16 v[76:79], v[164:167], v[148:151], v[76:79]
    ds_read_b64_tr_b16 v[134:135], v6 offset:10240
    s_waitcnt lgkmcnt(4)
    v_mfma_f32_16x16x32_bf16 v[80:83], v[160:163], v[152:155], v[80:83]
    ds_read_b64_tr_b16 v[136:137], v7 offset:8192
    v_mfma_f32_16x16x32_bf16 v[84:87], v[164:167], v[152:155], v[84:87]
    ds_read_b64_tr_b16 v[138:139], v7 offset:10240
    v_mfma_f32_16x16x32_bf16 v[88:91], v[160:163], v[156:159], v[88:91]
    ds_read_b64_tr_b16 v[140:141], v8 offset:8192
    v_mfma_f32_16x16x32_bf16 v[92:95], v[164:167], v[156:159], v[92:95]
    ds_read_b64_tr_b16 v[142:143], v8 offset:10240
    s_waitcnt lgkmcnt(4)
    v_mfma_f32_16x16x32_bf16 v[96:99], v[160:163], v[128:131], v[96:99]
    ds_read_b64_tr_b16 v[144:145], v5 offset:20480
    v_mfma_f32_16x16x32_bf16 v[100:103], v[164:167], v[128:131], v[100:103]
    ds_read_b64_tr_b16 v[146:147], v5 offset:22528
    v_mfma_f32_16x16x32_bf16 v[104:107], v[160:163], v[132:135], v[104:107]
    ds_read_b64_tr_b16 v[148:149], v6 offset:20480
    v_mfma_f32_16x16x32_bf16 v[108:111], v[164:167], v[132:135], v[108:111]
    ds_read_b64_tr_b16 v[150:151], v6 offset:22528
    s_waitcnt lgkmcnt(4)
    v_mfma_f32_16x16x32_bf16 v[112:115], v[160:163], v[136:139], v[112:115]
    ds_read_b64_tr_b16 v[152:153], v7 offset:20480
    v_mfma_f32_16x16x32_bf16 v[116:119], v[164:167], v[136:139], v[116:119]
    ds_read_b64_tr_b16 v[154:155], v7 offset:22528
    v_mfma_f32_16x16x32_bf16 v[120:123], v[160:163], v[140:143], v[120:123]
    ds_read_b64_tr_b16 v[156:157], v8 offset:20480
    buffer_load_dwordx4 v[160:163], v9, s[12:15], s42 offen sc1
    v_mfma_f32_16x16x32_bf16 v[124:127], v[164:167], v[140:143], v[124:127]
    ds_read_b64_tr_b16 v[158:159], v8 offset:22528
    buffer_load_dwordx4 v[164:167], v9, s[12:15], s42 offen offset:1024 sc1
    s_waitcnt vmcnt(7) lgkmcnt(4)
    v_mfma_f32_16x16x32_bf16 v[32:35], v[144:147], v[168:171], v[32:35]
    ds_read_b64_tr_b16 v[128:129], v5 offset:4096
    s_waitcnt vmcnt(6)
    v_mfma_f32_16x16x32_bf16 v[40:43], v[144:147], v[172:175], v[40:43]
    ds_read_b64_tr_b16 v[130:131], v5 offset:6144
    v_mfma_f32_16x16x32_bf16 v[36:39], v[148:151], v[168:171], v[36:39]
    ds_read_b64_tr_b16 v[132:133], v6 offset:4096
    v_mfma_f32_16x16x32_bf16 v[44:47], v[148:151], v[172:175], v[44:47]
    ds_read_b64_tr_b16 v[134:135], v6 offset:6144
    s_waitcnt lgkmcnt(4)
    v_mfma_f32_16x16x32_bf16 v[48:51], v[152:155], v[168:171], v[48:51]
    ds_read_b64_tr_b16 v[136:137], v7 offset:4096
    v_mfma_f32_16x16x32_bf16 v[56:59], v[152:155], v[172:175], v[56:59]
    ds_read_b64_tr_b16 v[138:139], v7 offset:6144
    v_mfma_f32_16x16x32_bf16 v[52:55], v[156:159], v[168:171], v[52:55]
    ds_read_b64_tr_b16 v[140:141], v8 offset:4096
    v_mfma_f32_16x16x32_bf16 v[60:63], v[156:159], v[172:175], v[60:63]
    ds_read_b64_tr_b16 v[142:143], v8 offset:6144
    s_waitcnt lgkmcnt(4)
    v_mfma_f32_16x16x32_bf16 v[64:67], v[168:171], v[128:131], v[64:67]
    ds_read_b64_tr_b16 v[144:145], v5 offset:12288
    v_mfma_f32_16x16x32_bf16 v[68:71], v[172:175], v[128:131], v[68:71]
    ds_read_b64_tr_b16 v[146:147], v5 offset:14336
    v_mfma_f32_16x16x32_bf16 v[72:75], v[168:171], v[132:135], v[72:75]
    ds_read_b64_tr_b16 v[148:149], v6 offset:12288
    v_mfma_f32_16x16x32_bf16 v[76:79], v[172:175], v[132:135], v[76:79]
    ds_read_b64_tr_b16 v[150:151], v6 offset:14336
    s_waitcnt lgkmcnt(4)
    v_mfma_f32_16x16x32_bf16 v[80:83], v[168:171], v[136:139], v[80:83]
    ds_read_b64_tr_b16 v[152:153], v7 offset:12288
    v_mfma_f32_16x16x32_bf16 v[84:87], v[172:175], v[136:139], v[84:87]
    ds_read_b64_tr_b16 v[154:155], v7 offset:14336
    v_mfma_f32_16x16x32_bf16 v[88:91], v[168:171], v[140:143], v[88:91]
    ds_read_b64_tr_b16 v[156:157], v8 offset:12288
    v_mfma_f32_16x16x32_bf16 v[92:95], v[172:175], v[140:143], v[92:95]
    ds_read_b64_tr_b16 v[158:159], v8 offset:14336
    s_waitcnt lgkmcnt(4)
    v_mfma_f32_16x16x32_bf16 v[96:99], v[168:171], v[144:147], v[96:99]
    s_barrier
    ds_read_b64_tr_b16 v[128:129], v5 offset:40960
    v_mfma_f32_16x16x32_bf16 v[100:103], v[172:175], v[144:147], v[100:103]
    ds_read_b64_tr_b16 v[130:131], v5 offset:43008
    v_mfma_f32_16x16x32_bf16 v[104:107], v[168:171], v[148:151], v[104:107]
    ds_read_b64_tr_b16 v[132:133], v6 offset:40960
    v_mfma_f32_16x16x32_bf16 v[108:111], v[172:175], v[148:151], v[108:111]
    ds_read_b64_tr_b16 v[134:135], v6 offset:43008
    s_waitcnt lgkmcnt(4)
    v_mfma_f32_16x16x32_bf16 v[112:115], v[168:171], v[152:155], v[112:115]
    ds_read_b64_tr_b16 v[136:137], v7 offset:40960
    v_mfma_f32_16x16x32_bf16 v[116:119], v[172:175], v[152:155], v[116:119]
    ds_read_b64_tr_b16 v[138:139], v7 offset:43008
    v_mfma_f32_16x16x32_bf16 v[120:123], v[168:171], v[156:159], v[120:123]
    ds_read_b64_tr_b16 v[140:141], v8 offset:40960
    buffer_load_dwordx4 v[168:171], v9, s[12:15], s42 offen offset:2048 sc1
    v_mfma_f32_16x16x32_bf16 v[124:127], v[172:175], v[156:159], v[124:127]
    ds_read_b64_tr_b16 v[142:143], v8 offset:43008
    buffer_load_dwordx4 v[172:175], v9, s[12:15], s42 offen offset:3072 sc1
    s_waitcnt vmcnt(7) lgkmcnt(4)
    v_mfma_f32_16x16x32_bf16 v[32:35], v[128:131], v[176:179], v[32:35]
    s_add_u32 s85, s96, s93
    ds_read_b64_tr_b16 v[144:145], v5 offset:24576
    s_waitcnt vmcnt(6)
    v_mfma_f32_16x16x32_bf16 v[40:43], v[128:131], v[180:183], v[40:43]
    s_add_u32 s97, s85, 16
    ds_read_b64_tr_b16 v[146:147], v5 offset:26624
    v_mfma_f32_16x16x32_bf16 v[36:39], v[132:135], v[176:179], v[36:39]
    s_min_u32 s85, s85, s97
    ds_read_b64_tr_b16 v[148:149], v6 offset:24576
    v_mfma_f32_16x16x32_bf16 v[44:47], v[132:135], v[180:183], v[44:47]
    s_sub_u32 s97, s85, 16
    ds_read_b64_tr_b16 v[150:151], v6 offset:26624
    s_waitcnt lgkmcnt(4)
    v_mfma_f32_16x16x32_bf16 v[48:51], v[136:139], v[176:179], v[48:51]
    s_min_u32 s85, s85, s97
    ds_read_b64_tr_b16 v[152:153], v7 offset:24576
    v_mfma_f32_16x16x32_bf16 v[56:59], v[136:139], v[180:183], v[56:59]
    s_cmp_ge_u32 s96, 16
    s_cselect_b32 s85, 16, s85
    ds_read_b64_tr_b16 v[154:155], v7 offset:26624
    v_mfma_f32_16x16x32_bf16 v[52:55], v[140:143], v[176:179], v[52:55]
    s_add_u32 s96, s96, 1
    s_mul_i32 s42, s85, 4096
    ds_read_b64_tr_b16 v[156:157], v8 offset:24576
    v_mfma_f32_16x16x32_bf16 v[60:63], v[140:143], v[180:183], v[60:63]
    ds_read_b64_tr_b16 v[158:159], v8 offset:26624
    s_waitcnt lgkmcnt(4)
    v_mfma_f32_16x16x32_bf16 v[64:67], v[176:179], v[144:147], v[64:67]
    ds_read_b64_tr_b16 v[128:129], v5 offset:32768
    v_mfma_f32_16x16x32_bf16 v[68:71], v[180:183], v[144:147], v[68:71]
    ds_read_b64_tr_b16 v[130:131], v5 offset:34816
    v_mfma_f32_16x16x32_bf16 v[72:75], v[176:179], v[148:151], v[72:75]
    ds_read_b64_tr_b16 v[132:133], v6 offset:32768
    v_mfma_f32_16x16x32_bf16 v[76:79], v[180:183], v[148:151], v[76:79]
    ds_read_b64_tr_b16 v[134:135], v6 offset:34816
    s_waitcnt lgkmcnt(4)
    v_mfma_f32_16x16x32_bf16 v[80:83], v[176:179], v[152:155], v[80:83]
    ds_read_b64_tr_b16 v[136:137], v7 offset:32768
    v_mfma_f32_16x16x32_bf16 v[84:87], v[180:183], v[152:155], v[84:87]
    ds_read_b64_tr_b16 v[138:139], v7 offset:34816
    v_mfma_f32_16x16x32_bf16 v[88:91], v[176:179], v[156:159], v[88:91]
    ds_read_b64_tr_b16 v[140:141], v8 offset:32768
    v_mfma_f32_16x16x32_bf16 v[92:95], v[180:183], v[156:159], v[92:95]
    ds_read_b64_tr_b16 v[142:143], v8 offset:34816
    s_waitcnt lgkmcnt(4)
    v_mfma_f32_16x16x32_bf16 v[96:99], v[176:179], v[128:131], v[96:99]
    ds_read_b64_tr_b16 v[144:145], v5 offset:45056
    v_mfma_f32_16x16x32_bf16 v[100:103], v[180:183], v[128:131], v[100:103]
    ds_read_b64_tr_b16 v[146:147], v5 offset:47104
    v_mfma_f32_16x16x32_bf16 v[104:107], v[176:179], v[132:135], v[104:107]
    ds_read_b64_tr_b16 v[148:149], v6 offset:45056
    v_mfma_f32_16x16x32_bf16 v[108:111], v[180:183], v[132:135], v[108:111]
    ds_read_b64_tr_b16 v[150:151], v6 offset:47104
    s_waitcnt lgkmcnt(4)
    v_mfma_f32_16x16x32_bf16 v[112:115], v[176:179], v[136:139], v[112:115]
    ds_read_b64_tr_b16 v[152:153], v7 offset:45056
    v_mfma_f32_16x16x32_bf16 v[116:119], v[180:183], v[136:139], v[116:119]
    ds_read_b64_tr_b16 v[154:155], v7 offset:47104
    v_mfma_f32_16x16x32_bf16 v[120:123], v[176:179], v[140:143], v[120:123]
    ds_read_b64_tr_b16 v[156:157], v8 offset:45056
    buffer_load_dwordx4 v[176:179], v9, s[12:15], s42 offen sc1
    v_mfma_f32_16x16x32_bf16 v[124:127], v[180:183], v[140:143], v[124:127]
    ds_read_b64_tr_b16 v[158:159], v8 offset:47104
    buffer_load_dwordx4 v[180:183], v9, s[12:15], s42 offen offset:1024 sc1
    s_waitcnt vmcnt(7) lgkmcnt(4)
    v_mfma_f32_16x16x32_bf16 v[32:35], v[144:147], v[184:187], v[32:35]
    ds_read_b64_tr_b16 v[128:129], v5 offset:28672
    s_waitcnt vmcnt(6)
    v_mfma_f32_16x16x32_bf16 v[40:43], v[144:147], v[188:191], v[40:43]
    ds_read_b64_tr_b16 v[130:131], v5 offset:30720
    v_mfma_f32_16x16x32_bf16 v[36:39], v[148:151], v[184:187], v[36:39]
    ds_read_b64_tr_b16 v[132:133], v6 offset:28672
    v_mfma_f32_16x16x32_bf16 v[44:47], v[148:151], v[188:191], v[44:47]
    ds_read_b64_tr_b16 v[134:135], v6 offset:30720
    s_waitcnt lgkmcnt(4)
    v_mfma_f32_16x16x32_bf16 v[48:51], v[152:155], v[184:187], v[48:51]
    ds_read_b64_tr_b16 v[136:137], v7 offset:28672
    v_mfma_f32_16x16x32_bf16 v[56:59], v[152:155], v[188:191], v[56:59]
    ds_read_b64_tr_b16 v[138:139], v7 offset:30720
    v_mfma_f32_16x16x32_bf16 v[52:55], v[156:159], v[184:187], v[52:55]
    ds_read_b64_tr_b16 v[140:141], v8 offset:28672
    v_mfma_f32_16x16x32_bf16 v[60:63], v[156:159], v[188:191], v[60:63]
    ds_read_b64_tr_b16 v[142:143], v8 offset:30720
    s_waitcnt lgkmcnt(4)
    v_mfma_f32_16x16x32_bf16 v[64:67], v[184:187], v[128:131], v[64:67]
    ds_read_b64_tr_b16 v[144:145], v5 offset:36864
    v_mfma_f32_16x16x32_bf16 v[68:71], v[188:191], v[128:131], v[68:71]
    ds_read_b64_tr_b16 v[146:147], v5 offset:38912
    v_mfma_f32_16x16x32_bf16 v[72:75], v[184:187], v[132:135], v[72:75]
    ds_read_b64_tr_b16 v[148:149], v6 offset:36864
    v_mfma_f32_16x16x32_bf16 v[76:79], v[188:191], v[132:135], v[76:79]
    ds_read_b64_tr_b16 v[150:151], v6 offset:38912
    s_waitcnt lgkmcnt(4)
    v_mfma_f32_16x16x32_bf16 v[80:83], v[184:187], v[136:139], v[80:83]
    ds_read_b64_tr_b16 v[152:153], v7 offset:36864
    v_mfma_f32_16x16x32_bf16 v[84:87], v[188:191], v[136:139], v[84:87]
    ds_read_b64_tr_b16 v[154:155], v7 offset:38912
    v_mfma_f32_16x16x32_bf16 v[88:91], v[184:187], v[140:143], v[88:91]
    ds_read_b64_tr_b16 v[156:157], v8 offset:36864
    v_mfma_f32_16x16x32_bf16 v[92:95], v[188:191], v[140:143], v[92:95]
    ds_read_b64_tr_b16 v[158:159], v8 offset:38912
    s_waitcnt lgkmcnt(4)
    v_mfma_f32_16x16x32_bf16 v[96:99], v[184:187], v[144:147], v[96:99]
    s_barrier
    ds_read_b64_tr_b16 v[128:129], v1 offset:16384
    v_mfma_f32_16x16x32_bf16 v[100:103], v[188:191], v[144:147], v[100:103]
    ds_read_b64_tr_b16 v[130:131], v1 offset:18432
    v_mfma_f32_16x16x32_bf16 v[104:107], v[184:187], v[148:151], v[104:107]
    ds_read_b64_tr_b16 v[132:133], v2 offset:16384
    v_mfma_f32_16x16x32_bf16 v[108:111], v[188:191], v[148:151], v[108:111]
    ds_read_b64_tr_b16 v[134:135], v2 offset:18432
    s_waitcnt lgkmcnt(4)
    v_mfma_f32_16x16x32_bf16 v[112:115], v[184:187], v[152:155], v[112:115]
    ds_read_b64_tr_b16 v[136:137], v3 offset:16384
    v_mfma_f32_16x16x32_bf16 v[116:119], v[188:191], v[152:155], v[116:119]
    ds_read_b64_tr_b16 v[138:139], v3 offset:18432
    v_mfma_f32_16x16x32_bf16 v[120:123], v[184:187], v[156:159], v[120:123]
    ds_read_b64_tr_b16 v[140:141], v4 offset:16384
    buffer_load_dwordx4 v[184:187], v9, s[12:15], s42 offen offset:2048 sc1
    v_mfma_f32_16x16x32_bf16 v[124:127], v[188:191], v[156:159], v[124:127]
    ds_read_b64_tr_b16 v[142:143], v4 offset:18432
    buffer_load_dwordx4 v[188:191], v9, s[12:15], s42 offen offset:3072 sc1
    s_sub_u32 s43, s43, 1
    s_cmp_lg_u32 s43, 1
    s_cbranch_scc1 pq_loop
    s_waitcnt vmcnt(7) lgkmcnt(4)
    v_mfma_f32_16x16x32_bf16 v[32:35], v[128:131], v[160:163], v[32:35]
    s_add_u32 s86, s96, s94
    ds_read_b64_tr_b16 v[144:145], v1 offset:0
    s_waitcnt vmcnt(6)
    v_mfma_f32_16x16x32_bf16 v[40:43], v[128:131], v[164:167], v[40:43]
    s_add_u32 s97, s86, 16
    ds_read_b64_tr_b16 v[146:147], v1 offset:2048
    v_mfma_f32_16x16x32_bf16 v[36:39], v[132:135], v[160:163], v[36:39]
    s_min_u32 s86, s86, s97
    ds_read_b64_tr_b16 v[148:149], v2 offset:0
    v_mfma_f32_16x16x32_bf16 v[44:47], v[132:135], v[164:167], v[44:47]
    s_sub_u32 s97, s86, 16
    ds_read_b64_tr_b16 v[150:151], v2 offset:2048
    s_waitcnt lgkmcnt(4)
    v_mfma_f32_16x16x32_bf16 v[48:51], v[136:139], v[160:163], v[48:51]
    s_min_u32 s86, s86, s97
    ds_read_b64_tr_b16 v[152:153], v3 offset:0
    v_mfma_f32_16x16x32_bf16 v[56:59], v[136:139], v[164:167], v[56:59]
    s_cmp_ge_u32 s96, 16
    s_cselect_b32 s86, 16, s86
    ds_read_b64_tr_b16 v[154:155], v3 offset:2048
    v_mfma_f32_16x16x32_bf16 v[52:55], v[140:143], v[160:163], v[52:55]
    s_add_u32 s96, s96, 1
    ds_read_b64_tr_b16 v[156:157], v4 offset:0
    v_mfma_f32_16x16x32_bf16 v[60:63], v[140:143], v[164:167], v[60:63]
    s_mul_i32 s42, s86, 4096
    ds_read_b64_tr_b16 v[158:159], v4 offset:2048
    s_waitcnt lgkmcnt(4)
    v_mfma_f32_16x16x32_bf16 v[64:67], v[160:163], v[144:147], v[64:67]
    ds_read_b64_tr_b16 v[128:129], v1 offset:8192
    v_mfma_f32_16x16x32_bf16 v[68:71], v[164:167], v[144:147], v[68:71]
    ds_read_b64_tr_b16 v[130:131], v1 offset:10240
    v_mfma_f32_16x16x32_bf16 v[72:75], v[160:163], v[148:151], v[72:75]
    ds_read_b64_tr_b16 v[132:133], v2 offset:8192
    v_mfma_f32_16x16x32_bf16 v[76:79], v[164:167], v[148:151], v[76:79]
    ds_read_b64_tr_b16 v[134:135], v2 offset:10240
    s_waitcnt lgkmcnt(4)
    v_mfma_f32_16x16x32_bf16 v[80:83], v[160:163], v[152:155], v[80:83]
    ds_read_b64_tr_b16 v[136:137], v3 offset:8192
    v_mfma_f32_16x16x32_bf16 v[84:87], v[164:167], v[152:155], v[84:87]
    ds_read_b64_tr_b16 v[138:139], v3 offset:10240
    v_mfma_f32_16x16x32_bf16 v[88:91], v[160:163], v[156:159], v[88:91]
    ds_read_b64_tr_b16 v[140:141], v4 offset:8192
    v_mfma_f32_16x16x32_bf16 v[92:95], v[164:167], v[156:159], v[92:95]
    ds_read_b64_tr_b16 v[142:143], v4 offset:10240
    s_waitcnt lgkmcnt(4)
    v_mfma_f32_16x16x32_bf16 v[96:99], v[160:163], v[128:131], v[96:99]
    ds_read_b64_tr_b16 v[144:145], v1 offset:20480
    v_mfma_f32_16x16x32_bf16 v[100:103], v[164:167], v[128:131], v[100:103]
    ds_read_b64_tr_b16 v[146:147], v1 offset:22528
    v_mfma_f32_16x16x32_bf16 v[104:107], v[160:163], v[132:135], v[104:107]
    ds_read_b64_tr_b16 v[148:149], v2 offset:20480
    v_mfma_f32_16x16x32_bf16 v[108:111], v[164:167], v[132:135], v[108:111]
    ds_read_b64_tr_b16 v[150:151], v2 offset:22528
    s_waitcnt lgkmcnt(4)
    v_mfma_f32_16x16x32_bf16 v[112:115], v[160:163], v[136:139], v[112:115]
    ds_read_b64_tr_b16 v[152:153], v3 offset:20480
    v_mfma_f32_16x16x32_bf16 v[116:119], v[164:167], v[136:139], v[116:119]
    ds_read_b64_tr_b16 v[154:155], v3 offset:22528
    v_mfma_f32_16x16x32_bf16 v[120:123], v[160:163], v[140:143], v[120:123]
    ds_read_b64_tr_b16 v[156:157], v4 offset:20480
    buffer_load_dwordx4 v[160:163], v9, s[12:15], s42 offen sc1
    v_mfma_f32_16x16x32_bf16 v[124:127], v[164:167], v[140:143], v[124:127]
    ds_read_b64_tr_b16 v[158:159], v4 offset:22528
    buffer_load_dwordx4 v[164:167], v9, s[12:15], s42 offen offset:1024 sc1
    s_waitcnt vmcnt(7) lgkmcnt(4)
    v_mfma_f32_16x16x32_bf16 v[32:35], v[144:147], v[168:171], v[32:35]
    ds_read_b64_tr_b16 v[128:129], v1 offset:4096
    s_waitcnt vmcnt(6)
    v_mfma_f32_16x16x32_bf16 v[40:43], v[144:147], v[172:175], v[40:43]
    ds_read_b64_tr_b16 v[130:131], v1 offset:6144
    v_mfma_f32_16x16x32_bf16 v[36:39], v[148:151], v[168:171], v[36:39]
    ds_read_b64_tr_b16 v[132:133], v2 offset:4096
    v_mfma_f32_16x16x32_bf16 v[44:47], v[148:151], v[172:175], v[44:47]
    ds_read_b64_tr_b16 v[134:135], v2 offset:6144
    s_waitcnt lgkmcnt(4)
    v_mfma_f32_16x16x32_bf16 v[48:51], v[152:155], v[168:171], v[48:51]
    ds_read_b64_tr_b16 v[136:137], v3 offset:4096
    v_mfma_f32_16x16x32_bf16 v[56:59], v[152:155], v[172:175], v[56:59]
    ds_read_b64_tr_b16 v[138:139], v3 offset:6144
    v_mfma_f32_16x16x32_bf16 v[52:55], v[156:159], v[168:171], v[52:55]
    ds_read_b64_tr_b16 v[140:141], v4 offset:4096
    v_mfma_f32_16x16x32_bf16 v[60:63], v[156:159], v[172:175], v[60:63]
    ds_read_b64_tr_b16 v[142:143], v4 offset:6144
    s_waitcnt lgkmcnt(4)
    v_mfma_f32_16x16x32_bf16 v[64:67], v[168:171], v[128:131], v[64:67]
    ds_read_b64_tr_b16 v[144:145], v1 offset:12288
    v_mfma_f32_16x16x32_bf16 v[68:71], v[172:175], v[128:131], v[68:71]
    ds_read_b64_tr_b16 v[146:147], v1 offset:14336
    v_mfma_f32_16x16x32_bf16 v[72:75], v[168:171], v[132:135], v[72:75]
    ds_read_b64_tr_b16 v[148:149], v2 offset:12288
    v_mfma_f32_16x16x32_bf16 v[76:79], v[172:175], v[132:135], v[76:79]
    ds_read_b64_tr_b16 v[150:151], v2 offset:14336
    s_waitcnt lgkmcnt(4)
    v_mfma_f32_16x16x32_bf16 v[80:83], v[168:171], v[136:139], v[80:83]
    ds_read_b64_tr_b16 v[152:153], v3 offset:12288
    v_mfma_f32_16x16x32_bf16 v[84:87], v[172:175], v[136:139], v[84:87]
    ds_read_b64_tr_b16 v[154:155], v3 offset:14336
    v_mfma_f32_16x16x32_bf16 v[88:91], v[168:171], v[140:143], v[88:91]
    ds_read_b64_tr_b16 v[156:157], v4 offset:12288
    v_mfma_f32_16x16x32_bf16 v[92:95], v[172:175], v[140:143], v[92:95]
    ds_read_b64_tr_b16 v[158:159], v4 offset:14336
    s_waitcnt lgkmcnt(4)
    v_mfma_f32_16x16x32_bf16 v[96:99], v[168:171], v[144:147], v[96:99]
    s_barrier
    ds_read_b64_tr_b16 v[128:129], v1 offset:40960
    v_mfma_f32_16x16x32_bf16 v[100:103], v[172:175], v[144:147], v[100:103]
    ds_read_b64_tr_b16 v[130:131], v1 offset:43008
    v_mfma_f32_16x16x32_bf16 v[104:107], v[168:171], v[148:151], v[104:107]
    ds_read_b64_tr_b16 v[132:133], v2 offset:40960
    v_mfma_f32_16x16x32_bf16 v[108:111], v[172:175], v[148:151], v[108:111]
    ds_read_b64_tr_b16 v[134:135], v2 offset:43008
    s_waitcnt lgkmcnt(4)
    v_mfma_f32_16x16x32_bf16 v[112:115], v[168:171], v[152:155], v[112:115]
    ds_read_b64_tr_b16 v[136:137], v3 offset:40960
    v_mfma_f32_16x16x32_bf16 v[116:119], v[172:175], v[152:155], v[116:119]
    ds_read_b64_tr_b16 v[138:139], v3 offset:43008
    v_mfma_f32_16x16x32_bf16 v[120:123], v[168:171], v[156:159], v[120:123]
    ds_read_b64_tr_b16 v[140:141], v4 offset:40960
    buffer_load_dwordx4 v[168:171], v9, s[12:15], s42 offen offset:2048 sc1
    v_mfma_f32_16x16x32_bf16 v[124:127], v[172:175], v[156:159], v[124:127]
    ds_read_b64_tr_b16 v[142:143], v4 offset:43008
    buffer_load_dwordx4 v[172:175], v9, s[12:15], s42 offen offset:3072 sc1
    s_waitcnt vmcnt(7) lgkmcnt(4)
    v_mfma_f32_16x16x32_bf16 v[32:35], v[128:131], v[176:179], v[32:35]
    s_add_u32 s87, s96, s95
    ds_read_b64_tr_b16 v[144:145], v1 offset:24576
    s_waitcnt vmcnt(6)
    v_mfma_f32_16x16x32_bf16 v[40:43], v[128:131], v[180:183], v[40:43]
    s_add_u32 s97, s87, 16
    ds_read_b64_tr_b16 v[146:147], v1 offset:26624
    v_mfma_f32_16x16x32_bf16 v[36:39], v[132:135], v[176:179], v[36:39]
    s_min_u32 s87, s87, s97
    ds_read_b64_tr_b16 v[148:149], v2 offset:24576
    v_mfma_f32_16x16x32_bf16 v[44:47], v[132:135], v[180:183], v[44:47]
    s_sub_u32 s97, s87, 16
    ds_read_b64_tr_b16 v[150:151], v2 offset:26624
    s_waitcnt lgkmcnt(4)
    v_mfma_f32_16x16x32_bf16 v[48:51], v[136:139], v[176:179], v[48:51]
    s_min_u32 s87, s87, s97
    ds_read_b64_tr_b16 v[152:153], v3 offset:24576
    v_mfma_f32_16x16x32_bf16 v[56:59], v[136:139], v[180:183], v[56:59]
    s_cmp_ge_u32 s96, 16
    s_cselect_b32 s87, 16, s87
    ds_read_b64_tr_b16 v[154:155], v3 offset:26624
    v_mfma_f32_16x16x32_bf16 v[52:55], v[140:143], v[176:179], v[52:55]
    s_add_u32 s96, s96, 1
    ds_read_b64_tr_b16 v[156:157], v4 offset:24576
    v_mfma_f32_16x16x32_bf16 v[60:63], v[140:143], v[180:183], v[60:63]
    s_mul_i32 s42, s87, 4096
    ds_read_b64_tr_b16 v[158:159], v4 offset:26624
    s_waitcnt lgkmcnt(4)
    v_mfma_f32_16x16x32_bf16 v[64:67], v[176:179], v[144:147], v[64:67]
    ds_read_b64_tr_b16 v[128:129], v1 offset:32768
    v_mfma_f32_16x16x32_bf16 v[68:71], v[180:183], v[144:147], v[68:71]
    ds_read_b64_tr_b16 v[130:131], v1 offset:34816
    v_mfma_f32_16x16x32_bf16 v[72:75], v[176:179], v[148:151], v[72:75]
    ds_read_b64_tr_b16 v[132:133], v2 offset:32768
    v_mfma_f32_16x16x32_bf16 v[76:79], v[180:183], v[148:151], v[76:79]
    ds_read_b64_tr_b16 v[134:135], v2 offset:34816
    s_waitcnt lgkmcnt(4)
    v_mfma_f32_16x16x32_bf16 v[80:83], v[176:179], v[152:155], v[80:83]
    ds_read_b64_tr_b16 v[136:137], v3 offset:32768
    v_mfma_f32_16x16x32_bf16 v[84:87], v[180:183], v[152:155], v[84:87]
    ds_read_b64_tr_b16 v[138:139], v3 offset:34816
    v_mfma_f32_16x16x32_bf16 v[88:91], v[176:179], v[156:159], v[88:91]
    ds_read_b64_tr_b16 v[140:141], v4 offset:32768
    v_mfma_f32_16x16x32_bf16 v[92:95], v[180:183], v[156:159], v[92:95]
    ds_read_b64_tr_b16 v[142:143], v4 offset:34816
    s_waitcnt lgkmcnt(4)
    v_mfma_f32_16x16x32_bf16 v[96:99], v[176:179], v[128:131], v[96:99]
    ds_read_b64_tr_b16 v[144:145], v1 offset:45056
    v_mfma_f32_16x16x32_bf16 v[100:103], v[180:183], v[128:131], v[100:103]
    ds_read_b64_tr_b16 v[146:147], v1 offset:47104
    v_mfma_f32_16x16x32_bf16 v[104:107], v[176:179], v[132:135], v[104:107]
    ds_read_b64_tr_b16 v[148:149], v2 offset:45056
    v_mfma_f32_16x16x32_bf16 v[108:111], v[180:183], v[132:135], v[108:111]
    ds_read_b64_tr_b16 v[150:151], v2 offset:47104
    s_waitcnt lgkmcnt(4)
    v_mfma_f32_16x16x32_bf16 v[112:115], v[176:179], v[136:139], v[112:115]
    ds_read_b64_tr_b16 v[152:153], v3 offset:45056
    v_mfma_f32_16x16x32_bf16 v[116:119], v[180:183], v[136:139], v[116:119]
    ds_read_b64_tr_b16 v[154:155], v3 offset:47104
    v_mfma_f32_16x16x32_bf16 v[120:123], v[176:179], v[140:143], v[120:123]
    ds_read_b64_tr_b16 v[156:157], v4 offset:45056
    buffer_load_dwordx4 v[176:179], v9, s[12:15], s42 offen sc1
    v_mfma_f32_16x16x32_bf16 v[124:127], v[180:183], v[140:143], v[124:127]
    ds_read_b64_tr_b16 v[158:159], v4 offset:47104
    buffer_load_dwordx4 v[180:183], v9, s[12:15], s42 offen offset:1024 sc1
    s_waitcnt vmcnt(7) lgkmcnt(4)
    v_mfma_f32_16x16x32_bf16 v[32:35], v[144:147], v[184:187], v[32:35]
    ds_read_b64_tr_b16 v[128:129], v1 offset:28672
    s_waitcnt vmcnt(6)
    v_mfma_f32_16x16x32_bf16 v[40:43], v[144:147], v[188:191], v[40:43]
    ds_read_b64_tr_b16 v[130:131], v1 offset:30720
    v_mfma_f32_16x16x32_bf16 v[36:39], v[148:151], v[184:187], v[36:39]
    ds_read_b64_tr_b16 v[132:133], v2 offset:28672
    v_mfma_f32_16x16x32_bf16 v[44:47], v[148:151], v[188:191], v[44:47]
    ds_read_b64_tr_b16 v[134:135], v2 offset:30720
    s_waitcnt lgkmcnt(4)
    v_mfma_f32_16x16x32_bf16 v[48:51], v[152:155], v[184:187], v[48:51]
    ds_read_b64_tr_b16 v[136:137], v3 offset:28672
    v_mfma_f32_16x16x32_bf16 v[56:59], v[152:155], v[188:191], v[56:59]
    ds_read_b64_tr_b16 v[138:139], v3 offset:30720
    v_mfma_f32_16x16x32_bf16 v[52:55], v[156:159], v[184:187], v[52:55]
    ds_read_b64_tr_b16 v[140:141], v4 offset:28672
    v_mfma_f32_16x16x32_bf16 v[60:63], v[156:159], v[188:191], v[60:63]
    ds_read_b64_tr_b16 v[142:143], v4 offset:30720
    s_waitcnt lgkmcnt(4)
    v_mfma_f32_16x16x32_bf16 v[64:67], v[184:187], v[128:131], v[64:67]
    ds_read_b64_tr_b16 v[144:145], v1 offset:36864
    v_mfma_f32_16x16x32_bf16 v[68:71], v[188:191], v[128:131], v[68:71]
    ds_read_b64_tr_b16 v[146:147], v1 offset:38912
    v_mfma_f32_16x16x32_bf16 v[72:75], v[184:187], v[132:135], v[72:75]
    ds_read_b64_tr_b16 v[148:149], v2 offset:36864
    v_mfma_f32_16x16x32_bf16 v[76:79], v[188:191], v[132:135], v[76:79]
    ds_read_b64_tr_b16 v[150:151], v2 offset:38912
    s_waitcnt lgkmcnt(4)
    v_mfma_f32_16x16x32_bf16 v[80:83], v[184:187], v[136:139], v[80:83]
    ds_read_b64_tr_b16 v[152:153], v3 offset:36864
    v_mfma_f32_16x16x32_bf16 v[84:87], v[188:191], v[136:139], v[84:87]
    ds_read_b64_tr_b16 v[154:155], v3 offset:38912
    v_mfma_f32_16x16x32_bf16 v[88:91], v[184:187], v[140:143], v[88:91]
    ds_read_b64_tr_b16 v[156:157], v4 offset:36864
    v_mfma_f32_16x16x32_bf16 v[92:95], v[188:191], v[140:143], v[92:95]
    ds_read_b64_tr_b16 v[158:159], v4 offset:38912
    s_waitcnt lgkmcnt(4)
    v_mfma_f32_16x16x32_bf16 v[96:99], v[184:187], v[144:147], v[96:99]
    s_barrier
    ds_read_b64_tr_b16 v[128:129], v5 offset:0
    v_mfma_f32_16x16x32_bf16 v[100:103], v[188:191], v[144:147], v[100:103]
    ds_read_b64_tr_b16 v[130:131], v5 offset:2048
    v_mfma_f32_16x16x32_bf16 v[104:107], v[184:187], v[148:151], v[104:107]
    ds_read_b64_tr_b16 v[132:133], v6 offset:0
    v_mfma_f32_16x16x32_bf16 v[108:111], v[188:191], v[148:151], v[108:111]
    ds_read_b64_tr_b16 v[134:135], v6 offset:2048
    s_waitcnt lgkmcnt(4)
    v_mfma_f32_16x16x32_bf16 v[112:115], v[184:187], v[152:155], v[112:115]
    ds_read_b64_tr_b16 v[136:137], v7 offset:0
    v_mfma_f32_16x16x32_bf16 v[116:119], v[188:191], v[152:155], v[116:119]
    ds_read_b64_tr_b16 v[138:139], v7 offset:2048
    v_mfma_f32_16x16x32_bf16 v[120:123], v[184:187], v[156:159], v[120:123]
    ds_read_b64_tr_b16 v[140:141], v8 offset:0
    buffer_load_dwordx4 v[184:187], v9, s[12:15], s42 offen offset:2048 sc1
    v_mfma_f32_16x16x32_bf16 v[124:127], v[188:191], v[156:159], v[124:127]
    ds_read_b64_tr_b16 v[142:143], v8 offset:2048
    buffer_load_dwordx4 v[188:191], v9, s[12:15], s42 offen offset:3072 sc1
    s_waitcnt vmcnt(7) lgkmcnt(4)
    v_mfma_f32_16x16x32_bf16 v[64:67], v[160:163], v[128:131], v[64:67]
    ds_read_b64_tr_b16 v[144:145], v5 offset:8192
    s_waitcnt vmcnt(6)
    v_mfma_f32_16x16x32_bf16 v[68:71], v[164:167], v[128:131], v[68:71]
    ds_read_b64_tr_b16 v[146:147], v5 offset:10240
    v_mfma_f32_16x16x32_bf16 v[72:75], v[160:163], v[132:135], v[72:75]
    ds_read_b64_tr_b16 v[148:149], v6 offset:8192
    v_mfma_f32_16x16x32_bf16 v[76:79], v[164:167], v[132:135], v[76:79]
    ds_read_b64_tr_b16 v[150:151], v6 offset:10240
    s_waitcnt lgkmcnt(4)
    v_mfma_f32_16x16x32_bf16 v[80:83], v[160:163], v[136:139], v[80:83]
    ds_read_b64_tr_b16 v[152:153], v7 offset:8192
    v_mfma_f32_16x16x32_bf16 v[84:87], v[164:167], v[136:139], v[84:87]
    ds_read_b64_tr_b16 v[154:155], v7 offset:10240
    v_mfma_f32_16x16x32_bf16 v[88:91], v[160:163], v[140:143], v[88:91]
    ds_read_b64_tr_b16 v[156:157], v8 offset:8192
    v_mfma_f32_16x16x32_bf16 v[92:95], v[164:167], v[140:143], v[92:95]
    ds_read_b64_tr_b16 v[158:159], v8 offset:10240
    s_waitcnt lgkmcnt(4)
    v_mfma_f32_16x16x32_bf16 v[96:99], v[160:163], v[144:147], v[96:99]
    ds_read_b64_tr_b16 v[128:129], v5 offset:4096
    v_mfma_f32_16x16x32_bf16 v[100:103], v[164:167], v[144:147], v[100:103]
    ds_read_b64_tr_b16 v[130:131], v5 offset:6144
    v_mfma_f32_16x16x32_bf16 v[104:107], v[160:163], v[148:151], v[104:107]
    ds_read_b64_tr_b16 v[132:133], v6 offset:4096
    v_mfma_f32_16x16x32_bf16 v[108:111], v[164:167], v[148:151], v[108:111]
    ds_read_b64_tr_b16 v[134:135], v6 offset:6144
    s_waitcnt lgkmcnt(4)
    v_mfma_f32_16x16x32_bf16 v[112:115], v[160:163], v[152:155], v[112:115]
    ds_read_b64_tr_b16 v[136:137], v7 offset:4096
    v_mfma_f32_16x16x32_bf16 v[116:119], v[164:167], v[152:155], v[116:119]
    ds_read_b64_tr_b16 v[138:139], v7 offset:6144
    v_mfma_f32_16x16x32_bf16 v[120:123], v[160:163], v[156:159], v[120:123]
    ds_read_b64_tr_b16 v[140:141], v8 offset:4096
    v_mfma_f32_16x16x32_bf16 v[124:127], v[164:167], v[156:159], v[124:127]
    ds_read_b64_tr_b16 v[142:143], v8 offset:6144
    s_waitcnt vmcnt(5) lgkmcnt(4)
    v_mfma_f32_16x16x32_bf16 v[64:67], v[168:171], v[128:131], v[64:67]
    ds_read_b64_tr_b16 v[144:145], v5 offset:12288
    s_waitcnt vmcnt(4)
    v_mfma_f32_16x16x32_bf16 v[68:71], v[172:175], v[128:131], v[68:71]
    ds_read_b64_tr_b16 v[146:147], v5 offset:14336
    v_mfma_f32_16x16x32_bf16 v[72:75], v[168:171], v[132:135], v[72:75]
    ds_read_b64_tr_b16 v[148:149], v6 offset:12288
    v_mfma_f32_16x16x32_bf16 v[76:79], v[172:175], v[132:135], v[76:79]
    ds_read_b64_tr_b16 v[150:151], v6 offset:14336
    s_waitcnt lgkmcnt(4)
    v_mfma_f32_16x16x32_bf16 v[80:83], v[168:171], v[136:139], v[80:83]
    ds_read_b64_tr_b16 v[152:153], v7 offset:12288
    v_mfma_f32_16x16x32_bf16 v[84:87], v[172:175], v[136:139], v[84:87]
    ds_read_b64_tr_b16 v[154:155], v7 offset:14336
    v_mfma_f32_16x16x32_bf16 v[88:91], v[168:171], v[140:143], v[88:91]
    ds_read_b64_tr_b16 v[156:157], v8 offset:12288
    v_mfma_f32_16x16x32_bf16 v[92:95], v[172:175], v[140:143], v[92:95]
    ds_read_b64_tr_b16 v[158:159], v8 offset:14336
    s_waitcnt lgkmcnt(4)
    v_mfma_f32_16x16x32_bf16 v[96:99], v[168:171], v[144:147], v[96:99]
    s_barrier
    ds_read_b64_tr_b16 v[128:129], v5 offset:24576
    v_mfma_f32_16x16x32_bf16 v[100:103], v[172:175], v[144:147], v[100:103]
    ds_read_b64_tr_b16 v[130:131], v5 offset:26624
    v_mfma_f32_16x16x32_bf16 v[104:107], v[168:171], v[148:151], v[104:107]
    ds_read_b64_tr_b16 v[132:133], v6 offset:24576
    v_mfma_f32_16x16x32_bf16 v[108:111], v[172:175], v[148:151], v[108:111]
    ds_read_b64_tr_b16 v[134:135], v6 offset:26624
    s_waitcnt lgkmcnt(4)
    v_mfma_f32_16x16x32_bf16 v[112:115], v[168:171], v[152:155], v[112:115]
    ds_read_b64_tr_b16 v[136:137], v7 offset:24576
    v_mfma_f32_16x16x32_bf16 v[116:119], v[172:175], v[152:155], v[116:119]
    ds_read_b64_tr_b16 v[138:139], v7 offset:26624
    v_mfma_f32_16x16x32_bf16 v[120:123], v[168:171], v[156:159], v[120:123]
    ds_read_b64_tr_b16 v[140:141], v8 offset:24576
    v_mfma_f32_16x16x32_bf16 v[124:127], v[172:175], v[156:159], v[124:127]
    ds_read_b64_tr_b16 v[142:143], v8 offset:26624
    s_waitcnt vmcnt(3) lgkmcnt(4)
    v_mfma_f32_16x16x32_bf16 v[64:67], v[176:179], v[128:131], v[64:67]
    ds_read_b64_tr_b16 v[144:145], v5 offset:32768
    s_waitcnt vmcnt(2)
    v_mfma_f32_16x16x32_bf16 v[68:71], v[180:183], v[128:131], v[68:71]
    ds_read_b64_tr_b16 v[146:147], v5 offset:34816
    v_mfma_f32_16x16x32_bf16 v[72:75], v[176:179], v[132:135], v[72:75]
    ds_read_b64_tr_b16 v[148:149], v6 offset:32768
    v_mfma_f32_16x16x32_bf16 v[76:79], v[180:183], v[132:135], v[76:79]
    ds_read_b64_tr_b16 v[150:151], v6 offset:34816
    s_waitcnt lgkmcnt(4)
    v_mfma_f32_16x16x32_bf16 v[80:83], v[176:179], v[136:139], v[80:83]
    ds_read_b64_tr_b16 v[152:153], v7 offset:32768
    v_mfma_f32_16x16x32_bf16 v[84:87], v[180:183], v[136:139], v[84:87]
    ds_read_b64_tr_b16 v[154:155], v7 offset:34816
    v_mfma_f32_16x16x32_bf16 v[88:91], v[176:179], v[140:143], v[88:91]
    ds_read_b64_tr_b16 v[156:157], v8 offset:32768
    v_mfma_f32_16x16x32_bf16 v[92:95], v[180:183], v[140:143], v[92:95]
    ds_read_b64_tr_b16 v[158:159], v8 offset:34816
    s_waitcnt lgkmcnt(4)
    v_mfma_f32_16x16x32_bf16 v[96:99], v[176:179], v[144:147], v[96:99]
    ds_read_b64_tr_b16 v[128:129], v5 offset:28672
    v_mfma_f32_16x16x32_bf16 v[100:103], v[180:183], v[144:147], v[100:103]
    ds_read_b64_tr_b16 v[130:131], v5 offset:30720
    v_mfma_f32_16x16x32_bf16 v[104:107], v[176:179], v[148:151], v[104:107]
    ds_read_b64_tr_b16 v[132:133], v6 offset:28672
    v_mfma_f32_16x16x32_bf16 v[108:111], v[180:183], v[148:151], v[108:111]
    ds_read_b64_tr_b16 v[134:135], v6 offset:30720
    s_waitcnt lgkmcnt(4)
    v_mfma_f32_16x16x32_bf16 v[112:115], v[176:179], v[152:155], v[112:115]
    ds_read_b64_tr_b16 v[136:137], v7 offset:28672
    v_mfma_f32_16x16x32_bf16 v[116:119], v[180:183], v[152:155], v[116:119]
    ds_read_b64_tr_b16 v[138:139], v7 offset:30720
    v_mfma_f32_16x16x32_bf16 v[120:123], v[176:179], v[156:159], v[120:123]
    ds_read_b64_tr_b16 v[140:141], v8 offset:28672
    v_mfma_f32_16x16x32_bf16 v[124:127], v[180:183], v[156:159], v[124:127]
    ds_read_b64_tr_b16 v[142:143], v8 offset:30720
    s_waitcnt vmcnt(1) lgkmcnt(4)
    v_mfma_f32_16x16x32_bf16 v[64:67], v[184:187], v[128:131], v[64:67]
    ds_read_b64_tr_b16 v[144:145], v5 offset:36864
    s_waitcnt vmcnt(0)
    v_mfma_f32_16x16x32_bf16 v[68:71], v[188:191], v[128:131], v[68:71]
    ds_read_b64_tr_b16 v[146:147], v5 offset:38912
    v_mfma_f32_16x16x32_bf16 v[72:75], v[184:187], v[132:135], v[72:75]
    ds_read_b64_tr_b16 v[148:149], v6 offset:36864
    v_mfma_f32_16x16x32_bf16 v[76:79], v[188:191], v[132:135], v[76:79]
    ds_read_b64_tr_b16 v[150:151], v6 offset:38912
    s_waitcnt lgkmcnt(4)
    v_mfma_f32_16x16x32_bf16 v[80:83], v[184:187], v[136:139], v[80:83]
    ds_read_b64_tr_b16 v[152:153], v7 offset:36864
    v_mfma_f32_16x16x32_bf16 v[84:87], v[188:191], v[136:139], v[84:87]
    ds_read_b64_tr_b16 v[154:155], v7 offset:38912
    v_mfma_f32_16x16x32_bf16 v[88:91], v[184:187], v[140:143], v[88:91]
    ds_read_b64_tr_b16 v[156:157], v8 offset:36864
    v_mfma_f32_16x16x32_bf16 v[92:95], v[188:191], v[140:143], v[92:95]
    ds_read_b64_tr_b16 v[158:159], v8 offset:38912
    s_waitcnt lgkmcnt(4)
    v_mfma_f32_16x16x32_bf16 v[96:99], v[184:187], v[144:147], v[96:99]
    s_barrier
    v_mfma_f32_16x16x32_bf16 v[100:103], v[188:191], v[144:147], v[100:103]
    v_mfma_f32_16x16x32_bf16 v[104:107], v[184:187], v[148:151], v[104:107]
    v_mfma_f32_16x16x32_bf16 v[108:111], v[188:191], v[148:151], v[108:111]
    s_waitcnt lgkmcnt(0)
    v_mfma_f32_16x16x32_bf16 v[112:115], v[184:187], v[152:155], v[112:115]
    v_mfma_f32_16x16x32_bf16 v[116:119], v[188:191], v[152:155], v[116:119]
    v_mfma_f32_16x16x32_bf16 v[120:123], v[184:187], v[156:159], v[120:123]
    v_mfma_f32_16x16x32_bf16 v[124:127], v[188:191], v[156:159], v[124:127]
    ds_read_b32 v16, v26
    ds_read_b32 v17, v27
    ds_read_b32 v212, v25 offset:512
    ds_read_b32 v210, v25 offset:256
    ds_read_b32 v213, v25 offset:640
    ds_read_b32 v211, v25 offset:384
    ds_read_b32 v208, v24 offset:0
    ds_read_b32 v209, v24 offset:128
    ds_read_b128 v[192:195], v29 offset:128
    ds_read_b128 v[200:203], v29 offset:256
    ds_read_b128 v[196:199], v29 offset:192
    ds_read_b128 v[204:207], v29 offset:320
    ds_read_b32 v220, v28 offset:128
    ds_read_b32 v224, v28 offset:256
    ds_read_b32 v222, v28 offset:192
    ds_read_b32 v226, v28 offset:320
    s_waitcnt lgkmcnt(8)
    v_mfma_f32_16x16x1_4b_f32 v[96:111], v16, v212, v[96:111]
    v_mfma_f32_16x16x1_4b_f32 v[64:79], v16, v210, v[64:79]
    v_mfma_f32_16x16x1_4b_f32 v[112:127], v16, v213, v[112:127]
    v_mfma_f32_16x16x1_4b_f32 v[80:95], v16, v211, v[80:95]
    v_mfma_f32_16x16x1_4b_f32 v[32:47], v208, v17, v[32:47]
    v_mfma_f32_16x16x1_4b_f32 v[48:63], v209, v17, v[48:63]
    s_waitcnt lgkmcnt(0)
    s_nop 3
    v_pk_mul_f32 v[96:97], v[96:97], v[192:193]
    v_pk_mul_f32 v[98:99], v[98:99], v[194:195]
    v_pk_mul_f32 v[100:101], v[100:101], v[196:197]
    v_pk_mul_f32 v[102:103], v[102:103], v[198:199]
    v_pk_mul_f32 v[104:105], v[104:105], v[192:193]
    v_pk_mul_f32 v[106:107], v[106:107], v[194:195]
    v_pk_mul_f32 v[108:109], v[108:109], v[196:197]
    v_pk_mul_f32 v[110:111], v[110:111], v[198:199]
    v_cvt_pk_bf16_f32 v144, v96, v97
    v_cvt_pk_bf16_f32 v145, v98, v99
    v_cvt_pk_bf16_f32 v146, v100, v101
    v_cvt_pk_bf16_f32 v147, v102, v103
    v_cvt_pk_bf16_f32 v148, v104, v105
    v_cvt_pk_bf16_f32 v149, v106, v107
    v_cvt_pk_bf16_f32 v150, v108, v109
    v_cvt_pk_bf16_f32 v151, v110, v111
    v_pk_mul_f32 v[16:17], v[64:65], v[200:201]
    v_pk_mul_f32 v[18:19], v[66:67], v[202:203]
    v_pk_mul_f32 v[20:21], v[68:69], v[204:205]
    v_pk_mul_f32 v[22:23], v[70:71], v[206:207]
    v_pk_mul_f32 v[24:25], v[72:73], v[200:201]
    v_pk_mul_f32 v[26:27], v[74:75], v[202:203]
    v_pk_mul_f32 v[28:29], v[76:77], v[204:205]
    v_pk_mul_f32 v[30:31], v[78:79], v[206:207]
    v_exp_f32 v16, v16 clamp
    v_exp_f32 v17, v17 clamp
    v_exp_f32 v18, v18 clamp
    v_exp_f32 v19, v19 clamp
    v_exp_f32 v20, v20 clamp
    v_exp_f32 v21, v21 clamp
    v_exp_f32 v22, v22 clamp
    v_exp_f32 v23, v23 clamp
    v_exp_f32 v24, v24 clamp
    v_exp_f32 v25, v25 clamp
    v_exp_f32 v26, v26 clamp
    v_exp_f32 v27, v27 clamp
    v_exp_f32 v28, v28 clamp
    v_exp_f32 v29, v29 clamp
    v_exp_f32 v30, v30 clamp
    v_exp_f32 v31, v31 clamp
    v_pk_fma_f32 v[64:65], v[64:65], v[192:193], 1.0 op_sel_hi:[1,1,0]
    v_pk_fma_f32 v[66:67], v[66:67], v[194:195], 1.0 op_sel_hi:[1,1,0]
    v_pk_fma_f32 v[68:69], v[68:69], v[196:197], 1.0 op_sel_hi:[1,1,0]
    v_pk_fma_f32 v[70:71], v[70:71], v[198:199], 1.0 op_sel_hi:[1,1,0]
    v_pk_fma_f32 v[72:73], v[72:73], v[192:193], 1.0 op_sel_hi:[1,1,0]
    v_pk_fma_f32 v[74:75], v[74:75], v[194:195], 1.0 op_sel_hi:[1,1,0]
    v_pk_fma_f32 v[76:77], v[76:77], v[196:197], 1.0 op_sel_hi:[1,1,0]
    v_pk_fma_f32 v[78:79], v[78:79], v[198:199], 1.0 op_sel_hi:[1,1,0]
    v_max_f32 v64, v64, v16
    v_max_f32 v65, v65, v17
    v_max_f32 v66, v66, v18
    v_max_f32 v67, v67, v19
    v_max_f32 v68, v68, v20
    v_max_f32 v69, v69, v21
    v_max_f32 v70, v70, v22
    v_max_f32 v71, v71, v23
    v_max_f32 v72, v72, v24
    v_max_f32 v73, v73, v25
    v_max_f32 v74, v74, v26
    v_max_f32 v75, v75, v27
    v_max_f32 v76, v76, v28
    v_max_f32 v77, v77, v29
    v_max_f32 v78, v78, v30
    v_max_f32 v79, v79, v31
    v_pk_add_f32 v[64:65], v[64:65], s[46:47] op_sel:[0,1]
    v_pk_add_f32 v[66:67], v[66:67], s[46:47] op_sel:[0,1]
    v_pk_add_f32 v[68:69], v[68:69], s[46:47] op_sel:[0,1]
    v_pk_add_f32 v[70:71], v[70:71], s[46:47] op_sel:[0,1]
    v_pk_add_f32 v[72:73], v[72:73], s[46:47] op_sel:[0,1]
    v_pk_add_f32 v[74:75], v[74:75], s[46:47] op_sel:[0,1]
    v_pk_add_f32 v[76:77], v[76:77], s[46:47] op_sel:[0,1]
    v_pk_add_f32 v[78:79], v[78:79], s[46:47] op_sel:[0,1]
    v_cvt_pk_bf16_f32 v128, v64, v65
    v_cvt_pk_bf16_f32 v129, v66, v67
    v_cvt_pk_bf16_f32 v130, v68, v69
    v_cvt_pk_bf16_f32 v131, v70, v71
    v_cvt_pk_bf16_f32 v132, v72, v73
    v_cvt_pk_bf16_f32 v133, v74, v75
    v_cvt_pk_bf16_f32 v134, v76, v77
    v_cvt_pk_bf16_f32 v135, v78, v79
    s_nop 1
    v_mfma_f32_16x16x32_bf16 v[64:67], v[128:131], v[144:147], 0
    v_mfma_f32_16x16x32_bf16 v[68:71], v[132:135], v[144:147], 0
    v_mfma_f32_16x16x32_bf16 v[72:75], v[128:131], v[148:151], 0
    v_mfma_f32_16x16x32_bf16 v[76:79], v[132:135], v[148:151], 0
    v_mfma_f32_16x16x32_bf16 v[96:99], v[216:219], v[128:131], 0
    v_mfma_f32_16x16x32_bf16 v[100:103], v[216:219], v[132:135], 0
    v_pk_mul_f32 v[112:113], v[112:113], v[192:193]
    v_pk_mul_f32 v[114:115], v[114:115], v[194:195]
    v_pk_mul_f32 v[116:117], v[116:117], v[196:197]
    v_pk_mul_f32 v[118:119], v[118:119], v[198:199]
    v_pk_mul_f32 v[120:121], v[120:121], v[192:193]
    v_pk_mul_f32 v[122:123], v[122:123], v[194:195]
    v_pk_mul_f32 v[124:125], v[124:125], v[196:197]
    v_pk_mul_f32 v[126:127], v[126:127], v[198:199]
    v_cvt_pk_bf16_f32 v152, v112, v113
    v_cvt_pk_bf16_f32 v153, v114, v115
    v_cvt_pk_bf16_f32 v154, v116, v117
    v_cvt_pk_bf16_f32 v155, v118, v119
    v_cvt_pk_bf16_f32 v156, v120, v121
    v_cvt_pk_bf16_f32 v157, v122, v123
    v_cvt_pk_bf16_f32 v158, v124, v125
    v_cvt_pk_bf16_f32 v159, v126, v127
    ds_write_b128 v10, v[64:67] offset:0
    ds_write_b128 v10, v[68:71] offset:4096
    ds_write_b128 v10, v[72:75] offset:8192
    ds_write_b128 v10, v[76:79] offset:12288
    ds_write_b32 v12, v96 offset:0
    ds_write_b32 v12, v100 offset:64
    v_pk_mul_f32 v[16:17], v[80:81], v[200:201]
    v_pk_mul_f32 v[18:19], v[82:83], v[202:203]
    v_pk_mul_f32 v[20:21], v[84:85], v[204:205]
    v_pk_mul_f32 v[22:23], v[86:87], v[206:207]
    v_pk_mul_f32 v[24:25], v[88:89], v[200:201]
    v_pk_mul_f32 v[26:27], v[90:91], v[202:203]
    v_pk_mul_f32 v[28:29], v[92:93], v[204:205]
    v_pk_mul_f32 v[30:31], v[94:95], v[206:207]
    v_exp_f32 v16, v16 clamp
    v_exp_f32 v17, v17 clamp
    v_exp_f32 v18, v18 clamp
    v_exp_f32 v19, v19 clamp
    v_exp_f32 v20, v20 clamp
    v_exp_f32 v21, v21 clamp
    v_exp_f32 v22, v22 clamp
    v_exp_f32 v23, v23 clamp
    v_exp_f32 v24, v24 clamp
    v_exp_f32 v25, v25 clamp
    v_exp_f32 v26, v26 clamp
    v_exp_f32 v27, v27 clamp
    v_exp_f32 v28, v28 clamp
    v_exp_f32 v29, v29 clamp
    v_exp_f32 v30, v30 clamp
    v_exp_f32 v31, v31 clamp
    v_pk_fma_f32 v[80:81], v[80:81], v[192:193], 1.0 op_sel_hi:[1,1,0]
    v_pk_fma_f32 v[82:83], v[82:83], v[194:195], 1.0 op_sel_hi:[1,1,0]
    v_pk_fma_f32 v[84:85], v[84:85], v[196:197], 1.0 op_sel_hi:[1,1,0]
    v_pk_fma_f32 v[86:87], v[86:87], v[198:199], 1.0 op_sel_hi:[1,1,0]
    v_pk_fma_f32 v[88:89], v[88:89], v[192:193], 1.0 op_sel_hi:[1,1,0]
    v_pk_fma_f32 v[90:91], v[90:91], v[194:195], 1.0 op_sel_hi:[1,1,0]
    v_pk_fma_f32 v[92:93], v[92:93], v[196:197], 1.0 op_sel_hi:[1,1,0]
    v_pk_fma_f32 v[94:95], v[94:95], v[198:199], 1.0 op_sel_hi:[1,1,0]
    v_max_f32 v80, v80, v16
    v_max_f32 v81, v81, v17
    v_max_f32 v82, v82, v18
    v_max_f32 v83, v83, v19
    v_max_f32 v84, v84, v20
    v_max_f32 v85, v85, v21
    v_max_f32 v86, v86, v22
    v_max_f32 v87, v87, v23
    v_max_f32 v88, v88, v24
    v_max_f32 v89, v89, v25
    v_max_f32 v90, v90, v26
    v_max_f32 v91, v91, v27
    v_max_f32 v92, v92, v28
    v_max_f32 v93, v93, v29
    v_max_f32 v94, v94, v30
    v_max_f32 v95, v95, v31
    v_pk_add_f32 v[80:81], v[80:81], s[46:47] op_sel:[0,1]
    v_pk_add_f32 v[82:83], v[82:83], s[46:47] op_sel:[0,1]
    v_pk_add_f32 v[84:85], v[84:85], s[46:47] op_sel:[0,1]
    v_pk_add_f32 v[86:87], v[86:87], s[46:47] op_sel:[0,1]
    v_pk_add_f32 v[88:89], v[88:89], s[46:47] op_sel:[0,1]
    v_pk_add_f32 v[90:91], v[90:91], s[46:47] op_sel:[0,1]
    v_pk_add_f32 v[92:93], v[92:93], s[46:47] op_sel:[0,1]
    v_pk_add_f32 v[94:95], v[94:95], s[46:47] op_sel:[0,1]
    v_cvt_pk_bf16_f32 v136, v80, v81
    v_cvt_pk_bf16_f32 v137, v82, v83
    v_cvt_pk_bf16_f32 v138, v84, v85
    v_cvt_pk_bf16_f32 v139, v86, v87
    v_cvt_pk_bf16_f32 v140, v88, v89
    v_cvt_pk_bf16_f32 v141, v90, v91
    v_cvt_pk_bf16_f32 v142, v92, v93
    v_cvt_pk_bf16_f32 v143, v94, v95
    s_nop 1
    v_mfma_f32_16x16x32_bf16 v[80:83], v[136:139], v[152:155], 0
    v_mfma_f32_16x16x32_bf16 v[84:87], v[140:143], v[152:155], 0
    v_mfma_f32_16x16x32_bf16 v[88:91], v[136:139], v[156:159], 0
    v_mfma_f32_16x16x32_bf16 v[92:95], v[140:143], v[156:159], 0
    v_mfma_f32_16x16x32_bf16 v[112:115], v[216:219], v[136:139], 0
    v_mfma_f32_16x16x32_bf16 v[116:119], v[216:219], v[140:143], 0
    s_nop 3
    ds_write_b128 v10, v[80:83] offset:16384
    ds_write_b128 v10, v[84:87] offset:20480
    ds_write_b128 v10, v[88:91] offset:24576
    ds_write_b128 v10, v[92:95] offset:28672
    ds_write_b32 v12, v112 offset:128
    ds_write_b32 v12, v116 offset:192
    s_waitcnt lgkmcnt(0)
    s_barrier
    ds_read_b128 v[64:67], v11 offset:0
    ds_read_b128 v[68:71], v11 offset:1024
    ds_read_b128 v[72:75], v11 offset:2048
    ds_read_b128 v[76:79], v11 offset:3072
    ds_read_b128 v[80:83], v11 offset:4096
    ds_read_b128 v[84:87], v11 offset:5120
    ds_read_b128 v[88:91], v11 offset:6144
    ds_read_b128 v[92:95], v11 offset:7168
    ds_read_b32 v96, v14 offset:0
    ds_read_b32 v97, v14 offset:256
    ds_read_b32 v98, v14 offset:512
    ds_read_b32 v99, v14 offset:768
    s_waitcnt lgkmcnt(8)
    v_pk_add_f32 v[64:65], v[64:65], v[68:69]
    v_pk_add_f32 v[72:73], v[72:73], v[76:77]
    v_pk_add_f32 v[66:67], v[66:67], v[70:71]
    v_pk_add_f32 v[74:75], v[74:75], v[78:79]
    v_pk_add_f32 v[64:65], v[64:65], v[72:73]
    v_pk_add_f32 v[66:67], v[66:67], v[74:75]
    v_cvt_pk_bf16_f32 v128, v64, v65
    v_cvt_pk_bf16_f32 v129, v66, v67
    s_waitcnt lgkmcnt(4)
    v_pk_add_f32 v[80:81], v[80:81], v[84:85]
    v_pk_add_f32 v[88:89], v[88:89], v[92:93]
    v_pk_add_f32 v[82:83], v[82:83], v[86:87]
    v_pk_add_f32 v[90:91], v[90:91], v[94:95]
    v_pk_add_f32 v[80:81], v[80:81], v[88:89]
    v_pk_add_f32 v[82:83], v[82:83], v[90:91]
    v_cvt_pk_bf16_f32 v130, v80, v81
    v_cvt_pk_bf16_f32 v131, v82, v83
    buffer_store_dwordx4 v[128:131], v9, s[24:27], s44 offen sc1
    s_waitcnt lgkmcnt(0)
    v_pk_add_f32 v[96:97], v[96:97], v[98:99]
    v_add_f32 v96, v96, v97
    buffer_store_dword v96, v13, s[16:19], s36 offen sc1
    ds_read_b64_tr_b16 v[64:65], v5 offset:16384
    ds_read_b64_tr_b16 v[66:67], v5 offset:18432
    ds_read_b64_tr_b16 v[68:69], v6 offset:16384
    ds_read_b64_tr_b16 v[70:71], v6 offset:18432
    ds_read_b64_tr_b16 v[72:73], v7 offset:16384
    ds_read_b64_tr_b16 v[74:75], v7 offset:18432
    ds_read_b64_tr_b16 v[76:77], v8 offset:16384
    ds_read_b64_tr_b16 v[78:79], v8 offset:18432
    ds_read_b64_tr_b16 v[80:81], v5 offset:20480
    ds_read_b64_tr_b16 v[82:83], v5 offset:22528
    ds_read_b64_tr_b16 v[84:85], v6 offset:20480
    ds_read_b64_tr_b16 v[86:87], v6 offset:22528
    ds_read_b64_tr_b16 v[88:89], v7 offset:20480
    ds_read_b64_tr_b16 v[90:91], v7 offset:22528
    ds_read_b64_tr_b16 v[92:93], v8 offset:20480
    ds_read_b64_tr_b16 v[94:95], v8 offset:22528
    ds_read_b64_tr_b16 v[100:101], v5 offset:40960
    ds_read_b64_tr_b16 v[102:103], v5 offset:43008
    ds_read_b64_tr_b16 v[104:105], v6 offset:40960
    ds_read_b64_tr_b16 v[106:107], v6 offset:43008
    ds_read_b64_tr_b16 v[108:109], v7 offset:40960
    ds_read_b64_tr_b16 v[110:111], v7 offset:43008
    ds_read_b64_tr_b16 v[132:133], v8 offset:40960
    ds_read_b64_tr_b16 v[134:135], v8 offset:43008
    ds_read_b64_tr_b16 v[136:137], v5 offset:45056
    ds_read_b64_tr_b16 v[138:139], v5 offset:47104
    ds_read_b64_tr_b16 v[140:141], v6 offset:45056
    ds_read_b64_tr_b16 v[142:143], v6 offset:47104
    ds_read_b64_tr_b16 v[144:145], v7 offset:45056
    ds_read_b64_tr_b16 v[146:147], v7 offset:47104
    ds_read_b64_tr_b16 v[148:149], v8 offset:45056
    ds_read_b64_tr_b16 v[150:151], v8 offset:47104
    s_waitcnt lgkmcnt(15)
    v_mfma_f32_16x16x32_bf16 v[32:35], v[64:67], v[160:163], v[32:35]
    v_mfma_f32_16x16x32_bf16 v[40:43], v[64:67], v[164:167], v[40:43]
    v_mfma_f32_16x16x32_bf16 v[36:39], v[68:71], v[160:163], v[36:39]
    v_mfma_f32_16x16x32_bf16 v[44:47], v[68:71], v[164:167], v[44:47]
    v_mfma_f32_16x16x32_bf16 v[48:51], v[72:75], v[160:163], v[48:51]
    v_mfma_f32_16x16x32_bf16 v[56:59], v[72:75], v[164:167], v[56:59]
    v_mfma_f32_16x16x32_bf16 v[52:55], v[76:79], v[160:163], v[52:55]
    v_mfma_f32_16x16x32_bf16 v[60:63], v[76:79], v[164:167], v[60:63]
    s_waitcnt lgkmcnt(15)
    v_mfma_f32_16x16x32_bf16 v[32:35], v[80:83], v[168:171], v[32:35]
    v_mfma_f32_16x16x32_bf16 v[40:43], v[80:83], v[172:175], v[40:43]
    v_mfma_f32_16x16x32_bf16 v[36:39], v[84:87], v[168:171], v[36:39]
    v_mfma_f32_16x16x32_bf16 v[44:47], v[84:87], v[172:175], v[44:47]
    v_mfma_f32_16x16x32_bf16 v[48:51], v[88:91], v[168:171], v[48:51]
    v_mfma_f32_16x16x32_bf16 v[56:59], v[88:91], v[172:175], v[56:59]
    v_mfma_f32_16x16x32_bf16 v[52:55], v[92:95], v[168:171], v[52:55]
    v_mfma_f32_16x16x32_bf16 v[60:63], v[92:95], v[172:175], v[60:63]
    s_waitcnt vmcnt(0)
    s_barrier
    s_waitcnt lgkmcnt(8)
    v_mfma_f32_16x16x32_bf16 v[32:35], v[100:103], v[176:179], v[32:35]
    v_mfma_f32_16x16x32_bf16 v[40:43], v[100:103], v[180:183], v[40:43]
    v_mfma_f32_16x16x32_bf16 v[36:39], v[104:107], v[176:179], v[36:39]
    v_mfma_f32_16x16x32_bf16 v[44:47], v[104:107], v[180:183], v[44:47]
    v_mfma_f32_16x16x32_bf16 v[48:51], v[108:111], v[176:179], v[48:51]
    v_mfma_f32_16x16x32_bf16 v[56:59], v[108:111], v[180:183], v[56:59]
    v_mfma_f32_16x16x32_bf16 v[52:55], v[132:135], v[176:179], v[52:55]
    v_mfma_f32_16x16x32_bf16 v[60:63], v[132:135], v[180:183], v[60:63]
    s_waitcnt lgkmcnt(0)
    v_mfma_f32_16x16x32_bf16 v[32:35], v[136:139], v[184:187], v[32:35]
    v_mfma_f32_16x16x32_bf16 v[40:43], v[136:139], v[188:191], v[40:43]
    v_mfma_f32_16x16x32_bf16 v[36:39], v[140:143], v[184:187], v[36:39]
    v_mfma_f32_16x16x32_bf16 v[44:47], v[140:143], v[188:191], v[44:47]
    v_mfma_f32_16x16x32_bf16 v[48:51], v[144:147], v[184:187], v[48:51]
    v_mfma_f32_16x16x32_bf16 v[56:59], v[144:147], v[188:191], v[56:59]
    v_mfma_f32_16x16x32_bf16 v[52:55], v[148:151], v[184:187], v[52:55]
    v_mfma_f32_16x16x32_bf16 v[60:63], v[148:151], v[188:191], v[60:63]
    s_nop 6
    v_pk_mul_f32 v[16:17], v[32:33], v[224:225] op_sel_hi:[1,0]
    v_pk_mul_f32 v[18:19], v[34:35], v[224:225] op_sel_hi:[1,0]
    v_pk_mul_f32 v[20:21], v[36:37], v[224:225] op_sel_hi:[1,0]
    v_pk_mul_f32 v[22:23], v[38:39], v[224:225] op_sel_hi:[1,0]
    v_pk_mul_f32 v[24:25], v[40:41], v[226:227] op_sel_hi:[1,0]
    v_pk_mul_f32 v[26:27], v[42:43], v[226:227] op_sel_hi:[1,0]
    v_pk_mul_f32 v[28:29], v[44:45], v[226:227] op_sel_hi:[1,0]
    v_pk_mul_f32 v[30:31], v[46:47], v[226:227] op_sel_hi:[1,0]
    v_exp_f32 v16, v16 clamp
    v_exp_f32 v17, v17 clamp
    v_exp_f32 v18, v18 clamp
    v_exp_f32 v19, v19 clamp
    v_exp_f32 v20, v20 clamp
    v_exp_f32 v21, v21 clamp
    v_exp_f32 v22, v22 clamp
    v_exp_f32 v23, v23 clamp
    v_exp_f32 v24, v24 clamp
    v_exp_f32 v25, v25 clamp
    v_exp_f32 v26, v26 clamp
    v_exp_f32 v27, v27 clamp
    v_exp_f32 v28, v28 clamp
    v_exp_f32 v29, v29 clamp
    v_exp_f32 v30, v30 clamp
    v_exp_f32 v31, v31 clamp
    v_pk_fma_f32 v[32:33], v[32:33], v[220:221], 1.0 op_sel_hi:[1,0,0]
    v_pk_fma_f32 v[34:35], v[34:35], v[220:221], 1.0 op_sel_hi:[1,0,0]
    v_pk_fma_f32 v[36:37], v[36:37], v[220:221], 1.0 op_sel_hi:[1,0,0]
    v_pk_fma_f32 v[38:39], v[38:39], v[220:221], 1.0 op_sel_hi:[1,0,0]
    v_pk_fma_f32 v[40:41], v[40:41], v[222:223], 1.0 op_sel_hi:[1,0,0]
    v_pk_fma_f32 v[42:43], v[42:43], v[222:223], 1.0 op_sel_hi:[1,0,0]
    v_pk_fma_f32 v[44:45], v[44:45], v[222:223], 1.0 op_sel_hi:[1,0,0]
    v_pk_fma_f32 v[46:47], v[46:47], v[222:223], 1.0 op_sel_hi:[1,0,0]
    v_max_f32 v32, v32, v16
    v_max_f32 v33, v33, v17
    v_max_f32 v34, v34, v18
    v_max_f32 v35, v35, v19
    v_max_f32 v36, v36, v20
    v_max_f32 v37, v37, v21
    v_max_f32 v38, v38, v22
    v_max_f32 v39, v39, v23
    v_max_f32 v40, v40, v24
    v_max_f32 v41, v41, v25
    v_max_f32 v42, v42, v26
    v_max_f32 v43, v43, v27
    v_max_f32 v44, v44, v28
    v_max_f32 v45, v45, v29
    v_max_f32 v46, v46, v30
    v_max_f32 v47, v47, v31
    v_pk_add_f32 v[32:33], v[32:33], s[46:47] op_sel:[0,1]
    v_pk_add_f32 v[34:35], v[34:35], s[46:47] op_sel:[0,1]
    v_pk_add_f32 v[36:37], v[36:37], s[46:47] op_sel:[0,1]
    v_pk_add_f32 v[38:39], v[38:39], s[46:47] op_sel:[0,1]
    v_pk_add_f32 v[40:41], v[40:41], s[46:47] op_sel:[0,1]
    v_pk_add_f32 v[42:43], v[42:43], s[46:47] op_sel:[0,1]
    v_pk_add_f32 v[44:45], v[44:45], s[46:47] op_sel:[0,1]
    v_pk_add_f32 v[46:47], v[46:47], s[46:47] op_sel:[0,1]
    v_cvt_pk_bf16_f32 v112, v32, v33
    v_cvt_pk_bf16_f32 v113, v34, v35
    v_cvt_pk_bf16_f32 v114, v36, v37
    v_cvt_pk_bf16_f32 v115, v38, v39
    v_cvt_pk_bf16_f32 v116, v40, v41
    v_cvt_pk_bf16_f32 v117, v42, v43
    v_cvt_pk_bf16_f32 v118, v44, v45
    v_cvt_pk_bf16_f32 v119, v46, v47
    v_pk_mul_f32 v[16:17], v[48:49], v[224:225] op_sel_hi:[1,0]
    v_pk_mul_f32 v[18:19], v[50:51], v[224:225] op_sel_hi:[1,0]
    v_pk_mul_f32 v[20:21], v[52:53], v[224:225] op_sel_hi:[1,0]
    v_pk_mul_f32 v[22:23], v[54:55], v[224:225] op_sel_hi:[1,0]
    v_pk_mul_f32 v[24:25], v[56:57], v[226:227] op_sel_hi:[1,0]
    v_pk_mul_f32 v[26:27], v[58:59], v[226:227] op_sel_hi:[1,0]
    v_pk_mul_f32 v[28:29], v[60:61], v[226:227] op_sel_hi:[1,0]
    v_pk_mul_f32 v[30:31], v[62:63], v[226:227] op_sel_hi:[1,0]
    v_exp_f32 v16, v16 clamp
    v_exp_f32 v17, v17 clamp
    v_exp_f32 v18, v18 clamp
    v_exp_f32 v19, v19 clamp
    v_exp_f32 v20, v20 clamp
    v_exp_f32 v21, v21 clamp
    v_exp_f32 v22, v22 clamp
    v_exp_f32 v23, v23 clamp
    v_exp_f32 v24, v24 clamp
    v_exp_f32 v25, v25 clamp
    v_exp_f32 v26, v26 clamp
    v_exp_f32 v27, v27 clamp
    v_exp_f32 v28, v28 clamp
    v_exp_f32 v29, v29 clamp
    v_exp_f32 v30, v30 clamp
    v_exp_f32 v31, v31 clamp
    v_pk_fma_f32 v[48:49], v[48:49], v[220:221], 1.0 op_sel_hi:[1,0,0]
    v_pk_fma_f32 v[50:51], v[50:51], v[220:221], 1.0 op_sel_hi:[1,0,0]
    v_pk_fma_f32 v[52:53], v[52:53], v[220:221], 1.0 op_sel_hi:[1,0,0]
    v_pk_fma_f32 v[54:55], v[54:55], v[220:221], 1.0 op_sel_hi:[1,0,0]
    v_pk_fma_f32 v[56:57], v[56:57], v[222:223], 1.0 op_sel_hi:[1,0,0]
    v_pk_fma_f32 v[58:59], v[58:59], v[222:223], 1.0 op_sel_hi:[1,0,0]
    v_pk_fma_f32 v[60:61], v[60:61], v[222:223], 1.0 op_sel_hi:[1,0,0]
    v_pk_fma_f32 v[62:63], v[62:63], v[222:223], 1.0 op_sel_hi:[1,0,0]
    v_max_f32 v48, v48, v16
    v_max_f32 v49, v49, v17
    v_max_f32 v50, v50, v18
    v_max_f32 v51, v51, v19
    v_max_f32 v52, v52, v20
    v_max_f32 v53, v53, v21
    v_max_f32 v54, v54, v22
    v_max_f32 v55, v55, v23
    v_max_f32 v56, v56, v24
    v_max_f32 v57, v57, v25
    v_max_f32 v58, v58, v26
    v_max_f32 v59, v59, v27
    v_max_f32 v60, v60, v28
    v_max_f32 v61, v61, v29
    v_max_f32 v62, v62, v30
    v_max_f32 v63, v63, v31
    v_pk_add_f32 v[48:49], v[48:49], s[46:47] op_sel:[0,1]
    v_pk_add_f32 v[50:51], v[50:51], s[46:47] op_sel:[0,1]
    v_pk_add_f32 v[52:53], v[52:53], s[46:47] op_sel:[0,1]
    v_pk_add_f32 v[54:55], v[54:55], s[46:47] op_sel:[0,1]
    v_pk_add_f32 v[56:57], v[56:57], s[46:47] op_sel:[0,1]
    v_pk_add_f32 v[58:59], v[58:59], s[46:47] op_sel:[0,1]
    v_pk_add_f32 v[60:61], v[60:61], s[46:47] op_sel:[0,1]
    v_pk_add_f32 v[62:63], v[62:63], s[46:47] op_sel:[0,1]
    v_cvt_pk_bf16_f32 v120, v48, v49
    v_cvt_pk_bf16_f32 v121, v50, v51
    v_cvt_pk_bf16_f32 v122, v52, v53
    v_cvt_pk_bf16_f32 v123, v54, v55
    v_cvt_pk_bf16_f32 v124, v56, v57
    v_cvt_pk_bf16_f32 v125, v58, v59
    v_cvt_pk_bf16_f32 v126, v60, v61
    v_cvt_pk_bf16_f32 v127, v62, v63
    v_mov_b32 v216, 0x3f80
    v_mov_b32 v217, 0x3f800000
    v_add_u32 v11, 98304, v9
    v_pk_mov_b32 v[16:17], 0, 0
    v_pk_mov_b32 v[18:19], 0, 0
    v_pk_mov_b32 v[20:21], 0, 0
    v_pk_mov_b32 v[22:23], 0, 0
    s_barrier
    buffer_load_dwordx4 v[32:35], v9, s[24:27], 0 offen sc1
    s_movk_i32 s44, 4096
    buffer_load_dwordx4 v[36:39], v9, s[24:27], s44 offen sc1
    s_movk_i32 s44, 8192
    buffer_load_dwordx4 v[40:43], v9, s[24:27], s44 offen sc1
    s_movk_i32 s44, 12288
    buffer_load_dwordx4 v[44:47], v9, s[24:27], s44 offen sc1
    s_movk_i32 s44, 16384
    buffer_load_dwordx4 v[48:51], v9, s[24:27], s44 offen sc1
    s_movk_i32 s44, 20480
    buffer_load_dwordx4 v[52:55], v9, s[24:27], s44 offen sc1
    s_movk_i32 s44, 24576
    buffer_load_dwordx4 v[56:59], v9, s[24:27], s44 offen sc1
    s_movk_i32 s44, 28672
    buffer_load_dwordx4 v[60:63], v9, s[24:27], s44 offen sc1
    s_mov_b32 s44, 32768
    buffer_load_dwordx4 v[64:67], v9, s[24:27], s44 offen sc1
    s_mov_b32 s44, 36864
    buffer_load_dwordx4 v[68:71], v9, s[24:27], s44 offen sc1
    s_mov_b32 s44, 40960
    buffer_load_dwordx4 v[72:75], v9, s[24:27], s44 offen sc1
    s_mov_b32 s44, 45056
    buffer_load_dwordx4 v[76:79], v9, s[24:27], s44 offen sc1
    s_mov_b32 s44, 49152
    buffer_load_dwordx4 v[80:83], v9, s[24:27], s44 offen sc1
    s_mov_b32 s44, 53248
    buffer_load_dwordx4 v[84:87], v9, s[24:27], s44 offen sc1
    s_mov_b32 s44, 57344
    buffer_load_dwordx4 v[88:91], v9, s[24:27], s44 offen sc1
    s_mov_b32 s44, 61440
    buffer_load_dwordx4 v[92:95], v9, s[24:27], s44 offen sc1
    s_waitcnt vmcnt(15)
    v_dot2_f32_bf16 v16, v32, v216, v16
    v_dot2_f32_bf16 v17, v32, v217, v17
    v_dot2_f32_bf16 v18, v33, v216, v18
    v_dot2_f32_bf16 v19, v33, v217, v19
    v_dot2_f32_bf16 v20, v34, v216, v20
    v_dot2_f32_bf16 v21, v34, v217, v21
    v_dot2_f32_bf16 v22, v35, v216, v22
    v_dot2_f32_bf16 v23, v35, v217, v23
    s_waitcnt vmcnt(14)
    v_dot2_f32_bf16 v16, v36, v216, v16
    v_dot2_f32_bf16 v17, v36, v217, v17
    v_dot2_f32_bf16 v18, v37, v216, v18
    v_dot2_f32_bf16 v19, v37, v217, v19
    v_dot2_f32_bf16 v20, v38, v216, v20
    v_dot2_f32_bf16 v21, v38, v217, v21
    v_dot2_f32_bf16 v22, v39, v216, v22
    v_dot2_f32_bf16 v23, v39, v217, v23
    s_waitcnt vmcnt(13)
    v_dot2_f32_bf16 v16, v40, v216, v16
    v_dot2_f32_bf16 v17, v40, v217, v17
    v_dot2_f32_bf16 v18, v41, v216, v18
    v_dot2_f32_bf16 v19, v41, v217, v19
    v_dot2_f32_bf16 v20, v42, v216, v20
    v_dot2_f32_bf16 v21, v42, v217, v21
    v_dot2_f32_bf16 v22, v43, v216, v22
    v_dot2_f32_bf16 v23, v43, v217, v23
    s_waitcnt vmcnt(12)
    v_dot2_f32_bf16 v16, v44, v216, v16
    v_dot2_f32_bf16 v17, v44, v217, v17
    v_dot2_f32_bf16 v18, v45, v216, v18
    v_dot2_f32_bf16 v19, v45, v217, v19
    v_dot2_f32_bf16 v20, v46, v216, v20
    v_dot2_f32_bf16 v21, v46, v217, v21
    v_dot2_f32_bf16 v22, v47, v216, v22
    v_dot2_f32_bf16 v23, v47, v217, v23
    s_waitcnt vmcnt(11)
    v_dot2_f32_bf16 v16, v48, v216, v16
    v_dot2_f32_bf16 v17, v48, v217, v17
    v_dot2_f32_bf16 v18, v49, v216, v18
    v_dot2_f32_bf16 v19, v49, v217, v19
    v_dot2_f32_bf16 v20, v50, v216, v20
    v_dot2_f32_bf16 v21, v50, v217, v21
    v_dot2_f32_bf16 v22, v51, v216, v22
    v_dot2_f32_bf16 v23, v51, v217, v23
    s_waitcnt vmcnt(10)
    v_dot2_f32_bf16 v16, v52, v216, v16
    v_dot2_f32_bf16 v17, v52, v217, v17
    v_dot2_f32_bf16 v18, v53, v216, v18
    v_dot2_f32_bf16 v19, v53, v217, v19
    v_dot2_f32_bf16 v20, v54, v216, v20
    v_dot2_f32_bf16 v21, v54, v217, v21
    v_dot2_f32_bf16 v22, v55, v216, v22
    v_dot2_f32_bf16 v23, v55, v217, v23
    s_waitcnt vmcnt(9)
    v_dot2_f32_bf16 v16, v56, v216, v16
    v_dot2_f32_bf16 v17, v56, v217, v17
    v_dot2_f32_bf16 v18, v57, v216, v18
    v_dot2_f32_bf16 v19, v57, v217, v19
    v_dot2_f32_bf16 v20, v58, v216, v20
    v_dot2_f32_bf16 v21, v58, v217, v21
    v_dot2_f32_bf16 v22, v59, v216, v22
    v_dot2_f32_bf16 v23, v59, v217, v23
    s_waitcnt vmcnt(8)
    v_dot2_f32_bf16 v16, v60, v216, v16
    v_dot2_f32_bf16 v17, v60, v217, v17
    v_dot2_f32_bf16 v18, v61, v216, v18
    v_dot2_f32_bf16 v19, v61, v217, v19
    v_dot2_f32_bf16 v20, v62, v216, v20
    v_dot2_f32_bf16 v21, v62, v217, v21
    v_dot2_f32_bf16 v22, v63, v216, v22
    v_dot2_f32_bf16 v23, v63, v217, v23
    buffer_load_dwordx4 v[228:231], v9, s[48:51], 0 offen offset:0 sc1
    buffer_load_dwordx4 v[232:235], v9, s[48:51], 0 offen offset:1024 sc1
    buffer_load_dwordx4 v[236:239], v9, s[48:51], 0 offen offset:2048 sc1
    buffer_load_dwordx4 v[240:243], v9, s[48:51], 0 offen offset:3072 sc1
    s_waitcnt vmcnt(11)
    v_dot2_f32_bf16 v16, v64, v216, v16
    v_dot2_f32_bf16 v17, v64, v217, v17
    v_dot2_f32_bf16 v18, v65, v216, v18
    v_dot2_f32_bf16 v19, v65, v217, v19
    v_dot2_f32_bf16 v20, v66, v216, v20
    v_dot2_f32_bf16 v21, v66, v217, v21
    v_dot2_f32_bf16 v22, v67, v216, v22
    v_dot2_f32_bf16 v23, v67, v217, v23
    s_waitcnt vmcnt(10)
    v_dot2_f32_bf16 v16, v68, v216, v16
    v_dot2_f32_bf16 v17, v68, v217, v17
    v_dot2_f32_bf16 v18, v69, v216, v18
    v_dot2_f32_bf16 v19, v69, v217, v19
    v_dot2_f32_bf16 v20, v70, v216, v20
    v_dot2_f32_bf16 v21, v70, v217, v21
    v_dot2_f32_bf16 v22, v71, v216, v22
    v_dot2_f32_bf16 v23, v71, v217, v23
    s_waitcnt vmcnt(9)
    v_dot2_f32_bf16 v16, v72, v216, v16
    v_dot2_f32_bf16 v17, v72, v217, v17
    v_dot2_f32_bf16 v18, v73, v216, v18
    v_dot2_f32_bf16 v19, v73, v217, v19
    v_dot2_f32_bf16 v20, v74, v216, v20
    v_dot2_f32_bf16 v21, v74, v217, v21
    v_dot2_f32_bf16 v22, v75, v216, v22
    v_dot2_f32_bf16 v23, v75, v217, v23
    s_waitcnt vmcnt(8)
    v_dot2_f32_bf16 v16, v76, v216, v16
    v_dot2_f32_bf16 v17, v76, v217, v17
    v_dot2_f32_bf16 v18, v77, v216, v18
    v_dot2_f32_bf16 v19, v77, v217, v19
    v_dot2_f32_bf16 v20, v78, v216, v20
    v_dot2_f32_bf16 v21, v78, v217, v21
    v_dot2_f32_bf16 v22, v79, v216, v22
    v_dot2_f32_bf16 v23, v79, v217, v23
    s_waitcnt vmcnt(7)
    v_dot2_f32_bf16 v16, v80, v216, v16
    v_dot2_f32_bf16 v17, v80, v217, v17
    v_dot2_f32_bf16 v18, v81, v216, v18
    v_dot2_f32_bf16 v19, v81, v217, v19
    v_dot2_f32_bf16 v20, v82, v216, v20
    v_dot2_f32_bf16 v21, v82, v217, v21
    v_dot2_f32_bf16 v22, v83, v216, v22
    v_dot2_f32_bf16 v23, v83, v217, v23
    s_waitcnt vmcnt(6)
    v_dot2_f32_bf16 v16, v84, v216, v16
    v_dot2_f32_bf16 v17, v84, v217, v17
    v_dot2_f32_bf16 v18, v85, v216, v18
    v_dot2_f32_bf16 v19, v85, v217, v19
    v_dot2_f32_bf16 v20, v86, v216, v20
    v_dot2_f32_bf16 v21, v86, v217, v21
    v_dot2_f32_bf16 v22, v87, v216, v22
    v_dot2_f32_bf16 v23, v87, v217, v23
    s_waitcnt vmcnt(5)
    v_dot2_f32_bf16 v16, v88, v216, v16
    v_dot2_f32_bf16 v17, v88, v217, v17
    v_dot2_f32_bf16 v18, v89, v216, v18
    v_dot2_f32_bf16 v19, v89, v217, v19
    v_dot2_f32_bf16 v20, v90, v216, v20
    v_dot2_f32_bf16 v21, v90, v217, v21
    v_dot2_f32_bf16 v22, v91, v216, v22
    v_dot2_f32_bf16 v23, v91, v217, v23
    s_waitcnt vmcnt(4)
    v_dot2_f32_bf16 v16, v92, v216, v16
    v_dot2_f32_bf16 v17, v92, v217, v17
    v_dot2_f32_bf16 v18, v93, v216, v18
    v_dot2_f32_bf16 v19, v93, v217, v19
    v_dot2_f32_bf16 v20, v94, v216, v20
    v_dot2_f32_bf16 v21, v94, v217, v21
    v_dot2_f32_bf16 v22, v95, v216, v22
    v_dot2_f32_bf16 v23, v95, v217, v23
    s_nop 2
    v_cvt_pk_bf16_f32 v128, v16, v17
    v_cvt_pk_bf16_f32 v129, v18, v19
    v_cvt_pk_bf16_f32 v130, v20, v21
    v_cvt_pk_bf16_f32 v131, v22, v23
    ds_write_b128 v10, v[128:131]
    s_waitcnt lgkmcnt(0)
    s_barrier
    ds_read_b128 v[144:147], v15 offset:0
    ds_read_b128 v[128:131], v11 offset:0
    ds_read_b128 v[132:135], v11 offset:1024
    ds_read_b128 v[148:151], v15 offset:64
    ds_read_b128 v[136:139], v11 offset:2048
    ds_read_b128 v[140:143], v11 offset:3072
    s_waitcnt lgkmcnt(3)
    v_mfma_f32_16x16x32_bf16 v[64:67], v[144:147], v[112:115], 0
    v_mfma_f32_16x16x32_bf16 v[68:71], v[144:147], v[116:119], 0
    v_mfma_f32_16x16x32_bf16 v[32:35], v[128:131], v[112:115], 0
    v_mfma_f32_16x16x32_bf16 v[36:39], v[132:135], v[112:115], 0
    v_mfma_f32_16x16x32_bf16 v[40:43], v[128:131], v[116:119], 0
    v_mfma_f32_16x16x32_bf16 v[44:47], v[132:135], v[116:119], 0
    s_waitcnt lgkmcnt(0)
    v_mfma_f32_16x16x32_bf16 v[72:75], v[148:151], v[120:123], 0
    v_mfma_f32_16x16x32_bf16 v[76:79], v[148:151], v[124:127], 0
    v_mfma_f32_16x16x32_bf16 v[48:51], v[136:139], v[120:123], 0
    v_mfma_f32_16x16x32_bf16 v[52:55], v[140:143], v[120:123], 0
    v_mfma_f32_16x16x32_bf16 v[56:59], v[136:139], v[124:127], 0
    v_mfma_f32_16x16x32_bf16 v[60:63], v[140:143], v[124:127], 0
    s_nop 1
    v_add_f32 v64, s47, v64
    v_add_f32 v68, s47, v68
    v_add_f32 v72, s47, v72
    v_add_f32 v76, s47, v76
    v_rcp_f32 v64, v64
    v_rcp_f32 v68, v68
    v_rcp_f32 v72, v72
    v_rcp_f32 v76, v76
    s_nop 0
    v_pk_mul_f32 v[32:33], v[32:33], v[64:65] op_sel_hi:[1,0]
    v_pk_mul_f32 v[34:35], v[34:35], v[64:65] op_sel_hi:[1,0]
    v_pk_mul_f32 v[36:37], v[36:37], v[64:65] op_sel_hi:[1,0]
    v_pk_mul_f32 v[38:39], v[38:39], v[64:65] op_sel_hi:[1,0]
    v_cvt_pk_bf16_f32 v16, v32, v33
    v_cvt_pk_bf16_f32 v17, v34, v35
    v_cvt_pk_bf16_f32 v18, v36, v37
    v_cvt_pk_bf16_f32 v19, v38, v39
    buffer_store_dwordx4 v[16:19], v9, s[20:23], 0 offen offset:0 sc1
    v_pk_mul_f32 v[40:41], v[40:41], v[68:69] op_sel_hi:[1,0]
    v_pk_mul_f32 v[42:43], v[42:43], v[68:69] op_sel_hi:[1,0]
    v_pk_mul_f32 v[44:45], v[44:45], v[68:69] op_sel_hi:[1,0]
    v_pk_mul_f32 v[46:47], v[46:47], v[68:69] op_sel_hi:[1,0]
    v_cvt_pk_bf16_f32 v20, v40, v41
    v_cvt_pk_bf16_f32 v21, v42, v43
    v_cvt_pk_bf16_f32 v22, v44, v45
    v_cvt_pk_bf16_f32 v23, v46, v47
    buffer_store_dwordx4 v[20:23], v9, s[20:23], 0 offen offset:1024 sc1
    v_pk_mul_f32 v[48:49], v[48:49], v[72:73] op_sel_hi:[1,0]
    v_pk_mul_f32 v[50:51], v[50:51], v[72:73] op_sel_hi:[1,0]
    v_pk_mul_f32 v[52:53], v[52:53], v[72:73] op_sel_hi:[1,0]
    v_pk_mul_f32 v[54:55], v[54:55], v[72:73] op_sel_hi:[1,0]
    v_cvt_pk_bf16_f32 v24, v48, v49
    v_cvt_pk_bf16_f32 v25, v50, v51
    v_cvt_pk_bf16_f32 v26, v52, v53
    v_cvt_pk_bf16_f32 v27, v54, v55
    buffer_store_dwordx4 v[24:27], v9, s[20:23], 0 offen offset:2048 sc1
    v_pk_mul_f32 v[56:57], v[56:57], v[76:77] op_sel_hi:[1,0]
    v_pk_mul_f32 v[58:59], v[58:59], v[76:77] op_sel_hi:[1,0]
    v_pk_mul_f32 v[60:61], v[60:61], v[76:77] op_sel_hi:[1,0]
    v_pk_mul_f32 v[62:63], v[62:63], v[76:77] op_sel_hi:[1,0]
    v_cvt_pk_bf16_f32 v28, v56, v57
    v_cvt_pk_bf16_f32 v29, v58, v59
    v_cvt_pk_bf16_f32 v30, v60, v61
    v_cvt_pk_bf16_f32 v31, v62, v63
    buffer_store_dwordx4 v[28:31], v9, s[20:23], 0 offen offset:3072 sc1
pq_out:
    s_lshl_b32 s99, s98, 6
    s_add_u32 s99, s99, s33
    s_add_u32 s99, s99, 16
    s_mul_i32 s99, s99, 256
    s_branch po
pq_idle:
    s_load_dwordx2 s[4:5], s[0:1], 64
    s_lshl_b32 s31, s33, 4
    s_cmp_eq_u32 s98, 0
    s_cselect_b32 s100, s31, s100
    s_cselect_b32 s101, 16, s101
    s_cselect_b32 s26, 256, s82
    s_mov_b32 s27, 0x00020000
    s_waitcnt lgkmcnt(0)
    s_cselect_b32 s24, s4, s80
    s_cselect_b32 s25, s5, s81
    s_load_dwordx2 s[4:5], s[0:1], 16
    s_and_b32 s18, s2, 7
    s_lshr_b32 s19, s2, 3
    s_lshr_b32 s16, s18, 1
    s_lshl_b32 s16, s16, 2
    s_lshr_b32 s17, s19, 3
    s_add_u32 s16, s16, s17
    s_and_b32 s17, s18, 1
    s_and_b32 s19, s19, 7
    s_lshl_b32 s19, s19, 1
    s_add_u32 s17, s17, s19
    v_and_b32 v146, 63, v0
    v_lshrrev_b32 v147, 3, v146
    v_mul_u32_u24 v140, 2048, v147
    v_and_b32 v148, 7, v146
    v_and_b32 v147, 6, v147
    v_xor_b32 v148, v148, v147
    v_lshl_add_u32 v140, v148, 4, v140
    s_and_b32 s19, s3, 3
    s_lshl_b32 s92, s19, 10
    s_add_u32 s92, s92, 131072
    s_mul_i32 s18, s19, 16384
    s_lshl_b32 s19, s17, 7
    s_add_u32 s18, s18, s19
    v_add_u32 v140, s18, v140
    v_add_u32 v141, 65536, v140
    s_lshr_b32 s96, s17, 1
    s_add_u32 s96, s96, s16
    s_and_b32 s96, s96, 3
    s_mov_b32 s94, 0
    s_mov_b32 s95, 0
    s_waitcnt lgkmcnt(0)
    s_mov_b32 s88, s4
    s_mov_b32 s89, s5
    s_mov_b32 s90, 2097152
    s_mov_b32 s91, 0x00020000
    s_load_dwordx4 s[84:87], s[0:1], 32
    s_and_b32 s18, s2, 7
    s_lshr_b32 s19, s2, 3
    s_and_b32 s16, s18, 1
    s_lshl_b32 s16, s16, 2
    s_lshr_b32 s17, s19, 3
    s_add_u32 s16, s16, s17
    s_lshr_b32 s17, s18, 1
    s_lshl_b32 s17, s17, 3
    s_and_b32 s19, s19, 7
    s_add_u32 s17, s17, s19
    v_and_b32 v154, 63, v0
    s_and_b32 s20, s3, 3
    s_lshl_b32 s20, s20, 8
    s_mul_i32 s21, s17, 224
    s_and_b32 s22, s17, 1
    s_lshl_b32 s22, s22, 1
    s_movk_i32 s23, 4682
    v_add_u32 v155, s20, v154
    v_mul_u32_u24 v156, s23, v155
    v_lshrrev_b32 v156, 16, v156
    v_mul_u32_u24 v157, 14, v156
    v_sub_u32 v157, v155, v157
    v_add_u32 v157, s22, v157
    v_subrev_u32 v155, 14, v157
    v_min_u32 v157, v157, v155
    v_mul_u32_u24 v150, 7168, v156
    v_lshl_add_u32 v150, v157, 4, v150
    v_add_u32 v150, s21, v150
    v_add_u32 v155, s20, v154
    v_add_u32 v155, 64, v155
    v_mul_u32_u24 v156, s23, v155
    v_lshrrev_b32 v156, 16, v156
    v_mul_u32_u24 v157, 14, v156
    v_sub_u32 v157, v155, v157
    v_add_u32 v157, s22, v157
    v_subrev_u32 v155, 14, v157
    v_min_u32 v157, v157, v155
    v_mul_u32_u24 v151, 7168, v156
    v_lshl_add_u32 v151, v157, 4, v151
    v_add_u32 v151, s21, v151
    v_add_u32 v155, s20, v154
    v_add_u32 v155, 128, v155
    v_mul_u32_u24 v156, s23, v155
    v_lshrrev_b32 v156, 16, v156
    v_mul_u32_u24 v157, 14, v156
    v_sub_u32 v157, v155, v157
    v_add_u32 v157, s22, v157
    v_subrev_u32 v155, 14, v157
    v_min_u32 v157, v157, v155
    v_mul_u32_u24 v152, 7168, v156
    v_lshl_add_u32 v152, v157, 4, v152
    v_add_u32 v152, s21, v152
    v_lshrrev_b32 v156, 6, v156
    v_lshl_add_u32 v152, v156, 28, v152
    v_add_u32 v155, s20, v154
    v_add_u32 v155, 192, v155
    v_mul_u32_u24 v156, s23, v155
    v_lshrrev_b32 v156, 16, v156
    v_mul_u32_u24 v157, 14, v156
    v_sub_u32 v157, v155, v157
    v_add_u32 v157, s22, v157
    v_subrev_u32 v155, 14, v157
    v_min_u32 v157, v157, v155
    v_mul_u32_u24 v153, 7168, v156
    v_lshl_add_u32 v153, v157, 4, v153
    v_add_u32 v153, s21, v153
    v_lshrrev_b32 v156, 6, v156
    v_lshl_add_u32 v153, v156, 28, v153
    s_waitcnt lgkmcnt(0)
    s_movk_i32 s15, 0x200
    s_mov_b32 s13, 0
    s_mov_b32 s44, s28
    s_mov_b32 s45, s29
    s_mov_b32 s46, 0
    s_mov_b32 s47, 0x00020000
    v_and_b32 v3, 63, v0
    v_lshlrev_b32 v4, 2, v3
    s_lshl_b32 s20, s3, 9
    s_add_u32 s20, s20, 155648
    v_mov_b32 v8, v3
    v_lshlrev_b32 v9, 4, v3
    v_and_b32 v3, 7, v8
    v_lshlrev_b32 v3, 4, v3
    v_lshrrev_b32 v5, 4, v8
    v_lshl_add_u32 v3, v5, 2, v3
    v_add_u32 v3, s20, v3
    s_cmp_lg_u32 s98, 0
    s_cbranch_scc1 pq_e1
    s_load_dwordx4 s[4:7], s[0:1], 32
    s_load_dwordx2 s[12:13], s[0:1], 16
    s_lshl_b32 s20, s2, 2
    s_add_u32 s20, s20, s3
    s_sub_u32 s20, s20, 4
    s_lshr_b32 s48, s20, 3
    s_and_b32 s49, s20, 7
    s_sub_u32 s30, s48, 56
    s_min_u32 s30, s30, s48
    s_lshl_b32 s30, s30, 7
    s_mul_i32 s21, s49, 917504
    s_add_u32 s30, s30, s21
    s_sub_u32 s21, s20, 896
    s_lshl_b32 s21, s21, 14
    s_cmp_lt_u32 s48, 56
    s_waitcnt lgkmcnt(0)
    s_cselect_b32 s44, s4, s6
    s_cselect_b32 s45, s5, s7
    s_mov_b32 s47, 0x00020000
    s_mov_b32 s46, 7340032
    s_movk_i32 s22, 7168
    s_cmp_ge_u32 s2, 224
    s_cselect_b32 s44, s12, s44
    s_cselect_b32 s45, s13, s45
    s_cselect_b32 s46, 2097152, s46
    s_cselect_b32 s30, s21, s30
    s_cselect_b32 s22, 128, s22
    s_lshl_b32 s14, s22, 3
    v_and_b32 v20, 63, v0
    v_lshrrev_b32 v21, 3, v20
    v_mul_lo_u32 v21, s22, v21
    v_and_b32 v22, 7, v20
    v_lshl_add_u32 v21, v22, 4, v21
    s_lshr_b32 s20, s2, 3
    s_and_b32 s21, s2, 7
    s_lshl_b32 s21, s21, 1
    s_add_u32 s20, s20, s21
    s_mul_i32 s21, s20, 6554
    s_lshr_b32 s21, s21, 16
    s_mul_i32 s21, s21, 10
    s_sub_u32 s15, s20, s21
    s_add_u32 s15, s15, 4
    s_lshl_b32 s48, s48, 11
    s_lshl_b32 s49, s49, 2
    s_add_u32 s48, s48, s49
    v_cmp_eq_u32 vcc, 0, v22
    v_mov_b32 v5, 0x3f80
    s_nop 0
    v_cndmask_b32 v56, 0, v5, vcc
    v_cmp_eq_u32 vcc, 1, v22
    v_mov_b32 v5, 0x3f800000
    s_nop 0
    v_cndmask_b32 v56, v56, v5, vcc
    v_cmp_eq_u32 vcc, 2, v22
    v_mov_b32 v5, 0x3f80
    s_nop 0
    v_cndmask_b32 v57, 0, v5, vcc
    v_cmp_eq_u32 vcc, 3, v22
    v_mov_b32 v5, 0x3f800000
    s_nop 0
    v_cndmask_b32 v57, v57, v5, vcc
    v_cmp_eq_u32 vcc, 4, v22
    v_mov_b32 v5, 0x3f80
    s_nop 0
    v_cndmask_b32 v58, 0, v5, vcc
    v_cmp_eq_u32 vcc, 5, v22
    v_mov_b32 v5, 0x3f800000
    s_nop 0
    v_cndmask_b32 v58, v58, v5, vcc
    v_cmp_eq_u32 vcc, 6, v22
    v_mov_b32 v5, 0x3f80
    s_nop 0
    v_cndmask_b32 v59, 0, v5, vcc
    v_cmp_eq_u32 vcc, 7, v22
    v_mov_b32 v5, 0x3f800000
    s_nop 0
    v_cndmask_b32 v59, v59, v5, vcc
    v_lshlrev_b32 v22, 3, v22
    v_bfe_u32 v6, v20, 4, 1
    v_lshl_add_u32 v22, v6, 2, v22
    v_lshrrev_b32 v6, 5, v20
    v_lshl_add_u32 v22, v6, 1, v22
    v_bfe_u32 v6, v20, 3, 1
    v_add_lshl_u32 v22, v22, v6, 5
    s_and_b32 s13, s15, 3
    s_add_u32 s13, s13, 5
pq_e1:
    s_waitcnt vmcnt(0)
    s_barrier
    s_cmp_lg_u32 s3, 4
    s_cbranch_scc1 pq_i1
    s_cmp_eq_u32 s98, 0
    s_cbranch_scc1 pq_i1
    s_mov_b64 exec, 1
    v_mov_b32 v1, 0
    v_mov_b32 v2, 1
    buffer_atomic_add v2, v1, s[80:83], s99 offen sc1
    s_mov_b64 exec, -1
pq_i1:
    s_cmp_lg_u32 s3, 4
    s_cbranch_scc1 pq_i2
    s_waitcnt vmcnt(0)
    s_cmp_lg_u32 s98, 0
    s_cbranch_scc1 pq_i9
    s_mov_b64 exec, 1
    v_mov_b32 v1, 0
    s_mov_b32 s50, 0x40000
    s_branch pq0_pgo
pq0_poll:
pq0_pgo:
    buffer_load_dword v2, v1, s[24:27], s100 offen sc1
    s_sub_u32 s50, s50, 1
    s_cbranch_scc1 pq0_pdone
    s_waitcnt vmcnt(0)
    v_readfirstlane_b32 s51, v2
    s_cmp_lt_u32 s51, s101
    s_cbranch_scc1 pq0_poll
pq0_pdone:
    s_mov_b64 exec, -1
    s_branch pq_i2
pq_i9:
    s_mov_b64 exec, 1
    v_mov_b32 v1, 0
    s_mov_b32 s50, 0x40000
    s_branch pq_pgo
pq_poll:
pq_pgo:
    v_mov_b32 v2, 0
    buffer_atomic_add v2, v1, s[24:27], s100 offen sc0 sc1
    s_sub_u32 s50, s50, 1
    s_cbranch_scc1 pq_pdone
    s_waitcnt vmcnt(0)
    v_readfirstlane_b32 s51, v2
    s_cmp_lt_u32 s51, s101
    s_cbranch_scc1 pq_poll
pq_pdone:
    s_mov_b64 exec, -1
pq_i2:
    s_barrier
    s_cmp_lg_u32 s98, 0
    s_cbranch_scc1 pq_e2
    v_mfma_f32_16x16x32_bf16 v[32:35], v[56:59], v[160:163], 0
    v_mfma_f32_16x16x32_bf16 v[32:35], v[56:59], v[164:167], v[32:35]
    v_mfma_f32_16x16x32_bf16 v[32:35], v[56:59], v[168:171], v[32:35]
    v_mfma_f32_16x16x32_bf16 v[32:35], v[56:59], v[172:175], v[32:35]
    v_mfma_f32_16x16x32_bf16 v[32:35], v[56:59], v[176:179], v[32:35]
    v_mfma_f32_16x16x32_bf16 v[32:35], v[56:59], v[180:183], v[32:35]
    v_mfma_f32_16x16x32_bf16 v[32:35], v[56:59], v[184:187], v[32:35]
    v_mfma_f32_16x16x32_bf16 v[32:35], v[56:59], v[188:191], v[32:35]
    v_and_b32 v36, 8, v20
    v_cmp_ne_u32 vcc, 0, v36
    v_cmp_lt_u32 s[20:21], 31, v20
    s_nop 5
    v_add_f32_dpp v32, v32, v32 row_ror:8 row_mask:0xf bank_mask:0xf
    v_add_f32_dpp v33, v33, v33 row_ror:8 row_mask:0xf bank_mask:0xf
    v_add_f32_dpp v34, v34, v34 row_ror:8 row_mask:0xf bank_mask:0xf
    v_add_f32_dpp v35, v35, v35 row_ror:8 row_mask:0xf bank_mask:0xf
    v_cndmask_b32 v32, v32, v33, vcc
    v_cndmask_b32 v34, v34, v35, vcc
    v_cndmask_b32 v32, v32, v34, s[20:21]
pq_e2:
    s_movk_i32 s12, 0x100
    s_cmp_lg_u32 s98, 0
    s_cbranch_scc1 pq_h0
    v_lshrrev_b32 v5, 3, v22
    s_add_u32 s16, s28, 33357824
    s_addc_u32 s17, s29, 0
    s_mov_b32 s18, 196608
    s_mov_b32 s19, 0x00020000
    s_lshl_b32 s20, s2, 2
    s_add_u32 s20, s20, s3
    s_sub_u32 s20, s20, 4
    s_lshl_b32 s20, s20, 8
    buffer_store_dword v32, v5, s[16:19], s20 offen sc1
pq_h0:
    s_lshl_b32 s20, s33, 2
    s_add_u32 s20, s20, s3
    s_sub_u32 s20, s20, 4
    s_lshl_b32 s20, s20, 12
    s_add_u32 s20, s20, 32505856
    s_add_u32 s20, s28, s20
    s_addc_u32 s21, s29, 0
    s_mov_b32 s22, 4096
    s_mov_b32 s23, 0x00020000
    s_waitcnt vmcnt(6)
    s_cmp_le_u32 s39, 16
    s_cbranch_scc1 st4
    s_waitcnt vmcnt(0)
st4:
    s_barrier
    s_cmp_ge_u32 s39, 16
    s_cbranch_scc1 ld5
    s_and_b32 s31, s39, 3
    s_cmp_eq_u32 s31, s35
    s_cselect_b32 s31, 3, -1
    s_add_u32 s41, s39, s31
    s_add_u32 s31, s41, 16
    s_min_u32 s41, s41, s31
    s_sub_u32 s31, s41, 16
    s_min_u32 s41, s41, s31
    s_mul_i32 s41, s41, 393216
    s_add_u32 s31, s40, s38
    s_add_u32 m0, s31, 0
    s_nop 0
    buffer_load_dwordx4 v130, s[8:11], s41 offen lds
    s_add_u32 m0, s31, 4096
    s_nop 0
    buffer_load_dwordx4 v131, s[8:11], s41 offen lds
    s_add_u32 m0, s31, 8192
    s_nop 0
    buffer_load_dwordx4 v132, s[8:11], s41 offen lds
    s_add_u32 m0, s31, 12288
    s_nop 0
    buffer_load_dwordx4 v133, s[8:11], s41 offen lds
    s_add_u32 m0, s31, 16384
    s_nop 0
    buffer_load_dwordx4 v134, s[8:11], s41 offen lds
    s_add_u32 m0, s31, 20480
    s_nop 0
    buffer_load_dwordx4 v135, s[8:11], s41 offen lds
    s_add_u32 s38, s38, 24576
    s_cmp_eq_u32 s38, 98304
    s_cselect_b32 s38, 0, s38
ld5:
    s_add_u32 s39, s39, 1
    s_cmp_lg_u32 s39, s13
    s_cbranch_scc1 cu6g
    s_cmp_lg_u32 s3, 5
    s_cbranch_scc1 cu6g
    s_cmp_ge_u32 s2, 193
    s_cbranch_scc1 cu6g
    s_mov_b64 exec, 1
    v_mov_b32 v1, 0
    v_mov_b32 v2, 1
    buffer_atomic_add v2, v1, s[24:27], s99 offen sc1
    s_mov_b64 exec, -1
cu6g:
    s_add_u32 s31, s15, 0
    s_cmp_lg_u32 s39, s31
    s_cbranch_scc1 cu6b0
    s_mov_b32 s12, s39
    buffer_load_dwordx4 v[64:67], v21, s[44:47], s30 offen
    s_add_u32 s30, s30, s14
    buffer_load_dwordx4 v[68:71], v21, s[44:47], s30 offen
    s_add_u32 s30, s30, s14
    buffer_load_dwordx4 v[72:75], v21, s[44:47], s30 offen
    s_add_u32 s30, s30, s14
    buffer_load_dwordx4 v[76:79], v21, s[44:47], s30 offen
    s_add_u32 s30, s30, s14
    buffer_load_dwordx4 v[80:83], v21, s[44:47], s30 offen
    s_add_u32 s30, s30, s14
    buffer_load_dwordx4 v[84:87], v21, s[44:47], s30 offen
    s_add_u32 s30, s30, s14
    buffer_load_dwordx4 v[88:91], v21, s[44:47], s30 offen
    s_add_u32 s30, s30, s14
    buffer_load_dwordx4 v[92:95], v21, s[44:47], s30 offen
    s_add_u32 s30, s30, s14
    buffer_load_dwordx4 v[96:99], v21, s[44:47], s30 offen
    s_add_u32 s30, s30, s14
    buffer_load_dwordx4 v[100:103], v21, s[44:47], s30 offen
    s_add_u32 s30, s30, s14
    buffer_load_dwordx4 v[104:107], v21, s[44:47], s30 offen
    s_add_u32 s30, s30, s14
    buffer_load_dwordx4 v[108:111], v21, s[44:47], s30 offen
    s_add_u32 s30, s30, s14
    buffer_load_dwordx4 v[112:115], v21, s[44:47], s30 offen
    s_add_u32 s30, s30, s14
    buffer_load_dwordx4 v[116:119], v21, s[44:47], s30 offen
    s_add_u32 s30, s30, s14
    buffer_load_dwordx4 v[120:123], v21, s[44:47], s30 offen
    s_add_u32 s30, s30, s14
    buffer_load_dwordx4 v[124:127], v21, s[44:47], s30 offen
    s_add_u32 s30, s30, s14
cu6b0:
    s_cmp_lg_u32 s98, 0
    s_cbranch_scc1 pq_h7
    s_waitcnt vmcnt(0)
pq_h7:
    s_waitcnt vmcnt(6)
    s_cmp_le_u32 s39, 16
    s_cbranch_scc1 st7
    s_waitcnt vmcnt(0)
st7:
    s_barrier
    s_cmp_ge_u32 s39, 16
    s_cbranch_scc1 ld8
    s_and_b32 s31, s39, 3
    s_cmp_eq_u32 s31, s35
    s_cselect_b32 s31, 3, -1
    s_add_u32 s41, s39, s31
    s_add_u32 s31, s41, 16
    s_min_u32 s41, s41, s31
    s_sub_u32 s31, s41, 16
    s_min_u32 s41, s41, s31
    s_mul_i32 s41, s41, 393216
    s_add_u32 s31, s40, s38
    s_add_u32 m0, s31, 0
    s_nop 0
    buffer_load_dwordx4 v130, s[8:11], s41 offen lds
    s_add_u32 m0, s31, 4096
    s_nop 0
    buffer_load_dwordx4 v131, s[8:11], s41 offen lds
    s_add_u32 m0, s31, 8192
    s_nop 0
    buffer_load_dwordx4 v132, s[8:11], s41 offen lds
    s_add_u32 m0, s31, 12288
    s_nop 0
    buffer_load_dwordx4 v133, s[8:11], s41 offen lds
    s_add_u32 m0, s31, 16384
    s_nop 0
    buffer_load_dwordx4 v134, s[8:11], s41 offen lds
    s_add_u32 m0, s31, 20480
    s_nop 0
    buffer_load_dwordx4 v135, s[8:11], s41 offen lds
    s_add_u32 s38, s38, 24576
    s_cmp_eq_u32 s38, 98304
    s_cselect_b32 s38, 0, s38
ld8:
    s_add_u32 s39, s39, 1
    s_cmp_lg_u32 s39, s13
    s_cbranch_scc1 cu9g
    s_cmp_lg_u32 s3, 5
    s_cbranch_scc1 cu9g
    s_cmp_ge_u32 s2, 193
    s_cbranch_scc1 cu9g
    s_mov_b64 exec, 1
    v_mov_b32 v1, 0
    v_mov_b32 v2, 1
    buffer_atomic_add v2, v1, s[24:27], s99 offen sc1
    s_mov_b64 exec, -1
cu9g:
    s_add_u32 s31, s15, 0
    s_cmp_lg_u32 s39, s31
    s_cbranch_scc1 cu9b0
    s_mov_b32 s12, s39
    buffer_load_dwordx4 v[64:67], v21, s[44:47], s30 offen
    s_add_u32 s30, s30, s14
    buffer_load_dwordx4 v[68:71], v21, s[44:47], s30 offen
    s_add_u32 s30, s30, s14
    buffer_load_dwordx4 v[72:75], v21, s[44:47], s30 offen
    s_add_u32 s30, s30, s14
    buffer_load_dwordx4 v[76:79], v21, s[44:47], s30 offen
    s_add_u32 s30, s30, s14
    buffer_load_dwordx4 v[80:83], v21, s[44:47], s30 offen
    s_add_u32 s30, s30, s14
    buffer_load_dwordx4 v[84:87], v21, s[44:47], s30 offen
    s_add_u32 s30, s30, s14
    buffer_load_dwordx4 v[88:91], v21, s[44:47], s30 offen
    s_add_u32 s30, s30, s14
    buffer_load_dwordx4 v[92:95], v21, s[44:47], s30 offen
    s_add_u32 s30, s30, s14
    buffer_load_dwordx4 v[96:99], v21, s[44:47], s30 offen
    s_add_u32 s30, s30, s14
    buffer_load_dwordx4 v[100:103], v21, s[44:47], s30 offen
    s_add_u32 s30, s30, s14
    buffer_load_dwordx4 v[104:107], v21, s[44:47], s30 offen
    s_add_u32 s30, s30, s14
    buffer_load_dwordx4 v[108:111], v21, s[44:47], s30 offen
    s_add_u32 s30, s30, s14
    buffer_load_dwordx4 v[112:115], v21, s[44:47], s30 offen
    s_add_u32 s30, s30, s14
    buffer_load_dwordx4 v[116:119], v21, s[44:47], s30 offen
    s_add_u32 s30, s30, s14
    buffer_load_dwordx4 v[120:123], v21, s[44:47], s30 offen
    s_add_u32 s30, s30, s14
    buffer_load_dwordx4 v[124:127], v21, s[44:47], s30 offen
    s_add_u32 s30, s30, s14
cu9b0:
    buffer_load_dwordx4 v[32:35], v9, s[20:23], 0 offen offset:0 sc1
    buffer_load_dwordx4 v[36:39], v9, s[20:23], 0 offen offset:1024 sc1
    buffer_load_dwordx4 v[40:43], v9, s[20:23], 0 offen offset:2048 sc1
    buffer_load_dwordx4 v[44:47], v9, s[20:23], 0 offen offset:3072 sc1
    s_mov_b32 s43, 9
pq_i3:
    s_waitcnt vmcnt(6)
    s_cmp_le_u32 s39, 16
    s_cbranch_scc1 st10
    s_waitcnt vmcnt(0)
st10:
    s_barrier
    s_cmp_ge_u32 s39, 16
    s_cbranch_scc1 ld11
    s_and_b32 s31, s39, 3
    s_cmp_eq_u32 s31, s35
    s_cselect_b32 s31, 3, -1
    s_add_u32 s41, s39, s31
    s_add_u32 s31, s41, 16
    s_min_u32 s41, s41, s31
    s_sub_u32 s31, s41, 16
    s_min_u32 s41, s41, s31
    s_mul_i32 s41, s41, 393216
    s_add_u32 s31, s40, s38
    s_add_u32 m0, s31, 0
    s_nop 0
    buffer_load_dwordx4 v130, s[8:11], s41 offen lds
    s_add_u32 m0, s31, 4096
    s_nop 0
    buffer_load_dwordx4 v131, s[8:11], s41 offen lds
    s_add_u32 m0, s31, 8192
    s_nop 0
    buffer_load_dwordx4 v132, s[8:11], s41 offen lds
    s_add_u32 m0, s31, 12288
    s_nop 0
    buffer_load_dwordx4 v133, s[8:11], s41 offen lds
    s_add_u32 m0, s31, 16384
    s_nop 0
    buffer_load_dwordx4 v134, s[8:11], s41 offen lds
    s_add_u32 m0, s31, 20480
    s_nop 0
    buffer_load_dwordx4 v135, s[8:11], s41 offen lds
    s_add_u32 s38, s38, 24576
    s_cmp_eq_u32 s38, 98304
    s_cselect_b32 s38, 0, s38
ld11:
    s_add_u32 s39, s39, 1
    s_cmp_lg_u32 s39, s13
    s_cbranch_scc1 cu12g
    s_cmp_lg_u32 s3, 5
    s_cbranch_scc1 cu12g
    s_cmp_ge_u32 s2, 193
    s_cbranch_scc1 cu12g
    s_mov_b64 exec, 1
    v_mov_b32 v1, 0
    v_mov_b32 v2, 1
    buffer_atomic_add v2, v1, s[24:27], s99 offen sc1
    s_mov_b64 exec, -1
cu12g:
    s_add_u32 s31, s15, 0
    s_cmp_lg_u32 s39, s31
    s_cbranch_scc1 cu12b0
    s_mov_b32 s12, s39
    buffer_load_dwordx4 v[64:67], v21, s[44:47], s30 offen
    s_add_u32 s30, s30, s14
    buffer_load_dwordx4 v[68:71], v21, s[44:47], s30 offen
    s_add_u32 s30, s30, s14
    buffer_load_dwordx4 v[72:75], v21, s[44:47], s30 offen
    s_add_u32 s30, s30, s14
    buffer_load_dwordx4 v[76:79], v21, s[44:47], s30 offen
    s_add_u32 s30, s30, s14
    buffer_load_dwordx4 v[80:83], v21, s[44:47], s30 offen
    s_add_u32 s30, s30, s14
    buffer_load_dwordx4 v[84:87], v21, s[44:47], s30 offen
    s_add_u32 s30, s30, s14
    buffer_load_dwordx4 v[88:91], v21, s[44:47], s30 offen
    s_add_u32 s30, s30, s14
    buffer_load_dwordx4 v[92:95], v21, s[44:47], s30 offen
    s_add_u32 s30, s30, s14
    buffer_load_dwordx4 v[96:99], v21, s[44:47], s30 offen
    s_add_u32 s30, s30, s14
    buffer_load_dwordx4 v[100:103], v21, s[44:47], s30 offen
    s_add_u32 s30, s30, s14
    buffer_load_dwordx4 v[104:107], v21, s[44:47], s30 offen
    s_add_u32 s30, s30, s14
    buffer_load_dwordx4 v[108:111], v21, s[44:47], s30 offen
    s_add_u32 s30, s30, s14
    buffer_load_dwordx4 v[112:115], v21, s[44:47], s30 offen
    s_add_u32 s30, s30, s14
    buffer_load_dwordx4 v[116:119], v21, s[44:47], s30 offen
    s_add_u32 s30, s30, s14
    buffer_load_dwordx4 v[120:123], v21, s[44:47], s30 offen
    s_add_u32 s30, s30, s14
    buffer_load_dwordx4 v[124:127], v21, s[44:47], s30 offen
    s_add_u32 s30, s30, s14
cu12b0:
    s_sub_u32 s43, s43, 1
    s_cmp_lg_u32 s43, 0
    s_cbranch_scc1 pq_i3
pq_i3x:
    v_pk_add_f32 v[32:33], v[32:33], v[40:41]
    v_pk_add_f32 v[34:35], v[34:35], v[42:43]
    v_pk_add_f32 v[36:37], v[36:37], v[44:45]
    v_pk_add_f32 v[38:39], v[38:39], v[46:47]
    v_pk_add_f32 v[32:33], v[32:33], v[36:37]
    v_pk_add_f32 v[34:35], v[34:35], v[38:39]
    v_and_b32 v5, 8, v8
    v_cmp_ne_u32 vcc, 0, v5
    v_permlane32_swap_b32 v32, v34
    v_permlane32_swap_b32 v33, v35
    s_nop 0
    v_pk_add_f32 v[32:33], v[32:33], v[34:35]
    s_nop 1
    v_permlane16_swap_b32 v32, v33
    s_nop 1
    v_add_f32 v32, v32, v33
    s_nop 1
    v_mov_b32_dpp v33, v32 row_ror:8 row_mask:0xf bank_mask:0xf
    v_cndmask_b32 v34, v32, v33, vcc
    v_cndmask_b32 v5, v33, v32, vcc
    v_mul_f32 v6, 0xba800000, v34
    v_mul_f32 v5, 0x3a800000, v5
    v_fma_f32 v5, -v6, v6, v5
    v_max_f32 v5, 0, v5
    v_add_f32 v5, 0x3727c5ac, v5
    v_rsq_f32 v7, v5
    s_nop 0
    v_mul_f32 v5, 0x3fb8aa3b, v7
    ds_write_b32 v3, v6
    ds_write_b32 v3, v7 offset:128
    ds_write_b32 v3, v5 offset:256
    s_waitcnt lgkmcnt(0)
    s_waitcnt vmcnt(6)
    s_cmp_le_u32 s39, 16
    s_cbranch_scc1 st13
    s_waitcnt vmcnt(0)
st13:
    s_barrier
    s_cmp_ge_u32 s39, 16
    s_cbranch_scc1 ld14
    s_and_b32 s31, s39, 3
    s_cmp_eq_u32 s31, s35
    s_cselect_b32 s31, 3, -1
    s_add_u32 s41, s39, s31
    s_add_u32 s31, s41, 16
    s_min_u32 s41, s41, s31
    s_sub_u32 s31, s41, 16
    s_min_u32 s41, s41, s31
    s_mul_i32 s41, s41, 393216
    s_add_u32 s31, s40, s38
    s_add_u32 m0, s31, 0
    s_nop 0
    buffer_load_dwordx4 v130, s[8:11], s41 offen lds
    s_add_u32 m0, s31, 4096
    s_nop 0
    buffer_load_dwordx4 v131, s[8:11], s41 offen lds
    s_add_u32 m0, s31, 8192
    s_nop 0
    buffer_load_dwordx4 v132, s[8:11], s41 offen lds
    s_add_u32 m0, s31, 12288
    s_nop 0
    buffer_load_dwordx4 v133, s[8:11], s41 offen lds
    s_add_u32 m0, s31, 16384
    s_nop 0
    buffer_load_dwordx4 v134, s[8:11], s41 offen lds
    s_add_u32 m0, s31, 20480
    s_nop 0
    buffer_load_dwordx4 v135, s[8:11], s41 offen lds
    s_add_u32 s38, s38, 24576
    s_cmp_eq_u32 s38, 98304
    s_cselect_b32 s38, 0, s38
ld14:
    s_add_u32 s39, s39, 1
    s_cmp_lg_u32 s98, 0
    s_cbranch_scc1 pq_h2
    v_mfma_f32_16x16x32_bf16 v[32:35], v[56:59], v[64:67], 0
    v_mfma_f32_16x16x32_bf16 v[32:35], v[56:59], v[68:71], v[32:35]
    v_mfma_f32_16x16x32_bf16 v[32:35], v[56:59], v[72:75], v[32:35]
    v_mfma_f32_16x16x32_bf16 v[32:35], v[56:59], v[76:79], v[32:35]
    v_mfma_f32_16x16x32_bf16 v[32:35], v[56:59], v[80:83], v[32:35]
    v_mfma_f32_16x16x32_bf16 v[32:35], v[56:59], v[84:87], v[32:35]
    v_mfma_f32_16x16x32_bf16 v[32:35], v[56:59], v[88:91], v[32:35]
    v_mfma_f32_16x16x32_bf16 v[32:35], v[56:59], v[92:95], v[32:35]
    v_mfma_f32_16x16x32_bf16 v[32:35], v[56:59], v[96:99], v[32:35]
    v_mfma_f32_16x16x32_bf16 v[32:35], v[56:59], v[100:103], v[32:35]
    v_mfma_f32_16x16x32_bf16 v[32:35], v[56:59], v[104:107], v[32:35]
    v_mfma_f32_16x16x32_bf16 v[32:35], v[56:59], v[108:111], v[32:35]
    v_mfma_f32_16x16x32_bf16 v[32:35], v[56:59], v[112:115], v[32:35]
    v_mfma_f32_16x16x32_bf16 v[32:35], v[56:59], v[116:119], v[32:35]
    v_mfma_f32_16x16x32_bf16 v[32:35], v[56:59], v[120:123], v[32:35]
    v_mfma_f32_16x16x32_bf16 v[32:35], v[56:59], v[124:127], v[32:35]
    v_and_b32 v36, 8, v20
    v_cmp_ne_u32 vcc, 0, v36
    v_cmp_lt_u32 s[20:21], 31, v20
    s_nop 5
    v_add_f32_dpp v32, v32, v32 row_ror:8 row_mask:0xf bank_mask:0xf
    v_add_f32_dpp v33, v33, v33 row_ror:8 row_mask:0xf bank_mask:0xf
    v_add_f32_dpp v34, v34, v34 row_ror:8 row_mask:0xf bank_mask:0xf
    v_add_f32_dpp v35, v35, v35 row_ror:8 row_mask:0xf bank_mask:0xf
    v_cndmask_b32 v32, v32, v33, vcc
    v_cndmask_b32 v34, v34, v35, vcc
    v_cndmask_b32 v32, v32, v34, s[20:21]
    v_mov_b32 v28, v32
pq_h2:
    s_waitcnt vmcnt(6)
    s_cmp_le_u32 s39, 16
    s_cbranch_scc1 st15
    s_waitcnt vmcnt(0)
st15:
    s_barrier
    s_cmp_ge_u32 s39, 16
    s_cbranch_scc1 ld16
    s_and_b32 s31, s39, 3
    s_cmp_eq_u32 s31, s35
    s_cselect_b32 s31, 3, -1
    s_add_u32 s41, s39, s31
    s_add_u32 s31, s41, 16
    s_min_u32 s41, s41, s31
    s_sub_u32 s31, s41, 16
    s_min_u32 s41, s41, s31
    s_mul_i32 s41, s41, 393216
    s_add_u32 s31, s40, s38
    s_add_u32 m0, s31, 0
    s_nop 0
    buffer_load_dwordx4 v130, s[8:11], s41 offen lds
    s_add_u32 m0, s31, 4096
    s_nop 0
    buffer_load_dwordx4 v131, s[8:11], s41 offen lds
    s_add_u32 m0, s31, 8192
    s_nop 0
    buffer_load_dwordx4 v132, s[8:11], s41 offen lds
    s_add_u32 m0, s31, 12288
    s_nop 0
    buffer_load_dwordx4 v133, s[8:11], s41 offen lds
    s_add_u32 m0, s31, 16384
    s_nop 0
    buffer_load_dwordx4 v134, s[8:11], s41 offen lds
    s_add_u32 m0, s31, 20480
    s_nop 0
    buffer_load_dwordx4 v135, s[8:11], s41 offen lds
    s_add_u32 s38, s38, 24576
    s_cmp_eq_u32 s38, 98304
    s_cselect_b32 s38, 0, s38
ld16:
    s_add_u32 s39, s39, 1
    s_cmp_lg_u32 s3, 4
    s_cbranch_scc1 pq_h3
    s_cmp_lg_u32 s98, 0
    s_cbranch_scc1 pq_h3
    s_movk_i32 s100, 8
    s_movk_i32 s101, 193
    s_mov_b64 exec, 1
    v_mov_b32 v30, 0
    s_mov_b32 s50, 0x40000
    s_branch pqg_pgo
pqg_poll:
pqg_pgo:
    buffer_load_dword v31, v30, s[24:27], s100 offen sc1
    s_sub_u32 s50, s50, 1
    s_cbranch_scc1 pqg_pdone
    s_waitcnt vmcnt(0)
    v_readfirstlane_b32 s51, v31
    s_cmp_lt_u32 s51, s101
    s_cbranch_scc1 pqg_poll
pqg_pdone:
    s_mov_b64 exec, -1
    s_lshl_b32 s20, s34, 12
    s_add_u32 s20, s20, 33357824
    s_add_u32 s44, s28, s20
    s_addc_u32 s45, s29, 0
    s_mov_b32 s46, 135168
    s_mov_b32 s47, 0x00020000
    s_mov_b32 s21, 65536
    s_mov_b32 s22, 131072
    v_lshlrev_b32 v29, 2, v4
    buffer_load_dwordx4 v[32:35], v29, s[44:47], 0 offen offset:0 sc1
    buffer_load_dwordx4 v[36:39], v29, s[44:47], 0 offen offset:1024 sc1
    buffer_load_dwordx4 v[40:43], v29, s[44:47], 0 offen offset:2048 sc1
    buffer_load_dwordx4 v[44:47], v29, s[44:47], 0 offen offset:3072 sc1
    buffer_load_dwordx4 v[48:51], v29, s[44:47], s21 offen offset:0 sc1
    buffer_load_dwordx4 v[52:55], v29, s[44:47], s21 offen offset:1024 sc1
    buffer_load_dwordx4 v[56:59], v29, s[44:47], s21 offen offset:2048 sc1
    buffer_load_dwordx4 v[60:63], v29, s[44:47], s21 offen offset:3072 sc1
    buffer_load_dwordx4 v[64:67], v29, s[44:47], s22 offen offset:0 sc1
    buffer_load_dwordx4 v[68:71], v29, s[44:47], s22 offen offset:1024 sc1
    buffer_load_dwordx4 v[72:75], v29, s[44:47], s22 offen offset:2048 sc1
    buffer_load_dwordx4 v[76:79], v29, s[44:47], s22 offen offset:3072 sc1
pq_h3:
    s_waitcnt vmcnt(6)
    s_cmp_le_u32 s39, 16
    s_cbranch_scc1 st17
    s_waitcnt vmcnt(0)
st17:
    s_barrier
    s_cmp_ge_u32 s39, 16
    s_cbranch_scc1 ld18
    s_and_b32 s31, s39, 3
    s_cmp_eq_u32 s31, s35
    s_cselect_b32 s31, 3, -1
    s_add_u32 s41, s39, s31
    s_add_u32 s31, s41, 16
    s_min_u32 s41, s41, s31
    s_sub_u32 s31, s41, 16
    s_min_u32 s41, s41, s31
    s_mul_i32 s41, s41, 393216
    s_add_u32 s31, s40, s38
    s_add_u32 m0, s31, 0
    s_nop 0
    buffer_load_dwordx4 v130, s[8:11], s41 offen lds
    s_add_u32 m0, s31, 4096
    s_nop 0
    buffer_load_dwordx4 v131, s[8:11], s41 offen lds
    s_add_u32 m0, s31, 8192
    s_nop 0
    buffer_load_dwordx4 v132, s[8:11], s41 offen lds
    s_add_u32 m0, s31, 12288
    s_nop 0
    buffer_load_dwordx4 v133, s[8:11], s41 offen lds
    s_add_u32 m0, s31, 16384
    s_nop 0
    buffer_load_dwordx4 v134, s[8:11], s41 offen lds
    s_add_u32 m0, s31, 20480
    s_nop 0
    buffer_load_dwordx4 v135, s[8:11], s41 offen lds
    s_add_u32 s38, s38, 24576
    s_cmp_eq_u32 s38, 98304
    s_cselect_b32 s38, 0, s38
ld18:
    s_add_u32 s39, s39, 1
    s_and_b32 s18, s94, 3
    s_cmp_eq_u32 s18, s96
    s_cselect_b32 s18, 3, -1
    s_add_u32 s93, s94, s18
    s_add_u32 s18, s93, 16
    s_min_u32 s93, s93, s18
    s_sub_u32 s18, s93, 16
    s_min_u32 s93, s93, s18
    s_mul_i32 s93, s93, 131072
    s_add_u32 s18, s92, s95
    s_add_u32 m0, s18, 0
    s_nop 0
    buffer_load_dwordx4 v140, s[88:91], s93 offen lds
    s_add_u32 m0, s18, 4096
    s_nop 0
    buffer_load_dwordx4 v141, s[88:91], s93 offen lds
    s_add_u32 s95, s95, 8192
    s_cmp_eq_u32 s95, 32768
    s_cselect_b32 s95, 0, s95
    s_add_u32 s94, s94, 1
    s_and_b32 s18, s94, 3
    s_cmp_eq_u32 s18, s96
    s_cselect_b32 s18, 3, -1
    s_add_u32 s93, s94, s18
    s_add_u32 s18, s93, 16
    s_min_u32 s93, s93, s18
    s_sub_u32 s18, s93, 16
    s_min_u32 s93, s93, s18
    s_mul_i32 s93, s93, 131072
    s_add_u32 s18, s92, s95
    s_add_u32 m0, s18, 0
    s_nop 0
    buffer_load_dwordx4 v140, s[88:91], s93 offen lds
    s_add_u32 m0, s18, 4096
    s_nop 0
    buffer_load_dwordx4 v141, s[88:91], s93 offen lds
    s_add_u32 s95, s95, 8192
    s_cmp_eq_u32 s95, 32768
    s_cselect_b32 s95, 0, s95
    s_add_u32 s94, s94, 1
    s_and_b32 s18, s94, 3
    s_cmp_eq_u32 s18, s96
    s_cselect_b32 s18, 3, -1
    s_add_u32 s93, s94, s18
    s_add_u32 s18, s93, 16
    s_min_u32 s93, s93, s18
    s_sub_u32 s18, s93, 16
    s_min_u32 s93, s93, s18
    s_mul_i32 s93, s93, 131072
    s_add_u32 s18, s92, s95
    s_add_u32 m0, s18, 0
    s_nop 0
    buffer_load_dwordx4 v140, s[88:91], s93 offen lds
    s_add_u32 m0, s18, 4096
    s_nop 0
    buffer_load_dwordx4 v141, s[88:91], s93 offen lds
    s_add_u32 s95, s95, 8192
    s_cmp_eq_u32 s95, 32768
    s_cselect_b32 s95, 0, s95
    s_add_u32 s94, s94, 1
    s_waitcnt vmcnt(6)
    s_barrier
    s_cmp_lg_u32 s98, 0
    s_cbranch_scc1 pq_h8
    s_add_u32 s44, s28, 33095680
    s_addc_u32 s45, s29, 0
    s_mov_b32 s46, 229376
    s_mov_b32 s47, 0x00020000
    buffer_store_dword v28, v22, s[44:47], s48 offen sc1
pq_h8:
    s_mov_b32 s8, s84
    s_mov_b32 s9, s85
    s_mov_b32 s10, 7340032
    s_mov_b32 s11, 0x00020000
    s_and_b32 s40, s3, 3
    s_lshl_b32 s40, s40, 12
    s_mov_b32 s41, 0xfff90000
    s_add_u32 s41, s41, 458752
    s_add_u32 m0, s40, 0
    s_nop 0
    buffer_load_dwordx4 v150, s[8:11], s41 offen lds
    s_add_u32 m0, s40, 1024
    s_nop 0
    buffer_load_dwordx4 v151, s[8:11], s41 offen lds
    s_add_u32 m0, s40, 2048
    s_nop 0
    buffer_load_dwordx4 v152, s[8:11], s41 offen lds
    s_add_u32 m0, s40, 3072
    s_nop 0
    buffer_load_dwordx4 v153, s[8:11], s41 offen lds
    s_mov_b32 s8, s86
    s_mov_b32 s9, s87
    s_mov_b32 s10, 7340032
    s_mov_b32 s11, 0x00020000
    s_and_b32 s40, s3, 3
    s_lshl_b32 s40, s40, 12
    s_add_u32 s40, s40, 16384
    s_mov_b32 s41, 0xfff90000
    s_add_u32 s41, s41, 458752
    s_add_u32 m0, s40, 0
    s_nop 0
    buffer_load_dwordx4 v150, s[8:11], s41 offen lds
    s_add_u32 m0, s40, 1024
    s_nop 0
    buffer_load_dwordx4 v151, s[8:11], s41 offen lds
    s_add_u32 m0, s40, 2048
    s_nop 0
    buffer_load_dwordx4 v152, s[8:11], s41 offen lds
    s_add_u32 m0, s40, 3072
    s_nop 0
    buffer_load_dwordx4 v153, s[8:11], s41 offen lds
    s_cmp_lg_u32 s3, 4
    s_cbranch_scc1 pq_h5
    s_cmp_lg_u32 s98, 0
    s_cbranch_scc1 pq_h6
    v_pk_add_f32 v[32:33], v[32:33], v[40:41]
    v_pk_add_f32 v[34:35], v[34:35], v[42:43]
    v_pk_add_f32 v[36:37], v[36:37], v[44:45]
    v_pk_add_f32 v[38:39], v[38:39], v[46:47]
    v_pk_add_f32 v[48:49], v[48:49], v[56:57]
    v_pk_add_f32 v[50:51], v[50:51], v[58:59]
    v_pk_add_f32 v[52:53], v[52:53], v[60:61]
    v_pk_add_f32 v[54:55], v[54:55], v[62:63]
    v_pk_add_f32 v[64:65], v[64:65], v[72:73]
    v_pk_add_f32 v[66:67], v[66:67], v[74:75]
    v_pk_add_f32 v[68:69], v[68:69], v[76:77]
    v_pk_add_f32 v[70:71], v[70:71], v[78:79]
    v_pk_add_f32 v[32:33], v[32:33], v[36:37]
    v_pk_add_f32 v[34:35], v[34:35], v[38:39]
    v_pk_add_f32 v[48:49], v[48:49], v[52:53]
    v_pk_add_f32 v[50:51], v[50:51], v[54:55]
    v_pk_add_f32 v[64:65], v[64:65], v[68:69]
    v_pk_add_f32 v[66:67], v[66:67], v[70:71]
    s_nop 0
    v_permlane32_swap_b32 v32, v34
    v_permlane32_swap_b32 v33, v35
    v_permlane32_swap_b32 v48, v50
    v_permlane32_swap_b32 v49, v51
    v_permlane32_swap_b32 v64, v66
    v_permlane32_swap_b32 v65, v67
    s_nop 0
    v_pk_add_f32 v[32:33], v[32:33], v[34:35]
    v_pk_add_f32 v[48:49], v[48:49], v[50:51]
    v_pk_add_f32 v[64:65], v[64:65], v[66:67]
    s_nop 1
    v_permlane16_swap_b32 v32, v33
    v_permlane16_swap_b32 v48, v49
    v_permlane16_swap_b32 v64, v65
    s_nop 1
    v_add_f32 v250, v32, v33
    v_add_f32 v251, v48, v49
    v_add_f32 v252, v64, v65
pq_h6:
    v_and_b32 v29, 60, v4
    v_lshlrev_b32 v29, 2, v29
    v_lshrrev_b32 v30, 6, v4
    v_lshl_add_u32 v29, v30, 2, v29
    v_add_u32 v29, 159744, v29
    ds_write_b32 v29, v250 offset:0
    ds_write_b32 v29, v251 offset:256
    ds_write_b32 v29, v252 offset:512
    s_waitcnt lgkmcnt(0)
pq_h5:
    s_barrier
    s_mov_b32 s8, s84
    s_mov_b32 s9, s85
    s_mov_b32 s10, 7340032
    s_mov_b32 s11, 0x00020000
    s_and_b32 s40, s3, 3
    s_lshl_b32 s40, s40, 12
    s_mov_b32 s41, 0x0
    s_add_u32 s41, s41, 458752
    s_add_u32 m0, s40, 32768
    s_nop 0
    buffer_load_dwordx4 v150, s[8:11], s41 offen lds
    s_add_u32 m0, s40, 33792
    s_nop 0
    buffer_load_dwordx4 v151, s[8:11], s41 offen lds
    s_add_u32 m0, s40, 34816
    s_nop 0
    buffer_load_dwordx4 v152, s[8:11], s41 offen lds
    s_add_u32 m0, s40, 35840
    s_nop 0
    buffer_load_dwordx4 v153, s[8:11], s41 offen lds
    s_mov_b32 s8, s86
    s_mov_b32 s9, s87
    s_mov_b32 s10, 7340032
    s_mov_b32 s11, 0x00020000
    s_and_b32 s40, s3, 3
    s_lshl_b32 s40, s40, 12
    s_add_u32 s40, s40, 16384
    s_mov_b32 s41, 0x0
    s_add_u32 s41, s41, 458752
    s_add_u32 m0, s40, 32768
    s_nop 0
    buffer_load_dwordx4 v150, s[8:11], s41 offen lds
    s_add_u32 m0, s40, 33792
    s_nop 0
    buffer_load_dwordx4 v151, s[8:11], s41 offen lds
    s_add_u32 m0, s40, 34816
    s_nop 0
    buffer_load_dwordx4 v152, s[8:11], s41 offen lds
    s_add_u32 m0, s40, 35840
    s_nop 0
    buffer_load_dwordx4 v153, s[8:11], s41 offen lds
    s_add_u32 s44, s28, 4194304
    s_addc_u32 s45, s29, 0
    s_mov_b32 s46, 4194304
    s_mov_b32 s47, 0x00020000
    s_lshl_b32 s48, s2, 2
    s_add_u32 s48, s48, s3
    s_sub_u32 s48, s48, 4
    s_lshl_b32 s48, s48, 12
    v_and_b32 v20, 63, v0
    v_lshlrev_b32 v20, 4, v20
    v_mov_b32 v24, -1
    v_mov_b32 v25, -1
    v_mov_b32 v26, -1
    v_mov_b32 v27, -1
    s_barrier
    buffer_store_dwordx4 v[24:27], v20, s[44:47], s48 offen offset:0 sc1
    buffer_store_dwordx4 v[24:27], v20, s[44:47], s48 offen offset:1024 sc1
    buffer_store_dwordx4 v[24:27], v20, s[44:47], s48 offen offset:2048 sc1
    buffer_store_dwordx4 v[24:27], v20, s[44:47], s48 offen offset:3072 sc1
    s_lshl_b32 s99, s98, 6
    s_add_u32 s99, s99, s34
    s_add_u32 s99, s99, 0
    s_mul_i32 s99, s99, 256
    s_lshl_b32 s100, s98, 6
    s_add_u32 s100, s100, s34
    s_add_u32 s100, s100, 0
    s_mov_b32 s101, 16
    s_mul_i32 s100, s100, 256
pqb_idle:
    s_mul_i32 s39, s98, 5242880
    s_lshl_b32 s38, s34, 12
    s_add_u32 s38, s38, s39
    s_add_u32 s38, s38, 30408704
    s_add_u32 s16, s28, s38
    s_addc_u32 s17, s29, 0
    s_mov_b32 s18, 4096
    s_mov_b32 s19, 0x00020000
    v_and_b32 v4, 63, v0
    v_lshlrev_b32 v5, 2, v4
    v_and_b32 v6, 3, v4
    v_lshlrev_b32 v6, 1, v6
    v_bfe_u32 v7, v4, 2, 2
    v_lshl_add_u32 v6, v7, 4, v6
    v_bfe_u32 v7, v4, 4, 1
    v_lshl_add_u32 v6, v7, 3, v6
    v_lshrrev_b32 v7, 5, v4
    v_lshl_add_u32 v6, v7, 6, v6
    v_add_u32 v6, 156672, v6
    s_waitcnt vmcnt(0)
    s_barrier
    s_cmp_lg_u32 s3, 4
    s_cbranch_scc1 pqb_i1
    s_mov_b64 exec, 1
    v_mov_b32 v1, 0
    v_mov_b32 v2, 1
    buffer_atomic_add v2, v1, s[80:83], s99 offen sc1
    s_mov_b64 exec, -1
pqb_i1:
    s_cmp_lg_u32 s3, 4
    s_cbranch_scc1 pqb_i2
    s_waitcnt vmcnt(0)
    s_mov_b64 exec, 1
    v_mov_b32 v1, 0
    s_mov_b32 s50, 0x40000
    s_branch pqb_pgo
pqb_poll:
pqb_pgo:
    v_mov_b32 v3, 0
    buffer_atomic_add v3, v1, s[80:83], s100 offen sc0 sc1
    s_sub_u32 s50, s50, 1
    s_cbranch_scc1 pqb_pdone
    s_waitcnt vmcnt(0)
    v_readfirstlane_b32 s51, v3
    s_cmp_lt_u32 s51, s101
    s_cbranch_scc1 pqb_poll
pqb_pdone:
    s_mov_b64 exec, -1
pqb_i2:
    s_barrier
    s_cmp_lg_u32 s3, 5
    s_cbranch_scc1 pq_nz
    buffer_load_dword v8, v5, s[16:19], 0 offen offset:0 sc1
    buffer_load_dword v9, v5, s[16:19], 0 offen offset:256 sc1
    buffer_load_dword v10, v5, s[16:19], 0 offen offset:512 sc1
    buffer_load_dword v11, v5, s[16:19], 0 offen offset:768 sc1
    buffer_load_dword v12, v5, s[16:19], 0 offen offset:1024 sc1
    buffer_load_dword v13, v5, s[16:19], 0 offen offset:1280 sc1
    buffer_load_dword v14, v5, s[16:19], 0 offen offset:1536 sc1
    buffer_load_dword v15, v5, s[16:19], 0 offen offset:1792 sc1
    buffer_load_dword v16, v5, s[16:19], 0 offen offset:2048 sc1
    buffer_load_dword v17, v5, s[16:19], 0 offen offset:2304 sc1
    buffer_load_dword v18, v5, s[16:19], 0 offen offset:2560 sc1
    buffer_load_dword v19, v5, s[16:19], 0 offen offset:2816 sc1
    buffer_load_dword v20, v5, s[16:19], 0 offen offset:3072 sc1
    buffer_load_dword v21, v5, s[16:19], 0 offen offset:3328 sc1
    buffer_load_dword v22, v5, s[16:19], 0 offen offset:3584 sc1
    buffer_load_dword v23, v5, s[16:19], 0 offen offset:3840 sc1
    s_waitcnt vmcnt(0)
    v_add_f32 v8, v8, v16
    v_add_f32 v9, v9, v17
    v_add_f32 v10, v10, v18
    v_add_f32 v11, v11, v19
    v_add_f32 v12, v12, v20
    v_add_f32 v13, v13, v21
    v_add_f32 v14, v14, v22
    v_add_f32 v15, v15, v23
    v_add_f32 v8, v8, v12
    v_add_f32 v9, v9, v13
    v_add_f32 v10, v10, v14
    v_add_f32 v11, v11, v15
    v_add_f32 v8, v8, v10
    v_add_f32 v9, v9, v11
    v_add_f32 v8, v8, v9
    v_cvt_pk_bf16_f32 v8, v8, v8
    ds_write_b16 v6, v8
    s_waitcnt lgkmcnt(0)
pq_nz:
    s_barrier
    s_branch pq_out
po:
    s_and_b32 s31, s2, 7
    s_lshr_b32 s32, s2, 3
    s_lshr_b32 s33, s31, 1
    s_lshl_b32 s33, s33, 2
    s_lshr_b32 s34, s32, 3
    s_add_u32 s33, s33, s34
    s_and_b32 s34, s31, 1
    s_and_b32 s32, s32, 7
    s_lshl_b32 s32, s32, 1
    s_add_u32 s34, s34, s32
    s_lshr_b32 s45, s33, 1
    s_lshl_b32 s100, s98, 6
    s_add_u32 s100, s100, s33
    s_add_u32 s100, s100, 16
    s_mov_b32 s101, 16
    s_mul_i32 s100, s100, 256
    s_cmp_ge_u32 s3, 4
    s_cbranch_scc1 po_idle
    v_and_b32 v9, 63, v0
    v_lshlrev_b32 v9, 4, v9
    s_lshl_b32 s35, s33, 2
    s_add_u32 s35, s35, s3
    s_lshl_b32 s37, s35, 16
    s_lshl_b32 s38, s34, 12
    s_add_u32 s37, s37, s38
    s_add_u32 s37, s37, 8388608
    s_add_u32 s20, s28, s37
    s_addc_u32 s21, s29, 0
    s_mov_b32 s22, 4096
    s_mov_b32 s23, 0x00020000
    v_and_b32 v10, 63, v0
    v_lshrrev_b32 v11, 3, v10
    v_mul_u32_u24 v1, 2048, v11
    v_and_b32 v12, 7, v10
    v_and_b32 v11, 6, v11
    v_xor_b32 v12, v12, v11
    v_lshl_add_u32 v1, v12, 4, v1
    v_and_b32 v11, 3, v10
    v_lshlrev_b32 v5, 3, v11
    v_lshrrev_b32 v11, 2, v10
    v_lshl_add_u32 v5, v11, 7, v5
    v_bfe_u32 v11, v10, 3, 2
    v_lshl_add_u32 v5, v11, 5, v5
    v_xor_b32 v6, 32, v5
    v_xor_b32 v7, 64, v5
    v_xor_b32 v8, 96, v5
    s_lshr_b32 s36, s34, 1
    s_add_u32 s36, s36, s33
    s_and_b32 s36, s36, 3
    s_mov_b32 s96, 0
    s_cmp_eq_u32 s36, 0
    s_cselect_b32 s92, 3, -1
    s_cmp_eq_u32 s36, 1
    s_cselect_b32 s93, 3, -1
    s_cmp_eq_u32 s36, 2
    s_cselect_b32 s94, 3, -1
    s_cmp_eq_u32 s36, 3
    s_cselect_b32 s95, 3, -1
    s_add_u32 s84, s96, s92
    s_add_u32 s97, s84, 16
    s_min_u32 s84, s84, s97
    s_sub_u32 s97, s84, 16
    s_min_u32 s84, s84, s97
    s_cmp_ge_u32 s96, 16
    s_cselect_b32 s84, 16, s84
    s_add_u32 s96, s96, 1
    s_add_u32 s85, s96, s93
    s_add_u32 s97, s85, 16
    s_min_u32 s85, s85, s97
    s_sub_u32 s97, s85, 16
    s_min_u32 s85, s85, s97
    s_cmp_ge_u32 s96, 16
    s_cselect_b32 s85, 16, s85
    s_add_u32 s96, s96, 1
    v_add_u32 v5, 131072, v5
    v_add_u32 v6, 131072, v6
    v_add_u32 v7, 131072, v7
    v_add_u32 v8, 131072, v8
    s_mul_i32 s36, s35, 229376
    s_add_u32 s36, s36, 12582912
    s_add_u32 s12, s28, s36
    s_addc_u32 s13, s29, 0
    s_mov_b32 s14, 65536
    s_mov_b32 s15, 0x00020000
    s_waitcnt lgkmcnt(0)
    s_waitcnt vmcnt(0)
    s_barrier
    ds_read_b64_tr_b16 v[80:81], v5 offset:0
    ds_read_b64_tr_b16 v[82:83], v5 offset:2048
    ds_read_b64_tr_b16 v[84:85], v6 offset:0
    ds_read_b64_tr_b16 v[86:87], v6 offset:2048
    ds_read_b64_tr_b16 v[88:89], v7 offset:0
    ds_read_b64_tr_b16 v[90:91], v7 offset:2048
    ds_read_b64_tr_b16 v[92:93], v8 offset:0
    ds_read_b64_tr_b16 v[94:95], v8 offset:2048
    v_lshlrev_b32 v16, 16, v228
    v_and_b32 v17, 0xffff0000, v228
    v_lshlrev_b32 v18, 16, v229
    v_and_b32 v19, 0xffff0000, v229
    v_lshlrev_b32 v20, 16, v230
    v_and_b32 v21, 0xffff0000, v230
    v_lshlrev_b32 v22, 16, v231
    v_and_b32 v23, 0xffff0000, v231
    v_lshlrev_b32 v24, 16, v232
    v_and_b32 v25, 0xffff0000, v232
    v_lshlrev_b32 v26, 16, v233
    v_and_b32 v27, 0xffff0000, v233
    v_lshlrev_b32 v28, 16, v234
    v_and_b32 v29, 0xffff0000, v234
    v_lshlrev_b32 v30, 16, v235
    v_and_b32 v31, 0xffff0000, v235
    v_lshlrev_b32 v32, 16, v236
    v_and_b32 v33, 0xffff0000, v236
    v_lshlrev_b32 v34, 16, v237
    v_and_b32 v35, 0xffff0000, v237
    v_lshlrev_b32 v36, 16, v238
    v_and_b32 v37, 0xffff0000, v238
    v_lshlrev_b32 v38, 16, v239
    v_and_b32 v39, 0xffff0000, v239
    v_lshlrev_b32 v40, 16, v240
    v_and_b32 v41, 0xffff0000, v240
    v_lshlrev_b32 v42, 16, v241
    v_and_b32 v43, 0xffff0000, v241
    v_lshlrev_b32 v44, 16, v242
    v_and_b32 v45, 0xffff0000, v242
    v_lshlrev_b32 v46, 16, v243
    v_and_b32 v47, 0xffff0000, v243
    s_barrier
    s_mul_i32 s42, s84, 4096
    buffer_load_dwordx4 v[112:115], v9, s[12:15], s42 offen sc1
    buffer_load_dwordx4 v[116:119], v9, s[12:15], s42 offen offset:1024 sc1
    buffer_load_dwordx4 v[120:123], v9, s[12:15], s42 offen offset:2048 sc1
    buffer_load_dwordx4 v[124:127], v9, s[12:15], s42 offen offset:3072 sc1
    s_mul_i32 s42, s85, 4096
    buffer_load_dwordx4 v[128:131], v9, s[12:15], s42 offen sc1
    buffer_load_dwordx4 v[132:135], v9, s[12:15], s42 offen offset:1024 sc1
    buffer_load_dwordx4 v[136:139], v9, s[12:15], s42 offen offset:2048 sc1
    buffer_load_dwordx4 v[140:143], v9, s[12:15], s42 offen offset:3072 sc1
    s_mov_b32 s43, 4
    .p2align 6
po_loop:
    s_waitcnt vmcnt(7) lgkmcnt(4)
    v_mfma_f32_16x16x32_bf16 v[16:19], v[80:83], v[112:115], v[16:19]
    s_add_u32 s86, s96, s94
    s_add_u32 s97, s86, 16
    ds_read_b64_tr_b16 v[96:97], v5 offset:4096
    s_waitcnt vmcnt(6)
    v_mfma_f32_16x16x32_bf16 v[24:27], v[80:83], v[116:119], v[24:27]
    s_min_u32 s86, s86, s97
    s_sub_u32 s97, s86, 16
    ds_read_b64_tr_b16 v[98:99], v5 offset:6144
    v_mfma_f32_16x16x32_bf16 v[20:23], v[84:87], v[112:115], v[20:23]
    s_min_u32 s86, s86, s97
    s_cmp_ge_u32 s96, 16
    s_cselect_b32 s86, 16, s86
    ds_read_b64_tr_b16 v[100:101], v6 offset:4096
    v_mfma_f32_16x16x32_bf16 v[28:31], v[84:87], v[116:119], v[28:31]
    s_add_u32 s96, s96, 1
    s_mul_i32 s42, s86, 4096
    ds_read_b64_tr_b16 v[102:103], v6 offset:6144
    s_waitcnt lgkmcnt(4)
    v_mfma_f32_16x16x32_bf16 v[32:35], v[88:91], v[112:115], v[32:35]
    ds_read_b64_tr_b16 v[104:105], v7 offset:4096
    v_mfma_f32_16x16x32_bf16 v[40:43], v[88:91], v[116:119], v[40:43]
    ds_read_b64_tr_b16 v[106:107], v7 offset:6144
    v_mfma_f32_16x16x32_bf16 v[36:39], v[92:95], v[112:115], v[36:39]
    ds_read_b64_tr_b16 v[108:109], v8 offset:4096
    buffer_load_dwordx4 v[112:115], v9, s[12:15], s42 offen sc1
    v_mfma_f32_16x16x32_bf16 v[44:47], v[92:95], v[116:119], v[44:47]
    ds_read_b64_tr_b16 v[110:111], v8 offset:6144
    buffer_load_dwordx4 v[116:119], v9, s[12:15], s42 offen offset:1024 sc1
    s_waitcnt vmcnt(7) lgkmcnt(4)
    v_mfma_f32_16x16x32_bf16 v[16:19], v[96:99], v[120:123], v[16:19]
    s_barrier
    ds_read_b64_tr_b16 v[80:81], v5 offset:8192
    s_waitcnt vmcnt(6)
    v_mfma_f32_16x16x32_bf16 v[24:27], v[96:99], v[124:127], v[24:27]
    ds_read_b64_tr_b16 v[82:83], v5 offset:10240
    v_mfma_f32_16x16x32_bf16 v[20:23], v[100:103], v[120:123], v[20:23]
    ds_read_b64_tr_b16 v[84:85], v6 offset:8192
    v_mfma_f32_16x16x32_bf16 v[28:31], v[100:103], v[124:127], v[28:31]
    ds_read_b64_tr_b16 v[86:87], v6 offset:10240
    s_waitcnt lgkmcnt(4)
    v_mfma_f32_16x16x32_bf16 v[32:35], v[104:107], v[120:123], v[32:35]
    ds_read_b64_tr_b16 v[88:89], v7 offset:8192
    v_mfma_f32_16x16x32_bf16 v[40:43], v[104:107], v[124:127], v[40:43]
    ds_read_b64_tr_b16 v[90:91], v7 offset:10240
    v_mfma_f32_16x16x32_bf16 v[36:39], v[108:111], v[120:123], v[36:39]
    ds_read_b64_tr_b16 v[92:93], v8 offset:8192
    buffer_load_dwordx4 v[120:123], v9, s[12:15], s42 offen offset:2048 sc1
    v_mfma_f32_16x16x32_bf16 v[44:47], v[108:111], v[124:127], v[44:47]
    ds_read_b64_tr_b16 v[94:95], v8 offset:10240
    buffer_load_dwordx4 v[124:127], v9, s[12:15], s42 offen offset:3072 sc1
    s_waitcnt vmcnt(7) lgkmcnt(4)
    v_mfma_f32_16x16x32_bf16 v[16:19], v[80:83], v[128:131], v[16:19]
    s_add_u32 s87, s96, s95
    s_add_u32 s97, s87, 16
    ds_read_b64_tr_b16 v[96:97], v5 offset:12288
    s_waitcnt vmcnt(6)
    v_mfma_f32_16x16x32_bf16 v[24:27], v[80:83], v[132:135], v[24:27]
    s_min_u32 s87, s87, s97
    s_sub_u32 s97, s87, 16
    ds_read_b64_tr_b16 v[98:99], v5 offset:14336
    v_mfma_f32_16x16x32_bf16 v[20:23], v[84:87], v[128:131], v[20:23]
    s_min_u32 s87, s87, s97
    s_cmp_ge_u32 s96, 16
    s_cselect_b32 s87, 16, s87
    ds_read_b64_tr_b16 v[100:101], v6 offset:12288
    v_mfma_f32_16x16x32_bf16 v[28:31], v[84:87], v[132:135], v[28:31]
    s_add_u32 s96, s96, 1
    s_mul_i32 s42, s87, 4096
    ds_read_b64_tr_b16 v[102:103], v6 offset:14336
    s_waitcnt lgkmcnt(4)
    v_mfma_f32_16x16x32_bf16 v[32:35], v[88:91], v[128:131], v[32:35]
    ds_read_b64_tr_b16 v[104:105], v7 offset:12288
    v_mfma_f32_16x16x32_bf16 v[40:43], v[88:91], v[132:135], v[40:43]
    ds_read_b64_tr_b16 v[106:107], v7 offset:14336
    v_mfma_f32_16x16x32_bf16 v[36:39], v[92:95], v[128:131], v[36:39]
    ds_read_b64_tr_b16 v[108:109], v8 offset:12288
    buffer_load_dwordx4 v[128:131], v9, s[12:15], s42 offen sc1
    v_mfma_f32_16x16x32_bf16 v[44:47], v[92:95], v[132:135], v[44:47]
    ds_read_b64_tr_b16 v[110:111], v8 offset:14336
    buffer_load_dwordx4 v[132:135], v9, s[12:15], s42 offen offset:1024 sc1
    s_waitcnt vmcnt(7) lgkmcnt(4)
    v_mfma_f32_16x16x32_bf16 v[16:19], v[96:99], v[136:139], v[16:19]
    s_barrier
    ds_read_b64_tr_b16 v[80:81], v5 offset:16384
    s_waitcnt vmcnt(6)
    v_mfma_f32_16x16x32_bf16 v[24:27], v[96:99], v[140:143], v[24:27]
    ds_read_b64_tr_b16 v[82:83], v5 offset:18432
    v_mfma_f32_16x16x32_bf16 v[20:23], v[100:103], v[136:139], v[20:23]
    ds_read_b64_tr_b16 v[84:85], v6 offset:16384
    v_mfma_f32_16x16x32_bf16 v[28:31], v[100:103], v[140:143], v[28:31]
    ds_read_b64_tr_b16 v[86:87], v6 offset:18432
    s_waitcnt lgkmcnt(4)
    v_mfma_f32_16x16x32_bf16 v[32:35], v[104:107], v[136:139], v[32:35]
    ds_read_b64_tr_b16 v[88:89], v7 offset:16384
    v_mfma_f32_16x16x32_bf16 v[40:43], v[104:107], v[140:143], v[40:43]
    ds_read_b64_tr_b16 v[90:91], v7 offset:18432
    v_mfma_f32_16x16x32_bf16 v[36:39], v[108:111], v[136:139], v[36:39]
    ds_read_b64_tr_b16 v[92:93], v8 offset:16384
    buffer_load_dwordx4 v[136:139], v9, s[12:15], s42 offen offset:2048 sc1
    v_mfma_f32_16x16x32_bf16 v[44:47], v[108:111], v[140:143], v[44:47]
    ds_read_b64_tr_b16 v[94:95], v8 offset:18432
    buffer_load_dwordx4 v[140:143], v9, s[12:15], s42 offen offset:3072 sc1
    s_waitcnt vmcnt(7) lgkmcnt(4)
    v_mfma_f32_16x16x32_bf16 v[16:19], v[80:83], v[112:115], v[16:19]
    s_add_u32 s84, s96, s92
    s_add_u32 s97, s84, 16
    ds_read_b64_tr_b16 v[96:97], v5 offset:20480
    s_waitcnt vmcnt(6)
    v_mfma_f32_16x16x32_bf16 v[24:27], v[80:83], v[116:119], v[24:27]
    s_min_u32 s84, s84, s97
    s_sub_u32 s97, s84, 16
    ds_read_b64_tr_b16 v[98:99], v5 offset:22528
    v_mfma_f32_16x16x32_bf16 v[20:23], v[84:87], v[112:115], v[20:23]
    s_min_u32 s84, s84, s97
    s_cmp_ge_u32 s96, 16
    s_cselect_b32 s84, 16, s84
    ds_read_b64_tr_b16 v[100:101], v6 offset:20480
    v_mfma_f32_16x16x32_bf16 v[28:31], v[84:87], v[116:119], v[28:31]
    s_add_u32 s96, s96, 1
    s_mul_i32 s42, s84, 4096
    ds_read_b64_tr_b16 v[102:103], v6 offset:22528
    s_waitcnt lgkmcnt(4)
    v_mfma_f32_16x16x32_bf16 v[32:35], v[88:91], v[112:115], v[32:35]
    ds_read_b64_tr_b16 v[104:105], v7 offset:20480
    v_mfma_f32_16x16x32_bf16 v[40:43], v[88:91], v[116:119], v[40:43]
    ds_read_b64_tr_b16 v[106:107], v7 offset:22528
    v_mfma_f32_16x16x32_bf16 v[36:39], v[92:95], v[112:115], v[36:39]
    ds_read_b64_tr_b16 v[108:109], v8 offset:20480
    buffer_load_dwordx4 v[112:115], v9, s[12:15], s42 offen sc1
    v_mfma_f32_16x16x32_bf16 v[44:47], v[92:95], v[116:119], v[44:47]
    ds_read_b64_tr_b16 v[110:111], v8 offset:22528
    buffer_load_dwordx4 v[116:119], v9, s[12:15], s42 offen offset:1024 sc1
    s_waitcnt vmcnt(7) lgkmcnt(4)
    v_mfma_f32_16x16x32_bf16 v[16:19], v[96:99], v[120:123], v[16:19]
    s_barrier
    ds_read_b64_tr_b16 v[80:81], v5 offset:24576
    s_waitcnt vmcnt(6)
    v_mfma_f32_16x16x32_bf16 v[24:27], v[96:99], v[124:127], v[24:27]
    ds_read_b64_tr_b16 v[82:83], v5 offset:26624
    v_mfma_f32_16x16x32_bf16 v[20:23], v[100:103], v[120:123], v[20:23]
    ds_read_b64_tr_b16 v[84:85], v6 offset:24576
    v_mfma_f32_16x16x32_bf16 v[28:31], v[100:103], v[124:127], v[28:31]
    ds_read_b64_tr_b16 v[86:87], v6 offset:26624
    s_waitcnt lgkmcnt(4)
    v_mfma_f32_16x16x32_bf16 v[32:35], v[104:107], v[120:123], v[32:35]
    ds_read_b64_tr_b16 v[88:89], v7 offset:24576
    v_mfma_f32_16x16x32_bf16 v[40:43], v[104:107], v[124:127], v[40:43]
    ds_read_b64_tr_b16 v[90:91], v7 offset:26624
    v_mfma_f32_16x16x32_bf16 v[36:39], v[108:111], v[120:123], v[36:39]
    ds_read_b64_tr_b16 v[92:93], v8 offset:24576
    buffer_load_dwordx4 v[120:123], v9, s[12:15], s42 offen offset:2048 sc1
    v_mfma_f32_16x16x32_bf16 v[44:47], v[108:111], v[124:127], v[44:47]
    ds_read_b64_tr_b16 v[94:95], v8 offset:26624
    buffer_load_dwordx4 v[124:127], v9, s[12:15], s42 offen offset:3072 sc1
    s_waitcnt vmcnt(7) lgkmcnt(4)
    v_mfma_f32_16x16x32_bf16 v[16:19], v[80:83], v[128:131], v[16:19]
    s_add_u32 s85, s96, s93
    s_add_u32 s97, s85, 16
    ds_read_b64_tr_b16 v[96:97], v5 offset:28672
    s_waitcnt vmcnt(6)
    v_mfma_f32_16x16x32_bf16 v[24:27], v[80:83], v[132:135], v[24:27]
    s_min_u32 s85, s85, s97
    s_sub_u32 s97, s85, 16
    ds_read_b64_tr_b16 v[98:99], v5 offset:30720
    v_mfma_f32_16x16x32_bf16 v[20:23], v[84:87], v[128:131], v[20:23]
    s_min_u32 s85, s85, s97
    s_cmp_ge_u32 s96, 16
    s_cselect_b32 s85, 16, s85
    ds_read_b64_tr_b16 v[100:101], v6 offset:28672
    v_mfma_f32_16x16x32_bf16 v[28:31], v[84:87], v[132:135], v[28:31]
    s_add_u32 s96, s96, 1
    s_mul_i32 s42, s85, 4096
    ds_read_b64_tr_b16 v[102:103], v6 offset:30720
    s_waitcnt lgkmcnt(4)
    v_mfma_f32_16x16x32_bf16 v[32:35], v[88:91], v[128:131], v[32:35]
    ds_read_b64_tr_b16 v[104:105], v7 offset:28672
    v_mfma_f32_16x16x32_bf16 v[40:43], v[88:91], v[132:135], v[40:43]
    ds_read_b64_tr_b16 v[106:107], v7 offset:30720
    v_mfma_f32_16x16x32_bf16 v[36:39], v[92:95], v[128:131], v[36:39]
    ds_read_b64_tr_b16 v[108:109], v8 offset:28672
    buffer_load_dwordx4 v[128:131], v9, s[12:15], s42 offen sc1
    v_mfma_f32_16x16x32_bf16 v[44:47], v[92:95], v[132:135], v[44:47]
    ds_read_b64_tr_b16 v[110:111], v8 offset:30720
    buffer_load_dwordx4 v[132:135], v9, s[12:15], s42 offen offset:1024 sc1
    s_waitcnt vmcnt(7) lgkmcnt(4)
    v_mfma_f32_16x16x32_bf16 v[16:19], v[96:99], v[136:139], v[16:19]
    s_barrier
    ds_read_b64_tr_b16 v[80:81], v5 offset:0
    s_waitcnt vmcnt(6)
    v_mfma_f32_16x16x32_bf16 v[24:27], v[96:99], v[140:143], v[24:27]
    ds_read_b64_tr_b16 v[82:83], v5 offset:2048
    v_mfma_f32_16x16x32_bf16 v[20:23], v[100:103], v[136:139], v[20:23]
    ds_read_b64_tr_b16 v[84:85], v6 offset:0
    v_mfma_f32_16x16x32_bf16 v[28:31], v[100:103], v[140:143], v[28:31]
    ds_read_b64_tr_b16 v[86:87], v6 offset:2048
    s_waitcnt lgkmcnt(4)
    v_mfma_f32_16x16x32_bf16 v[32:35], v[104:107], v[136:139], v[32:35]
    ds_read_b64_tr_b16 v[88:89], v7 offset:0
    v_mfma_f32_16x16x32_bf16 v[40:43], v[104:107], v[140:143], v[40:43]
    ds_read_b64_tr_b16 v[90:91], v7 offset:2048
    v_mfma_f32_16x16x32_bf16 v[36:39], v[108:111], v[136:139], v[36:39]
    ds_read_b64_tr_b16 v[92:93], v8 offset:0
    buffer_load_dwordx4 v[136:139], v9, s[12:15], s42 offen offset:2048 sc1
    v_mfma_f32_16x16x32_bf16 v[44:47], v[108:111], v[140:143], v[44:47]
    ds_read_b64_tr_b16 v[94:95], v8 offset:2048
    buffer_load_dwordx4 v[140:143], v9, s[12:15], s42 offen offset:3072 sc1
    s_sub_u32 s43, s43, 1
    s_cmp_lg_u32 s43, 0
    s_cbranch_scc1 po_loop
    s_lshl_b32 s36, s35, 12
    s_lshl_b32 s37, s34, 8
    s_add_u32 s36, s36, s37
    s_add_u32 s24, s28, 32768000
    s_addc_u32 s25, s29, 0
    s_mov_b32 s26, 262144
    s_mov_b32 s27, 0x00020000
    v_cvt_pk_bf16_f32 v228, v16, v17
    v_cvt_pk_bf16_f32 v229, v18, v19
    v_cvt_pk_bf16_f32 v230, v20, v21
    v_cvt_pk_bf16_f32 v231, v22, v23
    buffer_store_dwordx4 v[228:231], v9, s[20:23], 0 offen offset:0 sc1
    v_cvt_pk_bf16_f32 v232, v24, v25
    v_cvt_pk_bf16_f32 v233, v26, v27
    v_cvt_pk_bf16_f32 v234, v28, v29
    v_cvt_pk_bf16_f32 v235, v30, v31
    buffer_store_dwordx4 v[232:235], v9, s[20:23], 0 offen offset:1024 sc1
    v_cvt_pk_bf16_f32 v236, v32, v33
    v_cvt_pk_bf16_f32 v237, v34, v35
    v_cvt_pk_bf16_f32 v238, v36, v37
    v_cvt_pk_bf16_f32 v239, v38, v39
    buffer_store_dwordx4 v[236:239], v9, s[20:23], 0 offen offset:2048 sc1
    v_cvt_pk_bf16_f32 v240, v40, v41
    v_cvt_pk_bf16_f32 v241, v42, v43
    v_cvt_pk_bf16_f32 v242, v44, v45
    v_cvt_pk_bf16_f32 v243, v46, v47
    buffer_store_dwordx4 v[240:243], v9, s[20:23], 0 offen offset:3072 sc1
    v_mov_b32 v14, 0x3f803f80
    v_mov_b32 v10, 0
    v_mov_b32 v11, 0
    v_mov_b32 v12, 0
    v_mov_b32 v13, 0
    v_dot2_f32_bf16 v10, v228, v14, v10
    v_dot2_f32_bf16 v11, v228, v228, v11
    v_dot2_f32_bf16 v10, v229, v14, v10
    v_dot2_f32_bf16 v11, v229, v229, v11
    v_dot2_f32_bf16 v10, v230, v14, v10
    v_dot2_f32_bf16 v11, v230, v230, v11
    v_dot2_f32_bf16 v10, v231, v14, v10
    v_dot2_f32_bf16 v11, v231, v231, v11
    v_dot2_f32_bf16 v12, v232, v14, v12
    v_dot2_f32_bf16 v13, v232, v232, v13
    v_dot2_f32_bf16 v12, v233, v14, v12
    v_dot2_f32_bf16 v13, v233, v233, v13
    v_dot2_f32_bf16 v12, v234, v14, v12
    v_dot2_f32_bf16 v13, v234, v234, v13
    v_dot2_f32_bf16 v12, v235, v14, v12
    v_dot2_f32_bf16 v13, v235, v235, v13
    v_dot2_f32_bf16 v10, v236, v14, v10
    v_dot2_f32_bf16 v11, v236, v236, v11
    v_dot2_f32_bf16 v10, v237, v14, v10
    v_dot2_f32_bf16 v11, v237, v237, v11
    v_dot2_f32_bf16 v10, v238, v14, v10
    v_dot2_f32_bf16 v11, v238, v238, v11
    v_dot2_f32_bf16 v10, v239, v14, v10
    v_dot2_f32_bf16 v11, v239, v239, v11
    v_dot2_f32_bf16 v12, v240, v14, v12
    v_dot2_f32_bf16 v13, v240, v240, v13
    v_dot2_f32_bf16 v12, v241, v14, v12
    v_dot2_f32_bf16 v13, v241, v241, v13
    v_dot2_f32_bf16 v12, v242, v14, v12
    v_dot2_f32_bf16 v13, v242, v242, v13
    v_dot2_f32_bf16 v12, v243, v14, v12
    v_dot2_f32_bf16 v13, v243, v243, v13
    s_nop 3
    v_permlane32_swap_b32 v10, v11
    v_permlane32_swap_b32 v12, v13
    s_nop 1
    v_add_f32 v10, v10, v11
    v_add_f32 v12, v12, v13
    s_nop 1
    v_permlane16_swap_b32 v10, v12
    s_nop 1
    v_add_f32 v10, v10, v12
    v_lshrrev_b32 v9, 2, v9
    buffer_store_dword v10, v9, s[24:27], s36 offen sc1
po_out:
    s_lshl_b32 s99, s98, 6
    s_add_u32 s99, s99, s45
    s_add_u32 s99, s99, 32
    s_mul_i32 s99, s99, 256
    s_branch pu
po_idle:
    s_waitcnt vmcnt(0)
    s_barrier
    s_cmp_lg_u32 s3, 4
    s_cbranch_scc1 po_i1
    s_mov_b64 exec, 1
    v_mov_b32 v1, 0
    v_mov_b32 v2, 1
    buffer_atomic_add v2, v1, s[80:83], s99 offen sc1
    s_mov_b64 exec, -1
po_i1:
    s_cmp_lg_u32 s3, 4
    s_cbranch_scc1 po_i2
    s_waitcnt vmcnt(0)
    s_mov_b64 exec, 1
    v_mov_b32 v1, 0
    s_mov_b32 s50, 0x40000
    s_branch po_pgo
po_poll:
po_pgo:
    v_mov_b32 v3, 0
    buffer_atomic_add v3, v1, s[80:83], s100 offen sc0 sc1
    s_sub_u32 s50, s50, 1
    s_cbranch_scc1 po_pdone
    s_waitcnt vmcnt(0)
    v_readfirstlane_b32 s51, v3
    s_cmp_lt_u32 s51, s101
    s_cbranch_scc1 po_poll
po_pdone:
    s_mov_b64 exec, -1
po_i2:
    s_barrier
    s_mov_b32 s43, 16
po_i3:
    s_waitcnt vmcnt(2)
    s_cmp_le_u32 s94, 16
    s_cbranch_scc1 st22
    s_waitcnt vmcnt(0)
st22:
    s_barrier
    s_cmp_ge_u32 s94, 16
    s_cbranch_scc1 ld23
    s_and_b32 s18, s94, 3
    s_cmp_eq_u32 s18, s96
    s_cselect_b32 s18, 3, -1
    s_add_u32 s93, s94, s18
    s_add_u32 s18, s93, 16
    s_min_u32 s93, s93, s18
    s_sub_u32 s18, s93, 16
    s_min_u32 s93, s93, s18
    s_mul_i32 s93, s93, 131072
    s_add_u32 s18, s92, s95
    s_add_u32 m0, s18, 0
    s_nop 0
    buffer_load_dwordx4 v140, s[88:91], s93 offen lds
    s_add_u32 m0, s18, 4096
    s_nop 0
    buffer_load_dwordx4 v141, s[88:91], s93 offen lds
    s_add_u32 s95, s95, 8192
    s_cmp_eq_u32 s95, 32768
    s_cselect_b32 s95, 0, s95
ld23:
    s_add_u32 s94, s94, 1
    s_sub_u32 s43, s43, 1
    s_cmp_lg_u32 s43, 0
    s_cbranch_scc1 po_i3
po_i3x:
    s_branch po_out
pu:
    s_load_dwordx4 s[4:7], s[0:1], 32
    s_and_b32 s31, s2, 7
    s_lshr_b32 s32, s2, 3
    s_and_b32 s33, s31, 1
    s_lshl_b32 s33, s33, 2
    s_lshr_b32 s34, s32, 3
    s_add_u32 s33, s33, s34
    s_lshr_b32 s34, s31, 1
    s_lshl_b32 s34, s34, 3
    s_and_b32 s32, s32, 7
    s_add_u32 s34, s34, s32
    s_lshl_b32 s100, s98, 6
    s_add_u32 s100, s100, s33
    s_add_u32 s100, s100, 32
    s_mov_b32 s101, 32
    s_mul_i32 s100, s100, 256
    s_lshl_b32 s35, s33, 3
    s_add_u32 s35, s35, s3
    s_lshr_b32 s37, s3, 2
    s_lshl_b32 s40, s3, 12
    s_and_b32 s45, s34, 1
    v_and_b32 v12, 63, v0
    v_lshlrev_b32 v7, 4, v12
    s_lshl_b32 s36, s35, 16
    s_add_u32 s36, s36, 8388608
    s_add_u32 s12, s28, s36
    s_addc_u32 s13, s29, 0
    s_mov_b32 s14, 65536
    s_mov_b32 s15, 0x00020000
    v_and_b32 v13, 3, v12
    v_lshlrev_b32 v5, 3, v13
    v_lshrrev_b32 v13, 2, v12
    v_mul_u32_u24 v13, 224, v13
    v_add_u32 v5, v5, v13
    v_add_u32 v6, 65536, v5
    s_lshl_b32 s38, s35, 12
    s_add_u32 s38, s38, 32768000
    s_mul_i32 s39, s34, 3584
    s_add_u32 s39, s39, 33095680
    s_add_u32 s20, s28, s38
    s_addc_u32 s21, s29, 0
    s_mov_b32 s22, 4096
    s_mov_b32 s23, 0x00020000
    s_add_u32 s24, s28, s39
    s_addc_u32 s25, s29, 0
    s_mov_b32 s26, 118272
    s_mov_b32 s27, 0x00020000
    s_mov_b32 s10, 7340032
    s_mov_b32 s11, 0x00020000
    s_cmp_eq_u32 s37, 0
    s_waitcnt lgkmcnt(0)
    s_cselect_b32 s8, s4, s6
    s_cselect_b32 s9, s5, s7
    s_cmp_lt_u32 s3, 4
    s_cbranch_scc1 pu_lo
    s_cmp_lg_u32 s3, 4
    s_cbranch_scc1 pu_c1
    v_and_b32 v13, 15, v12
    v_bfe_u32 v14, v12, 4, 1
    v_mul_u32_u24 v14, 3584, v14
    v_add_lshl_u32 v13, v13, v14, 5
    v_lshrrev_b32 v14, 5, v12
    v_lshl_add_u32 v13, v14, 4, v13
    s_lshl_b32 s48, s45, 9
    s_mul_i32 s49, s45, 3072
    s_sub_u32 s49, 3072, s49
    buffer_load_dwordx4 v[196:199], v13, s[24:27], s48 offen offset:0 sc1
    buffer_load_dwordx4 v[200:203], v13, s[24:27], s48 offen offset:512 sc1
    buffer_load_dwordx4 v[204:207], v13, s[24:27], s48 offen offset:1024 sc1
    buffer_load_dwordx4 v[208:211], v13, s[24:27], s48 offen offset:1536 sc1
    buffer_load_dwordx4 v[212:215], v13, s[24:27], s48 offen offset:2048 sc1
    buffer_load_dwordx4 v[216:219], v13, s[24:27], s48 offen offset:2560 sc1
    buffer_load_dwordx4 v[220:223], v13, s[24:27], s49 offen offset:0 sc1
pu_c1:
    v_and_b32 v12, 63, v0
    s_and_b32 s46, s3, 3
    s_lshl_b32 s46, s46, 8
    s_mul_i32 s47, s34, 224
    s_and_b32 s48, s34, 1
    s_lshl_b32 s48, s48, 1
    s_movk_i32 s49, 4682
    v_add_u32 v13, s46, v12
    v_mul_u32_u24 v14, s49, v13
    v_lshrrev_b32 v14, 16, v14
    v_mul_u32_u24 v15, 14, v14
    v_sub_u32 v15, v13, v15
    v_add_u32 v15, s48, v15
    v_subrev_u32 v13, 14, v15
    v_min_u32 v15, v15, v13
    v_mul_u32_u24 v1, 7168, v14
    v_lshl_add_u32 v1, v15, 4, v1
    v_add_u32 v1, s47, v1
    v_add_u32 v13, s46, v12
    v_add_u32 v13, 64, v13
    v_mul_u32_u24 v14, s49, v13
    v_lshrrev_b32 v14, 16, v14
    v_mul_u32_u24 v15, 14, v14
    v_sub_u32 v15, v13, v15
    v_add_u32 v15, s48, v15
    v_subrev_u32 v13, 14, v15
    v_min_u32 v15, v15, v13
    v_mul_u32_u24 v2, 7168, v14
    v_lshl_add_u32 v2, v15, 4, v2
    v_add_u32 v2, s47, v2
    v_add_u32 v13, s46, v12
    v_add_u32 v13, 128, v13
    v_mul_u32_u24 v14, s49, v13
    v_lshrrev_b32 v14, 16, v14
    v_mul_u32_u24 v15, 14, v14
    v_sub_u32 v15, v13, v15
    v_add_u32 v15, s48, v15
    v_subrev_u32 v13, 14, v15
    v_min_u32 v15, v15, v13
    v_mul_u32_u24 v3, 7168, v14
    v_lshl_add_u32 v3, v15, 4, v3
    v_add_u32 v3, s47, v3
    v_lshrrev_b32 v14, 6, v14
    v_lshl_add_u32 v3, v14, 28, v3
    v_add_u32 v13, s46, v12
    v_add_u32 v13, 192, v13
    v_mul_u32_u24 v14, s49, v13
    v_lshrrev_b32 v14, 16, v14
    v_mul_u32_u24 v15, 14, v14
    v_sub_u32 v15, v13, v15
    v_add_u32 v15, s48, v15
    v_subrev_u32 v13, 14, v15
    v_min_u32 v15, v15, v13
    v_mul_u32_u24 v4, 7168, v14
    v_lshl_add_u32 v4, v15, 4, v4
    v_add_u32 v4, s47, v4
    v_lshrrev_b32 v14, 6, v14
    v_lshl_add_u32 v4, v14, 28, v4
    s_mov_b32 s41, 0xfff90000
    s_mov_b32 s42, 0xfffff000
    v_lshlrev_b32 v13, 2, v12
    v_add_u32 v13, 131072, v13
    v_and_b32 v14, 3, v12
    v_lshlrev_b32 v14, 6, v14
    v_and_b32 v15, 12, v12
    v_add_u32 v14, v14, v15
    v_lshrrev_b32 v15, 5, v12
    v_lshl_add_u32 v15, v15, 4, v14
    s_add_u32 s30, s37, 1
    s_load_dwordx2 s[88:89], s[0:1], 48
    s_mov_b32 s90, 7340032
    s_mov_b32 s91, 0x00020000
    s_lshl_b32 s44, s2, 2
    s_add_u32 s44, s44, s3
    s_mul_i32 s44, s44, 7168
    s_add_u32 s46, s44, 4096
    s_lshr_b32 s31, s2, 3
    s_and_b32 s32, s2, 7
    s_lshl_b32 s32, s32, 1
    s_add_u32 s31, s31, s32
    s_mul_i32 s32, s31, 5958
    s_lshr_b32 s32, s32, 16
    s_mul_i32 s32, s32, 11
    s_sub_u32 s31, s31, s32
    s_add_u32 s31, s31, 1
    s_lshl_b32 s47, s31, 12
    s_lshr_b32 s31, s3, 2
    s_or_b32 s31, s31, s98
    s_cmp_lg_u32 s31, 0
    s_cselect_b32 s47, -1, s47
    s_waitcnt lgkmcnt(0)
    v_pk_mov_b32 v[68:69], 0, 0
    v_pk_mov_b32 v[70:71], 0, 0
    v_pk_mov_b32 v[72:73], 0, 0
    v_pk_mov_b32 v[74:75], 0, 0
    v_pk_mov_b32 v[76:77], 0, 0
    v_pk_mov_b32 v[78:79], 0, 0
    v_pk_mov_b32 v[80:81], 0, 0
    v_pk_mov_b32 v[82:83], 0, 0
    v_pk_mov_b32 v[84:85], 0, 0
    v_pk_mov_b32 v[86:87], 0, 0
    v_pk_mov_b32 v[88:89], 0, 0
    v_pk_mov_b32 v[90:91], 0, 0
    v_pk_mov_b32 v[92:93], 0, 0
    v_pk_mov_b32 v[94:95], 0, 0
    v_pk_mov_b32 v[96:97], 0, 0
    v_pk_mov_b32 v[98:99], 0, 0
    v_pk_mov_b32 v[100:101], 0, 0
    v_pk_mov_b32 v[102:103], 0, 0
    v_pk_mov_b32 v[104:105], 0, 0
    v_pk_mov_b32 v[106:107], 0, 0
    v_pk_mov_b32 v[108:109], 0, 0
    v_pk_mov_b32 v[110:111], 0, 0
    v_pk_mov_b32 v[112:113], 0, 0
    v_pk_mov_b32 v[114:115], 0, 0
    v_pk_mov_b32 v[116:117], 0, 0
    v_pk_mov_b32 v[118:119], 0, 0
    v_pk_mov_b32 v[120:121], 0, 0
    v_pk_mov_b32 v[122:123], 0, 0
    v_pk_mov_b32 v[124:125], 0, 0
    v_pk_mov_b32 v[126:127], 0, 0
    v_pk_mov_b32 v[128:129], 0, 0
    v_pk_mov_b32 v[130:131], 0, 0
    v_pk_mov_b32 v[132:133], 0, 0
    v_pk_mov_b32 v[134:135], 0, 0
    v_pk_mov_b32 v[136:137], 0, 0
    v_pk_mov_b32 v[138:139], 0, 0
    v_pk_mov_b32 v[140:141], 0, 0
    v_pk_mov_b32 v[142:143], 0, 0
    v_pk_mov_b32 v[144:145], 0, 0
    v_pk_mov_b32 v[146:147], 0, 0
    v_pk_mov_b32 v[148:149], 0, 0
    v_pk_mov_b32 v[150:151], 0, 0
    v_pk_mov_b32 v[152:153], 0, 0
    v_pk_mov_b32 v[154:155], 0, 0
    v_pk_mov_b32 v[156:157], 0, 0
    v_pk_mov_b32 v[158:159], 0, 0
    v_pk_mov_b32 v[160:161], 0, 0
    v_pk_mov_b32 v[162:163], 0, 0
    v_pk_mov_b32 v[164:165], 0, 0
    v_pk_mov_b32 v[166:167], 0, 0
    v_pk_mov_b32 v[168:169], 0, 0
    v_pk_mov_b32 v[170:171], 0, 0
    v_pk_mov_b32 v[172:173], 0, 0
    v_pk_mov_b32 v[174:175], 0, 0
    v_pk_mov_b32 v[176:177], 0, 0
    v_pk_mov_b32 v[178:179], 0, 0
    s_waitcnt vmcnt(0)
    s_barrier
    s_cmp_lg_u32 s3, 4
    s_cbranch_scc1 pu_c2
    v_pk_add_f32 v[196:197], v[196:197], v[198:199]
    v_pk_add_f32 v[200:201], v[200:201], v[202:203]
    v_pk_add_f32 v[204:205], v[204:205], v[206:207]
    v_pk_add_f32 v[208:209], v[208:209], v[210:211]
    v_pk_add_f32 v[212:213], v[212:213], v[214:215]
    v_pk_add_f32 v[216:217], v[216:217], v[218:219]
    v_pk_add_f32 v[220:221], v[220:221], v[222:223]
    v_add_f32 v196, v196, v197
    v_add_f32 v200, v200, v201
    v_add_f32 v204, v204, v205
    v_add_f32 v208, v208, v209
    v_add_f32 v212, v212, v213
    v_add_f32 v216, v216, v217
    v_add_f32 v220, v220, v221
    v_mov_b32 v197, v196
    v_mov_b32 v201, v200
    v_mov_b32 v205, v204
    v_mov_b32 v209, v208
    v_mov_b32 v213, v212
    v_mov_b32 v217, v216
    v_mov_b32 v221, v220
    s_nop 1
    v_permlane32_swap_b32 v196, v197
    v_permlane32_swap_b32 v200, v201
    v_permlane32_swap_b32 v204, v205
    v_permlane32_swap_b32 v208, v209
    v_permlane32_swap_b32 v212, v213
    v_permlane32_swap_b32 v216, v217
    v_permlane32_swap_b32 v220, v221
    s_nop 1
    v_add_f32 v196, v196, v197
    v_add_f32 v200, v200, v201
    v_add_f32 v204, v204, v205
    v_add_f32 v208, v208, v209
    v_add_f32 v212, v212, v213
    v_add_f32 v216, v216, v217
    v_add_f32 v220, v220, v221
    ds_write_b32 v13, v196 offset:0
    ds_write_b32 v13, v200 offset:256
    ds_write_b32 v13, v204 offset:512
    ds_write_b32 v13, v208 offset:768
    ds_write_b32 v13, v212 offset:1024
    ds_write_b32 v13, v216 offset:1280
    ds_write_b32 v13, v220 offset:1536
pu_c2:
    s_cmp_lg_u32 s3, 7
    s_cbranch_scc1 pu_join
    s_mov_b64 exec, 1
    v_mov_b32 v16, 0
    v_mov_b32 v17, 1
    buffer_atomic_add v17, v16, s[80:83], s99 offen sc1
    s_mov_b64 exec, -1
    s_branch pu_join
pu_lo:
    s_waitcnt vmcnt(0)
    s_barrier
    v_and_b32 v12, 63, v0
    s_and_b32 s46, s3, 3
    s_lshl_b32 s46, s46, 8
    s_mul_i32 s47, s34, 224
    s_and_b32 s48, s34, 1
    s_lshl_b32 s48, s48, 1
    s_movk_i32 s49, 4682
    v_add_u32 v13, s46, v12
    v_mul_u32_u24 v14, s49, v13
    v_lshrrev_b32 v14, 16, v14
    v_mul_u32_u24 v15, 14, v14
    v_sub_u32 v15, v13, v15
    v_add_u32 v15, s48, v15
    v_subrev_u32 v13, 14, v15
    v_min_u32 v15, v15, v13
    v_mul_u32_u24 v1, 7168, v14
    v_lshl_add_u32 v1, v15, 4, v1
    v_add_u32 v1, s47, v1
    v_add_u32 v13, s46, v12
    v_add_u32 v13, 64, v13
    v_mul_u32_u24 v14, s49, v13
    v_lshrrev_b32 v14, 16, v14
    v_mul_u32_u24 v15, 14, v14
    v_sub_u32 v15, v13, v15
    v_add_u32 v15, s48, v15
    v_subrev_u32 v13, 14, v15
    v_min_u32 v15, v15, v13
    v_mul_u32_u24 v2, 7168, v14
    v_lshl_add_u32 v2, v15, 4, v2
    v_add_u32 v2, s47, v2
    v_add_u32 v13, s46, v12
    v_add_u32 v13, 128, v13
    v_mul_u32_u24 v14, s49, v13
    v_lshrrev_b32 v14, 16, v14
    v_mul_u32_u24 v15, 14, v14
    v_sub_u32 v15, v13, v15
    v_add_u32 v15, s48, v15
    v_subrev_u32 v13, 14, v15
    v_min_u32 v15, v15, v13
    v_mul_u32_u24 v3, 7168, v14
    v_lshl_add_u32 v3, v15, 4, v3
    v_add_u32 v3, s47, v3
    v_lshrrev_b32 v14, 6, v14
    v_lshl_add_u32 v3, v14, 28, v3
    v_add_u32 v13, s46, v12
    v_add_u32 v13, 192, v13
    v_mul_u32_u24 v14, s49, v13
    v_lshrrev_b32 v14, 16, v14
    v_mul_u32_u24 v15, 14, v14
    v_sub_u32 v15, v13, v15
    v_add_u32 v15, s48, v15
    v_subrev_u32 v13, 14, v15
    v_min_u32 v15, v15, v13
    v_mul_u32_u24 v4, 7168, v14
    v_lshl_add_u32 v4, v15, 4, v4
    v_add_u32 v4, s47, v4
    v_lshrrev_b32 v14, 6, v14
    v_lshl_add_u32 v4, v14, 28, v4
    s_mov_b32 s41, 0xfff90000
    s_mov_b32 s42, 0xfffff000
    v_lshlrev_b32 v13, 2, v12
    v_add_u32 v13, 131072, v13
    v_and_b32 v14, 3, v12
    v_lshlrev_b32 v14, 6, v14
    v_and_b32 v15, 12, v12
    v_add_u32 v14, v14, v15
    v_lshrrev_b32 v15, 5, v12
    v_lshl_add_u32 v15, v15, 4, v14
    s_add_u32 s30, s37, 1
    s_load_dwordx2 s[88:89], s[0:1], 48
    s_mov_b32 s90, 7340032
    s_mov_b32 s91, 0x00020000
    s_lshl_b32 s44, s2, 2
    s_add_u32 s44, s44, s3
    s_mul_i32 s44, s44, 7168
    s_add_u32 s46, s44, 4096
    s_lshr_b32 s31, s2, 3
    s_and_b32 s32, s2, 7
    s_lshl_b32 s32, s32, 1
    s_add_u32 s31, s31, s32
    s_mul_i32 s32, s31, 5958
    s_lshr_b32 s32, s32, 16
    s_mul_i32 s32, s32, 11
    s_sub_u32 s31, s31, s32
    s_add_u32 s31, s31, 1
    s_lshl_b32 s47, s31, 12
    s_lshr_b32 s31, s3, 2
    s_or_b32 s31, s31, s98
    s_cmp_lg_u32 s31, 0
    s_cselect_b32 s47, -1, s47
    s_waitcnt lgkmcnt(0)
    v_pk_mov_b32 v[68:69], 0, 0
    v_pk_mov_b32 v[70:71], 0, 0
    v_pk_mov_b32 v[72:73], 0, 0
    v_pk_mov_b32 v[74:75], 0, 0
    v_pk_mov_b32 v[76:77], 0, 0
    v_pk_mov_b32 v[78:79], 0, 0
    v_pk_mov_b32 v[80:81], 0, 0
    v_pk_mov_b32 v[82:83], 0, 0
    v_pk_mov_b32 v[84:85], 0, 0
    v_pk_mov_b32 v[86:87], 0, 0
    v_pk_mov_b32 v[88:89], 0, 0
    v_pk_mov_b32 v[90:91], 0, 0
    v_pk_mov_b32 v[92:93], 0, 0
    v_pk_mov_b32 v[94:95], 0, 0
    v_pk_mov_b32 v[96:97], 0, 0
    v_pk_mov_b32 v[98:99], 0, 0
    v_pk_mov_b32 v[100:101], 0, 0
    v_pk_mov_b32 v[102:103], 0, 0
    v_pk_mov_b32 v[104:105], 0, 0
    v_pk_mov_b32 v[106:107], 0, 0
    v_pk_mov_b32 v[108:109], 0, 0
    v_pk_mov_b32 v[110:111], 0, 0
    v_pk_mov_b32 v[112:113], 0, 0
    v_pk_mov_b32 v[114:115], 0, 0
    v_pk_mov_b32 v[116:117], 0, 0
    v_pk_mov_b32 v[118:119], 0, 0
    v_pk_mov_b32 v[120:121], 0, 0
    v_pk_mov_b32 v[122:123], 0, 0
    v_pk_mov_b32 v[124:125], 0, 0
    v_pk_mov_b32 v[126:127], 0, 0
    v_pk_mov_b32 v[128:129], 0, 0
    v_pk_mov_b32 v[130:131], 0, 0
    v_pk_mov_b32 v[132:133], 0, 0
    v_pk_mov_b32 v[134:135], 0, 0
    v_pk_mov_b32 v[136:137], 0, 0
    v_pk_mov_b32 v[138:139], 0, 0
    v_pk_mov_b32 v[140:141], 0, 0
    v_pk_mov_b32 v[142:143], 0, 0
    v_pk_mov_b32 v[144:145], 0, 0
    v_pk_mov_b32 v[146:147], 0, 0
    v_pk_mov_b32 v[148:149], 0, 0
    v_pk_mov_b32 v[150:151], 0, 0
    v_pk_mov_b32 v[152:153], 0, 0
    v_pk_mov_b32 v[154:155], 0, 0
    v_pk_mov_b32 v[156:157], 0, 0
    v_pk_mov_b32 v[158:159], 0, 0
    v_pk_mov_b32 v[160:161], 0, 0
    v_pk_mov_b32 v[162:163], 0, 0
    v_pk_mov_b32 v[164:165], 0, 0
    v_pk_mov_b32 v[166:167], 0, 0
    v_pk_mov_b32 v[168:169], 0, 0
    v_pk_mov_b32 v[170:171], 0, 0
    v_pk_mov_b32 v[172:173], 0, 0
    v_pk_mov_b32 v[174:175], 0, 0
    v_pk_mov_b32 v[176:177], 0, 0
    v_pk_mov_b32 v[178:179], 0, 0
pu_join:
    s_mov_b32 s41, 458752
    ds_read_b64_tr_b16 v[20:21], v5 offset:0
    ds_read_b64_tr_b16 v[22:23], v5 offset:3584
    ds_read_b64_tr_b16 v[24:25], v5 offset:16384
    ds_read_b64_tr_b16 v[26:27], v5 offset:19968
    ds_read_b64_tr_b16 v[28:29], v5 offset:32
    ds_read_b64_tr_b16 v[30:31], v5 offset:3616
    ds_read_b64_tr_b16 v[32:33], v5 offset:16416
    ds_read_b64_tr_b16 v[34:35], v5 offset:20000
    ds_read_b64_tr_b16 v[36:37], v5 offset:64
    ds_read_b64_tr_b16 v[38:39], v5 offset:3648
    ds_read_b64_tr_b16 v[40:41], v5 offset:16448
    ds_read_b64_tr_b16 v[42:43], v5 offset:20032
    ds_read_b64_tr_b16 v[44:45], v5 offset:96
    ds_read_b64_tr_b16 v[46:47], v5 offset:3680
    s_cmp_lg_u32 s3, 7
    s_cbranch_scc1 pu_nopoll
    s_waitcnt vmcnt(0)
    s_mov_b64 exec, 1
    v_mov_b32 v16, 0
    s_mov_b32 s50, 0x40000
    s_branch pu_pgo
pu_poll:
pu_pgo:
    v_mov_b32 v18, 0
    buffer_atomic_add v18, v16, s[80:83], s100 offen sc0 sc1
    s_sub_u32 s50, s50, 1
    s_cbranch_scc1 pu_pdone
    s_waitcnt vmcnt(0)
    v_readfirstlane_b32 s51, v18
    s_cmp_lt_u32 s51, s101
    s_cbranch_scc1 pu_poll
pu_pdone:
    s_mov_b64 exec, -1
pu_nopoll:
    s_barrier
    s_add_u32 s42, s42, 4096
    buffer_load_dwordx4 v[52:55], v7, s[12:15], s42 offen sc1
    buffer_load_dwordx4 v[56:59], v7, s[12:15], s42 offen offset:1024 sc1
    buffer_load_dwordx4 v[60:63], v7, s[12:15], s42 offen offset:2048 sc1
    buffer_load_dwordx4 v[64:67], v7, s[12:15], s42 offen offset:3072 sc1
    s_add_u32 s41, s41, 458752
    s_add_u32 m0, s40, 65536
    s_nop 0
    buffer_load_dwordx4 v1, s[8:11], s41 offen lds
    s_cmp_lt_u32 s3, 4
    s_cbranch_scc1 pu_np
    s_setprio 1
pu_np:
    s_mov_b32 s43, 4
    .p2align 6
pu_loop:
    s_waitcnt vmcnt(4) lgkmcnt(10)
    v_mfma_f32_16x16x32_bf16 v[68:71], v[20:23], v[52:55], v[68:71]
    s_add_u32 s42, s42, 4096
    ds_read_b64_tr_b16 v[48:49], v5 offset:16480
    s_waitcnt vmcnt(3)
    v_mfma_f32_16x16x32_bf16 v[76:79], v[20:23], v[56:59], v[76:79]
    ds_read_b64_tr_b16 v[50:51], v5 offset:20064
    s_add_u32 m0, s40, 66560
    v_mfma_f32_16x16x32_bf16 v[72:75], v[24:27], v[52:55], v[72:75]
    buffer_load_dwordx4 v2, s[8:11], s41 offen lds
s_cmp_lg_u32 s42, s47
    s_cbranch_scc1 pu_wb1
    buffer_load_dwordx4 v[244:247], v7, s[88:91], s44 offen offset:0
    buffer_load_dwordx4 v[244:247], v7, s[88:91], s44 offen offset:1024
    buffer_load_dwordx4 v[244:247], v7, s[88:91], s44 offen offset:2048
    buffer_load_dwordx4 v[244:247], v7, s[88:91], s44 offen offset:3072
    buffer_load_dwordx4 v[244:247], v7, s[88:91], s46 offen offset:0
    buffer_load_dwordx4 v[244:247], v7, s[88:91], s46 offen offset:1024
    buffer_load_dwordx4 v[244:247], v7, s[88:91], s46 offen offset:2048
pu_wb1:
    ds_read_b64_tr_b16 v[20:21], v5 offset:128
    v_mfma_f32_16x16x32_bf16 v[80:83], v[24:27], v[56:59], v[80:83]
    ds_read_b64_tr_b16 v[22:23], v5 offset:3712
    s_waitcnt lgkmcnt(10)
    v_mfma_f32_16x16x32_bf16 v[84:87], v[28:31], v[52:55], v[84:87]
    ds_read_b64_tr_b16 v[24:25], v5 offset:16512
    v_mfma_f32_16x16x32_bf16 v[92:95], v[28:31], v[56:59], v[92:95]
    ds_read_b64_tr_b16 v[26:27], v5 offset:20096
    v_mfma_f32_16x16x32_bf16 v[88:91], v[32:35], v[52:55], v[88:91]
    ds_read_b64_tr_b16 v[28:29], v5 offset:160
    v_mfma_f32_16x16x32_bf16 v[96:99], v[32:35], v[56:59], v[96:99]
    ds_read_b64_tr_b16 v[30:31], v5 offset:3744
    s_waitcnt lgkmcnt(10)
    v_mfma_f32_16x16x32_bf16 v[100:103], v[36:39], v[52:55], v[100:103]
    ds_read_b64_tr_b16 v[32:33], v5 offset:16544
    v_mfma_f32_16x16x32_bf16 v[108:111], v[36:39], v[56:59], v[108:111]
    ds_read_b64_tr_b16 v[34:35], v5 offset:20128
    v_mfma_f32_16x16x32_bf16 v[104:107], v[40:43], v[52:55], v[104:107]
    ds_read_b64_tr_b16 v[36:37], v5 offset:192
    v_mfma_f32_16x16x32_bf16 v[112:115], v[40:43], v[56:59], v[112:115]
    ds_read_b64_tr_b16 v[38:39], v5 offset:3776
    s_waitcnt lgkmcnt(10)
    v_mfma_f32_16x16x32_bf16 v[116:119], v[44:47], v[52:55], v[116:119]
    ds_read_b64_tr_b16 v[40:41], v5 offset:16576
    v_mfma_f32_16x16x32_bf16 v[124:127], v[44:47], v[56:59], v[124:127]
    ds_read_b64_tr_b16 v[42:43], v5 offset:20160
    v_mfma_f32_16x16x32_bf16 v[120:123], v[48:51], v[52:55], v[120:123]
    ds_read_b64_tr_b16 v[44:45], v5 offset:7168
    v_mfma_f32_16x16x32_bf16 v[128:131], v[48:51], v[56:59], v[128:131]
    ds_read_b64_tr_b16 v[46:47], v5 offset:10752
    s_waitcnt lgkmcnt(10)
    s_add_u32 m0, s40, 67584
    v_mfma_f32_16x16x32_bf16 v[132:135], v[20:23], v[52:55], v[132:135]
    buffer_load_dwordx4 v3, s[8:11], s41 offen lds
    ds_read_b64_tr_b16 v[48:49], v5 offset:23552
    v_mfma_f32_16x16x32_bf16 v[140:143], v[20:23], v[56:59], v[140:143]
    ds_read_b64_tr_b16 v[50:51], v5 offset:27136
    v_mfma_f32_16x16x32_bf16 v[136:139], v[24:27], v[52:55], v[136:139]
    ds_read_b64_tr_b16 v[20:21], v5 offset:7200
    v_mfma_f32_16x16x32_bf16 v[144:147], v[24:27], v[56:59], v[144:147]
    ds_read_b64_tr_b16 v[22:23], v5 offset:10784
    s_waitcnt lgkmcnt(10)
    v_mfma_f32_16x16x32_bf16 v[148:151], v[28:31], v[52:55], v[148:151]
    ds_read_b64_tr_b16 v[24:25], v5 offset:23584
    v_mfma_f32_16x16x32_bf16 v[156:159], v[28:31], v[56:59], v[156:159]
    ds_read_b64_tr_b16 v[26:27], v5 offset:27168
    v_mfma_f32_16x16x32_bf16 v[152:155], v[32:35], v[52:55], v[152:155]
    ds_read_b64_tr_b16 v[28:29], v5 offset:7232
    v_mfma_f32_16x16x32_bf16 v[160:163], v[32:35], v[56:59], v[160:163]
    ds_read_b64_tr_b16 v[30:31], v5 offset:10816
    s_waitcnt lgkmcnt(10)
    v_mfma_f32_16x16x32_bf16 v[164:167], v[36:39], v[52:55], v[164:167]
    ds_read_b64_tr_b16 v[32:33], v5 offset:23616
    v_mfma_f32_16x16x32_bf16 v[172:175], v[36:39], v[56:59], v[172:175]
    ds_read_b64_tr_b16 v[34:35], v5 offset:27200
    v_mfma_f32_16x16x32_bf16 v[168:171], v[40:43], v[52:55], v[168:171]
    ds_read_b64_tr_b16 v[36:37], v5 offset:7264
    buffer_load_dwordx4 v[52:55], v7, s[12:15], s42 offen sc1
    v_mfma_f32_16x16x32_bf16 v[176:179], v[40:43], v[56:59], v[176:179]
    ds_read_b64_tr_b16 v[38:39], v5 offset:10848
    buffer_load_dwordx4 v[56:59], v7, s[12:15], s42 offen offset:1024 sc1
    s_waitcnt vmcnt(5) lgkmcnt(10)
    v_mfma_f32_16x16x32_bf16 v[68:71], v[44:47], v[60:63], v[68:71]
    ds_read_b64_tr_b16 v[40:41], v5 offset:23648
    s_waitcnt vmcnt(4)
    v_mfma_f32_16x16x32_bf16 v[76:79], v[44:47], v[64:67], v[76:79]
    ds_read_b64_tr_b16 v[42:43], v5 offset:27232
    s_add_u32 m0, s40, 68608
    v_mfma_f32_16x16x32_bf16 v[72:75], v[48:51], v[60:63], v[72:75]
    buffer_load_dwordx4 v4, s[8:11], s41 offen lds
    ds_read_b64_tr_b16 v[44:45], v5 offset:7296
    v_mfma_f32_16x16x32_bf16 v[80:83], v[48:51], v[64:67], v[80:83]
    ds_read_b64_tr_b16 v[46:47], v5 offset:10880
    s_waitcnt lgkmcnt(10)
    v_mfma_f32_16x16x32_bf16 v[84:87], v[20:23], v[60:63], v[84:87]
    ds_read_b64_tr_b16 v[48:49], v5 offset:23680
    v_mfma_f32_16x16x32_bf16 v[92:95], v[20:23], v[64:67], v[92:95]
    ds_read_b64_tr_b16 v[50:51], v5 offset:27264
    v_mfma_f32_16x16x32_bf16 v[88:91], v[24:27], v[60:63], v[88:91]
    ds_read_b64_tr_b16 v[20:21], v5 offset:7328
    v_mfma_f32_16x16x32_bf16 v[96:99], v[24:27], v[64:67], v[96:99]
    ds_read_b64_tr_b16 v[22:23], v5 offset:10912
    s_waitcnt lgkmcnt(10)
    v_mfma_f32_16x16x32_bf16 v[100:103], v[28:31], v[60:63], v[100:103]
    ds_read_b64_tr_b16 v[24:25], v5 offset:23712
    v_mfma_f32_16x16x32_bf16 v[108:111], v[28:31], v[64:67], v[108:111]
    ds_read_b64_tr_b16 v[26:27], v5 offset:27296
    v_mfma_f32_16x16x32_bf16 v[104:107], v[32:35], v[60:63], v[104:107]
    ds_read_b64_tr_b16 v[28:29], v5 offset:7360
    v_mfma_f32_16x16x32_bf16 v[112:115], v[32:35], v[64:67], v[112:115]
    ds_read_b64_tr_b16 v[30:31], v5 offset:10944
    s_waitcnt lgkmcnt(10)
    v_mfma_f32_16x16x32_bf16 v[116:119], v[36:39], v[60:63], v[116:119]
    ds_read_b64_tr_b16 v[32:33], v5 offset:23744
    v_mfma_f32_16x16x32_bf16 v[124:127], v[36:39], v[64:67], v[124:127]
    ds_read_b64_tr_b16 v[34:35], v5 offset:27328
    v_mfma_f32_16x16x32_bf16 v[120:123], v[40:43], v[60:63], v[120:123]
    s_waitcnt vmcnt(8)
    s_barrier
    s_add_u32 s41, s41, 458752
    ds_read_b64_tr_b16 v[36:37], v5 offset:32768
    v_mfma_f32_16x16x32_bf16 v[128:131], v[40:43], v[64:67], v[128:131]
    ds_read_b64_tr_b16 v[38:39], v5 offset:36352
    s_waitcnt lgkmcnt(10)
    s_add_u32 m0, s40, 98304
    v_mfma_f32_16x16x32_bf16 v[132:135], v[44:47], v[60:63], v[132:135]
    buffer_load_dwordx4 v1, s[8:11], s41 offen lds
    ds_read_b64_tr_b16 v[40:41], v5 offset:49152
    v_mfma_f32_16x16x32_bf16 v[140:143], v[44:47], v[64:67], v[140:143]
    ds_read_b64_tr_b16 v[42:43], v5 offset:52736
    v_mfma_f32_16x16x32_bf16 v[136:139], v[48:51], v[60:63], v[136:139]
    ds_read_b64_tr_b16 v[44:45], v5 offset:32800
    v_mfma_f32_16x16x32_bf16 v[144:147], v[48:51], v[64:67], v[144:147]
    ds_read_b64_tr_b16 v[46:47], v5 offset:36384
    s_waitcnt lgkmcnt(10)
    v_mfma_f32_16x16x32_bf16 v[148:151], v[20:23], v[60:63], v[148:151]
    ds_read_b64_tr_b16 v[48:49], v5 offset:49184
    v_mfma_f32_16x16x32_bf16 v[156:159], v[20:23], v[64:67], v[156:159]
    ds_read_b64_tr_b16 v[50:51], v5 offset:52768
    v_mfma_f32_16x16x32_bf16 v[152:155], v[24:27], v[60:63], v[152:155]
    ds_read_b64_tr_b16 v[20:21], v5 offset:32832
    v_mfma_f32_16x16x32_bf16 v[160:163], v[24:27], v[64:67], v[160:163]
    ds_read_b64_tr_b16 v[22:23], v5 offset:36416
    s_waitcnt lgkmcnt(10)
    v_mfma_f32_16x16x32_bf16 v[164:167], v[28:31], v[60:63], v[164:167]
    ds_read_b64_tr_b16 v[24:25], v5 offset:49216
    v_mfma_f32_16x16x32_bf16 v[172:175], v[28:31], v[64:67], v[172:175]
    ds_read_b64_tr_b16 v[26:27], v5 offset:52800
    v_mfma_f32_16x16x32_bf16 v[168:171], v[32:35], v[60:63], v[168:171]
    ds_read_b64_tr_b16 v[28:29], v5 offset:32864
    buffer_load_dwordx4 v[60:63], v7, s[12:15], s42 offen offset:2048 sc1
    v_mfma_f32_16x16x32_bf16 v[176:179], v[32:35], v[64:67], v[176:179]
    ds_read_b64_tr_b16 v[30:31], v5 offset:36448
    buffer_load_dwordx4 v[64:67], v7, s[12:15], s42 offen offset:3072 sc1
    s_waitcnt vmcnt(5) lgkmcnt(10)
    v_mfma_f32_16x16x32_bf16 v[68:71], v[36:39], v[52:55], v[68:71]
    s_add_u32 s42, s42, 4096
    ds_read_b64_tr_b16 v[32:33], v5 offset:49248
    s_waitcnt vmcnt(4)
    v_mfma_f32_16x16x32_bf16 v[76:79], v[36:39], v[56:59], v[76:79]
    ds_read_b64_tr_b16 v[34:35], v5 offset:52832
    s_add_u32 m0, s40, 99328
    v_mfma_f32_16x16x32_bf16 v[72:75], v[40:43], v[52:55], v[72:75]
    buffer_load_dwordx4 v2, s[8:11], s41 offen lds
s_cmp_lg_u32 s42, s47
    s_cbranch_scc1 pu_wb2
    buffer_load_dwordx4 v[244:247], v7, s[88:91], s44 offen offset:0
    buffer_load_dwordx4 v[244:247], v7, s[88:91], s44 offen offset:1024
    buffer_load_dwordx4 v[244:247], v7, s[88:91], s44 offen offset:2048
    buffer_load_dwordx4 v[244:247], v7, s[88:91], s44 offen offset:3072
    buffer_load_dwordx4 v[244:247], v7, s[88:91], s46 offen offset:0
    buffer_load_dwordx4 v[244:247], v7, s[88:91], s46 offen offset:1024
    buffer_load_dwordx4 v[244:247], v7, s[88:91], s46 offen offset:2048
pu_wb2:
    ds_read_b64_tr_b16 v[36:37], v5 offset:32896
    v_mfma_f32_16x16x32_bf16 v[80:83], v[40:43], v[56:59], v[80:83]
    ds_read_b64_tr_b16 v[38:39], v5 offset:36480
    s_waitcnt lgkmcnt(10)
    v_mfma_f32_16x16x32_bf16 v[84:87], v[44:47], v[52:55], v[84:87]
    ds_read_b64_tr_b16 v[40:41], v5 offset:49280
    v_mfma_f32_16x16x32_bf16 v[92:95], v[44:47], v[56:59], v[92:95]
    ds_read_b64_tr_b16 v[42:43], v5 offset:52864
    v_mfma_f32_16x16x32_bf16 v[88:91], v[48:51], v[52:55], v[88:91]
    ds_read_b64_tr_b16 v[44:45], v5 offset:32928
    v_mfma_f32_16x16x32_bf16 v[96:99], v[48:51], v[56:59], v[96:99]
    ds_read_b64_tr_b16 v[46:47], v5 offset:36512
    s_waitcnt lgkmcnt(10)
    v_mfma_f32_16x16x32_bf16 v[100:103], v[20:23], v[52:55], v[100:103]
    ds_read_b64_tr_b16 v[48:49], v5 offset:49312
    v_mfma_f32_16x16x32_bf16 v[108:111], v[20:23], v[56:59], v[108:111]
    ds_read_b64_tr_b16 v[50:51], v5 offset:52896
    v_mfma_f32_16x16x32_bf16 v[104:107], v[24:27], v[52:55], v[104:107]
    ds_read_b64_tr_b16 v[20:21], v5 offset:32960
    v_mfma_f32_16x16x32_bf16 v[112:115], v[24:27], v[56:59], v[112:115]
    ds_read_b64_tr_b16 v[22:23], v5 offset:36544
    s_waitcnt lgkmcnt(10)
    v_mfma_f32_16x16x32_bf16 v[116:119], v[28:31], v[52:55], v[116:119]
    ds_read_b64_tr_b16 v[24:25], v5 offset:49344
    v_mfma_f32_16x16x32_bf16 v[124:127], v[28:31], v[56:59], v[124:127]
    ds_read_b64_tr_b16 v[26:27], v5 offset:52928
    v_mfma_f32_16x16x32_bf16 v[120:123], v[32:35], v[52:55], v[120:123]
    ds_read_b64_tr_b16 v[28:29], v5 offset:39936
    v_mfma_f32_16x16x32_bf16 v[128:131], v[32:35], v[56:59], v[128:131]
    ds_read_b64_tr_b16 v[30:31], v5 offset:43520
    s_waitcnt lgkmcnt(10)
    s_add_u32 m0, s40, 100352
    v_mfma_f32_16x16x32_bf16 v[132:135], v[36:39], v[52:55], v[132:135]
    buffer_load_dwordx4 v3, s[8:11], s41 offen lds
    ds_read_b64_tr_b16 v[32:33], v5 offset:56320
    v_mfma_f32_16x16x32_bf16 v[140:143], v[36:39], v[56:59], v[140:143]
    ds_read_b64_tr_b16 v[34:35], v5 offset:59904
    v_mfma_f32_16x16x32_bf16 v[136:139], v[40:43], v[52:55], v[136:139]
    ds_read_b64_tr_b16 v[36:37], v5 offset:39968
    v_mfma_f32_16x16x32_bf16 v[144:147], v[40:43], v[56:59], v[144:147]
    ds_read_b64_tr_b16 v[38:39], v5 offset:43552
    s_waitcnt lgkmcnt(10)
    v_mfma_f32_16x16x32_bf16 v[148:151], v[44:47], v[52:55], v[148:151]
    ds_read_b64_tr_b16 v[40:41], v5 offset:56352
    v_mfma_f32_16x16x32_bf16 v[156:159], v[44:47], v[56:59], v[156:159]
    ds_read_b64_tr_b16 v[42:43], v5 offset:59936
    v_mfma_f32_16x16x32_bf16 v[152:155], v[48:51], v[52:55], v[152:155]
    ds_read_b64_tr_b16 v[44:45], v5 offset:40000
    v_mfma_f32_16x16x32_bf16 v[160:163], v[48:51], v[56:59], v[160:163]
    ds_read_b64_tr_b16 v[46:47], v5 offset:43584
    s_waitcnt lgkmcnt(10)
    v_mfma_f32_16x16x32_bf16 v[164:167], v[20:23], v[52:55], v[164:167]
    ds_read_b64_tr_b16 v[48:49], v5 offset:56384
    v_mfma_f32_16x16x32_bf16 v[172:175], v[20:23], v[56:59], v[172:175]
    ds_read_b64_tr_b16 v[50:51], v5 offset:59968
    v_mfma_f32_16x16x32_bf16 v[168:171], v[24:27], v[52:55], v[168:171]
    ds_read_b64_tr_b16 v[20:21], v5 offset:40032
    buffer_load_dwordx4 v[52:55], v7, s[12:15], s42 offen sc1
    v_mfma_f32_16x16x32_bf16 v[176:179], v[24:27], v[56:59], v[176:179]
    ds_read_b64_tr_b16 v[22:23], v5 offset:43616
    buffer_load_dwordx4 v[56:59], v7, s[12:15], s42 offen offset:1024 sc1
    s_waitcnt vmcnt(5) lgkmcnt(10)
    v_mfma_f32_16x16x32_bf16 v[68:71], v[28:31], v[60:63], v[68:71]
    ds_read_b64_tr_b16 v[24:25], v5 offset:56416
    s_waitcnt vmcnt(4)
    v_mfma_f32_16x16x32_bf16 v[76:79], v[28:31], v[64:67], v[76:79]
    ds_read_b64_tr_b16 v[26:27], v5 offset:60000
    s_add_u32 m0, s40, 101376
    v_mfma_f32_16x16x32_bf16 v[72:75], v[32:35], v[60:63], v[72:75]
    buffer_load_dwordx4 v4, s[8:11], s41 offen lds
    ds_read_b64_tr_b16 v[28:29], v5 offset:40064
    v_mfma_f32_16x16x32_bf16 v[80:83], v[32:35], v[64:67], v[80:83]
    ds_read_b64_tr_b16 v[30:31], v5 offset:43648
    s_waitcnt lgkmcnt(10)
    v_mfma_f32_16x16x32_bf16 v[84:87], v[36:39], v[60:63], v[84:87]
    ds_read_b64_tr_b16 v[32:33], v5 offset:56448
    v_mfma_f32_16x16x32_bf16 v[92:95], v[36:39], v[64:67], v[92:95]
    ds_read_b64_tr_b16 v[34:35], v5 offset:60032
    v_mfma_f32_16x16x32_bf16 v[88:91], v[40:43], v[60:63], v[88:91]
    ds_read_b64_tr_b16 v[36:37], v5 offset:40096
    v_mfma_f32_16x16x32_bf16 v[96:99], v[40:43], v[64:67], v[96:99]
    ds_read_b64_tr_b16 v[38:39], v5 offset:43680
    s_waitcnt lgkmcnt(10)
    v_mfma_f32_16x16x32_bf16 v[100:103], v[44:47], v[60:63], v[100:103]
    ds_read_b64_tr_b16 v[40:41], v5 offset:56480
    v_mfma_f32_16x16x32_bf16 v[108:111], v[44:47], v[64:67], v[108:111]
    ds_read_b64_tr_b16 v[42:43], v5 offset:60064
    v_mfma_f32_16x16x32_bf16 v[104:107], v[48:51], v[60:63], v[104:107]
    ds_read_b64_tr_b16 v[44:45], v5 offset:40128
    v_mfma_f32_16x16x32_bf16 v[112:115], v[48:51], v[64:67], v[112:115]
    ds_read_b64_tr_b16 v[46:47], v5 offset:43712
    s_waitcnt lgkmcnt(10)
    v_mfma_f32_16x16x32_bf16 v[116:119], v[20:23], v[60:63], v[116:119]
    ds_read_b64_tr_b16 v[48:49], v5 offset:56512
    v_mfma_f32_16x16x32_bf16 v[124:127], v[20:23], v[64:67], v[124:127]
    ds_read_b64_tr_b16 v[50:51], v5 offset:60096
    v_mfma_f32_16x16x32_bf16 v[120:123], v[24:27], v[60:63], v[120:123]
    s_waitcnt vmcnt(8)
    s_barrier
    s_add_u32 s41, s41, 458752
    ds_read_b64_tr_b16 v[20:21], v6 offset:0
    v_mfma_f32_16x16x32_bf16 v[128:131], v[24:27], v[64:67], v[128:131]
    ds_read_b64_tr_b16 v[22:23], v6 offset:3584
    s_waitcnt lgkmcnt(10)
    s_add_u32 m0, s40, 0
    v_mfma_f32_16x16x32_bf16 v[132:135], v[28:31], v[60:63], v[132:135]
    buffer_load_dwordx4 v1, s[8:11], s41 offen lds
    ds_read_b64_tr_b16 v[24:25], v6 offset:16384
    v_mfma_f32_16x16x32_bf16 v[140:143], v[28:31], v[64:67], v[140:143]
    ds_read_b64_tr_b16 v[26:27], v6 offset:19968
    v_mfma_f32_16x16x32_bf16 v[136:139], v[32:35], v[60:63], v[136:139]
    ds_read_b64_tr_b16 v[28:29], v6 offset:32
    v_mfma_f32_16x16x32_bf16 v[144:147], v[32:35], v[64:67], v[144:147]
    ds_read_b64_tr_b16 v[30:31], v6 offset:3616
    s_waitcnt lgkmcnt(10)
    v_mfma_f32_16x16x32_bf16 v[148:151], v[36:39], v[60:63], v[148:151]
    ds_read_b64_tr_b16 v[32:33], v6 offset:16416
    v_mfma_f32_16x16x32_bf16 v[156:159], v[36:39], v[64:67], v[156:159]
    ds_read_b64_tr_b16 v[34:35], v6 offset:20000
    v_mfma_f32_16x16x32_bf16 v[152:155], v[40:43], v[60:63], v[152:155]
    ds_read_b64_tr_b16 v[36:37], v6 offset:64
    v_mfma_f32_16x16x32_bf16 v[160:163], v[40:43], v[64:67], v[160:163]
    ds_read_b64_tr_b16 v[38:39], v6 offset:3648
    s_waitcnt lgkmcnt(10)
    v_mfma_f32_16x16x32_bf16 v[164:167], v[44:47], v[60:63], v[164:167]
    ds_read_b64_tr_b16 v[40:41], v6 offset:16448
    v_mfma_f32_16x16x32_bf16 v[172:175], v[44:47], v[64:67], v[172:175]
    ds_read_b64_tr_b16 v[42:43], v6 offset:20032
    v_mfma_f32_16x16x32_bf16 v[168:171], v[48:51], v[60:63], v[168:171]
    ds_read_b64_tr_b16 v[44:45], v6 offset:96
    buffer_load_dwordx4 v[60:63], v7, s[12:15], s42 offen offset:2048 sc1
    v_mfma_f32_16x16x32_bf16 v[176:179], v[48:51], v[64:67], v[176:179]
    ds_read_b64_tr_b16 v[46:47], v6 offset:3680
    buffer_load_dwordx4 v[64:67], v7, s[12:15], s42 offen offset:3072 sc1
    s_waitcnt vmcnt(5) lgkmcnt(10)
    v_mfma_f32_16x16x32_bf16 v[68:71], v[20:23], v[52:55], v[68:71]
    s_add_u32 s42, s42, 4096
    ds_read_b64_tr_b16 v[48:49], v6 offset:16480
    s_waitcnt vmcnt(4)
    v_mfma_f32_16x16x32_bf16 v[76:79], v[20:23], v[56:59], v[76:79]
    ds_read_b64_tr_b16 v[50:51], v6 offset:20064
    s_add_u32 m0, s40, 1024
    v_mfma_f32_16x16x32_bf16 v[72:75], v[24:27], v[52:55], v[72:75]
    buffer_load_dwordx4 v2, s[8:11], s41 offen lds
s_cmp_lg_u32 s42, s47
    s_cbranch_scc1 pu_wb3
    buffer_load_dwordx4 v[244:247], v7, s[88:91], s44 offen offset:0
    buffer_load_dwordx4 v[244:247], v7, s[88:91], s44 offen offset:1024
    buffer_load_dwordx4 v[244:247], v7, s[88:91], s44 offen offset:2048
    buffer_load_dwordx4 v[244:247], v7, s[88:91], s44 offen offset:3072
    buffer_load_dwordx4 v[244:247], v7, s[88:91], s46 offen offset:0
    buffer_load_dwordx4 v[244:247], v7, s[88:91], s46 offen offset:1024
    buffer_load_dwordx4 v[244:247], v7, s[88:91], s46 offen offset:2048
pu_wb3:
    ds_read_b64_tr_b16 v[20:21], v6 offset:128
    v_mfma_f32_16x16x32_bf16 v[80:83], v[24:27], v[56:59], v[80:83]
    ds_read_b64_tr_b16 v[22:23], v6 offset:3712
    s_waitcnt lgkmcnt(10)
    v_mfma_f32_16x16x32_bf16 v[84:87], v[28:31], v[52:55], v[84:87]
    ds_read_b64_tr_b16 v[24:25], v6 offset:16512
    v_mfma_f32_16x16x32_bf16 v[92:95], v[28:31], v[56:59], v[92:95]
    ds_read_b64_tr_b16 v[26:27], v6 offset:20096
    v_mfma_f32_16x16x32_bf16 v[88:91], v[32:35], v[52:55], v[88:91]
    ds_read_b64_tr_b16 v[28:29], v6 offset:160
    v_mfma_f32_16x16x32_bf16 v[96:99], v[32:35], v[56:59], v[96:99]
    ds_read_b64_tr_b16 v[30:31], v6 offset:3744
    s_waitcnt lgkmcnt(10)
    v_mfma_f32_16x16x32_bf16 v[100:103], v[36:39], v[52:55], v[100:103]
    ds_read_b64_tr_b16 v[32:33], v6 offset:16544
    v_mfma_f32_16x16x32_bf16 v[108:111], v[36:39], v[56:59], v[108:111]
    ds_read_b64_tr_b16 v[34:35], v6 offset:20128
    v_mfma_f32_16x16x32_bf16 v[104:107], v[40:43], v[52:55], v[104:107]
    ds_read_b64_tr_b16 v[36:37], v6 offset:192
    v_mfma_f32_16x16x32_bf16 v[112:115], v[40:43], v[56:59], v[112:115]
    ds_read_b64_tr_b16 v[38:39], v6 offset:3776
    s_waitcnt lgkmcnt(10)
    v_mfma_f32_16x16x32_bf16 v[116:119], v[44:47], v[52:55], v[116:119]
    ds_read_b64_tr_b16 v[40:41], v6 offset:16576
    v_mfma_f32_16x16x32_bf16 v[124:127], v[44:47], v[56:59], v[124:127]
    ds_read_b64_tr_b16 v[42:43], v6 offset:20160
    v_mfma_f32_16x16x32_bf16 v[120:123], v[48:51], v[52:55], v[120:123]
    ds_read_b64_tr_b16 v[44:45], v6 offset:7168
    v_mfma_f32_16x16x32_bf16 v[128:131], v[48:51], v[56:59], v[128:131]
    ds_read_b64_tr_b16 v[46:47], v6 offset:10752
    s_waitcnt lgkmcnt(10)
    s_add_u32 m0, s40, 2048
    v_mfma_f32_16x16x32_bf16 v[132:135], v[20:23], v[52:55], v[132:135]
    buffer_load_dwordx4 v3, s[8:11], s41 offen lds
    ds_read_b64_tr_b16 v[48:49], v6 offset:23552
    v_mfma_f32_16x16x32_bf16 v[140:143], v[20:23], v[56:59], v[140:143]
    ds_read_b64_tr_b16 v[50:51], v6 offset:27136
    v_mfma_f32_16x16x32_bf16 v[136:139], v[24:27], v[52:55], v[136:139]
    ds_read_b64_tr_b16 v[20:21], v6 offset:7200
    v_mfma_f32_16x16x32_bf16 v[144:147], v[24:27], v[56:59], v[144:147]
    ds_read_b64_tr_b16 v[22:23], v6 offset:10784
    s_waitcnt lgkmcnt(10)
    v_mfma_f32_16x16x32_bf16 v[148:151], v[28:31], v[52:55], v[148:151]
    ds_read_b64_tr_b16 v[24:25], v6 offset:23584
    v_mfma_f32_16x16x32_bf16 v[156:159], v[28:31], v[56:59], v[156:159]
    ds_read_b64_tr_b16 v[26:27], v6 offset:27168
    v_mfma_f32_16x16x32_bf16 v[152:155], v[32:35], v[52:55], v[152:155]
    ds_read_b64_tr_b16 v[28:29], v6 offset:7232
    v_mfma_f32_16x16x32_bf16 v[160:163], v[32:35], v[56:59], v[160:163]
    ds_read_b64_tr_b16 v[30:31], v6 offset:10816
    s_waitcnt lgkmcnt(10)
    v_mfma_f32_16x16x32_bf16 v[164:167], v[36:39], v[52:55], v[164:167]
    ds_read_b64_tr_b16 v[32:33], v6 offset:23616
    v_mfma_f32_16x16x32_bf16 v[172:175], v[36:39], v[56:59], v[172:175]
    ds_read_b64_tr_b16 v[34:35], v6 offset:27200
    v_mfma_f32_16x16x32_bf16 v[168:171], v[40:43], v[52:55], v[168:171]
    ds_read_b64_tr_b16 v[36:37], v6 offset:7264
    buffer_load_dwordx4 v[52:55], v7, s[12:15], s42 offen sc1
    v_mfma_f32_16x16x32_bf16 v[176:179], v[40:43], v[56:59], v[176:179]
    ds_read_b64_tr_b16 v[38:39], v6 offset:10848
    buffer_load_dwordx4 v[56:59], v7, s[12:15], s42 offen offset:1024 sc1
    s_waitcnt vmcnt(5) lgkmcnt(10)
    v_mfma_f32_16x16x32_bf16 v[68:71], v[44:47], v[60:63], v[68:71]
    ds_read_b64_tr_b16 v[40:41], v6 offset:23648
    s_waitcnt vmcnt(4)
    v_mfma_f32_16x16x32_bf16 v[76:79], v[44:47], v[64:67], v[76:79]
    ds_read_b64_tr_b16 v[42:43], v6 offset:27232
    s_add_u32 m0, s40, 3072
    v_mfma_f32_16x16x32_bf16 v[72:75], v[48:51], v[60:63], v[72:75]
    buffer_load_dwordx4 v4, s[8:11], s41 offen lds
    ds_read_b64_tr_b16 v[44:45], v6 offset:7296
    v_mfma_f32_16x16x32_bf16 v[80:83], v[48:51], v[64:67], v[80:83]
    ds_read_b64_tr_b16 v[46:47], v6 offset:10880
    s_waitcnt lgkmcnt(10)
    v_mfma_f32_16x16x32_bf16 v[84:87], v[20:23], v[60:63], v[84:87]
    ds_read_b64_tr_b16 v[48:49], v6 offset:23680
    v_mfma_f32_16x16x32_bf16 v[92:95], v[20:23], v[64:67], v[92:95]
    ds_read_b64_tr_b16 v[50:51], v6 offset:27264
    v_mfma_f32_16x16x32_bf16 v[88:91], v[24:27], v[60:63], v[88:91]
    ds_read_b64_tr_b16 v[20:21], v6 offset:7328
    v_mfma_f32_16x16x32_bf16 v[96:99], v[24:27], v[64:67], v[96:99]
    ds_read_b64_tr_b16 v[22:23], v6 offset:10912
    s_waitcnt lgkmcnt(10)
    v_mfma_f32_16x16x32_bf16 v[100:103], v[28:31], v[60:63], v[100:103]
    ds_read_b64_tr_b16 v[24:25], v6 offset:23712
    v_mfma_f32_16x16x32_bf16 v[108:111], v[28:31], v[64:67], v[108:111]
    ds_read_b64_tr_b16 v[26:27], v6 offset:27296
    v_mfma_f32_16x16x32_bf16 v[104:107], v[32:35], v[60:63], v[104:107]
    ds_read_b64_tr_b16 v[28:29], v6 offset:7360
    v_mfma_f32_16x16x32_bf16 v[112:115], v[32:35], v[64:67], v[112:115]
    ds_read_b64_tr_b16 v[30:31], v6 offset:10944
    s_waitcnt lgkmcnt(10)
    v_mfma_f32_16x16x32_bf16 v[116:119], v[36:39], v[60:63], v[116:119]
    ds_read_b64_tr_b16 v[32:33], v6 offset:23744
    v_mfma_f32_16x16x32_bf16 v[124:127], v[36:39], v[64:67], v[124:127]
    ds_read_b64_tr_b16 v[34:35], v6 offset:27328
    v_mfma_f32_16x16x32_bf16 v[120:123], v[40:43], v[60:63], v[120:123]
    s_waitcnt vmcnt(8)
    s_barrier
    s_add_u32 s41, s41, 458752
    ds_read_b64_tr_b16 v[36:37], v6 offset:32768
    v_mfma_f32_16x16x32_bf16 v[128:131], v[40:43], v[64:67], v[128:131]
    ds_read_b64_tr_b16 v[38:39], v6 offset:36352
    s_waitcnt lgkmcnt(10)
    s_add_u32 m0, s40, 32768
    v_mfma_f32_16x16x32_bf16 v[132:135], v[44:47], v[60:63], v[132:135]
    buffer_load_dwordx4 v1, s[8:11], s41 offen lds
    ds_read_b64_tr_b16 v[40:41], v6 offset:49152
    v_mfma_f32_16x16x32_bf16 v[140:143], v[44:47], v[64:67], v[140:143]
    ds_read_b64_tr_b16 v[42:43], v6 offset:52736
    v_mfma_f32_16x16x32_bf16 v[136:139], v[48:51], v[60:63], v[136:139]
    ds_read_b64_tr_b16 v[44:45], v6 offset:32800
    v_mfma_f32_16x16x32_bf16 v[144:147], v[48:51], v[64:67], v[144:147]
    ds_read_b64_tr_b16 v[46:47], v6 offset:36384
    s_waitcnt lgkmcnt(10)
    v_mfma_f32_16x16x32_bf16 v[148:151], v[20:23], v[60:63], v[148:151]
    ds_read_b64_tr_b16 v[48:49], v6 offset:49184
    v_mfma_f32_16x16x32_bf16 v[156:159], v[20:23], v[64:67], v[156:159]
    ds_read_b64_tr_b16 v[50:51], v6 offset:52768
    v_mfma_f32_16x16x32_bf16 v[152:155], v[24:27], v[60:63], v[152:155]
    ds_read_b64_tr_b16 v[20:21], v6 offset:32832
    v_mfma_f32_16x16x32_bf16 v[160:163], v[24:27], v[64:67], v[160:163]
    ds_read_b64_tr_b16 v[22:23], v6 offset:36416
    s_waitcnt lgkmcnt(10)
    v_mfma_f32_16x16x32_bf16 v[164:167], v[28:31], v[60:63], v[164:167]
    ds_read_b64_tr_b16 v[24:25], v6 offset:49216
    v_mfma_f32_16x16x32_bf16 v[172:175], v[28:31], v[64:67], v[172:175]
    ds_read_b64_tr_b16 v[26:27], v6 offset:52800
    v_mfma_f32_16x16x32_bf16 v[168:171], v[32:35], v[60:63], v[168:171]
    ds_read_b64_tr_b16 v[28:29], v6 offset:32864
    buffer_load_dwordx4 v[60:63], v7, s[12:15], s42 offen offset:2048 sc1
    v_mfma_f32_16x16x32_bf16 v[176:179], v[32:35], v[64:67], v[176:179]
    ds_read_b64_tr_b16 v[30:31], v6 offset:36448
    buffer_load_dwordx4 v[64:67], v7, s[12:15], s42 offen offset:3072 sc1
    s_waitcnt vmcnt(5) lgkmcnt(10)
    v_mfma_f32_16x16x32_bf16 v[68:71], v[36:39], v[52:55], v[68:71]
    s_add_u32 s42, s42, 4096
    ds_read_b64_tr_b16 v[32:33], v6 offset:49248
    s_waitcnt vmcnt(4)
    v_mfma_f32_16x16x32_bf16 v[76:79], v[36:39], v[56:59], v[76:79]
    ds_read_b64_tr_b16 v[34:35], v6 offset:52832
    s_add_u32 m0, s40, 33792
    v_mfma_f32_16x16x32_bf16 v[72:75], v[40:43], v[52:55], v[72:75]
    buffer_load_dwordx4 v2, s[8:11], s41 offen lds
s_cmp_lg_u32 s42, s47
    s_cbranch_scc1 pu_wb0
    buffer_load_dwordx4 v[244:247], v7, s[88:91], s44 offen offset:0
    buffer_load_dwordx4 v[244:247], v7, s[88:91], s44 offen offset:1024
    buffer_load_dwordx4 v[244:247], v7, s[88:91], s44 offen offset:2048
    buffer_load_dwordx4 v[244:247], v7, s[88:91], s44 offen offset:3072
    buffer_load_dwordx4 v[244:247], v7, s[88:91], s46 offen offset:0
    buffer_load_dwordx4 v[244:247], v7, s[88:91], s46 offen offset:1024
    buffer_load_dwordx4 v[244:247], v7, s[88:91], s46 offen offset:2048
pu_wb0:
    ds_read_b64_tr_b16 v[36:37], v6 offset:32896
    v_mfma_f32_16x16x32_bf16 v[80:83], v[40:43], v[56:59], v[80:83]
    ds_read_b64_tr_b16 v[38:39], v6 offset:36480
    s_waitcnt lgkmcnt(10)
    v_mfma_f32_16x16x32_bf16 v[84:87], v[44:47], v[52:55], v[84:87]
    ds_read_b64_tr_b16 v[40:41], v6 offset:49280
    v_mfma_f32_16x16x32_bf16 v[92:95], v[44:47], v[56:59], v[92:95]
    ds_read_b64_tr_b16 v[42:43], v6 offset:52864
    v_mfma_f32_16x16x32_bf16 v[88:91], v[48:51], v[52:55], v[88:91]
    ds_read_b64_tr_b16 v[44:45], v6 offset:32928
    v_mfma_f32_16x16x32_bf16 v[96:99], v[48:51], v[56:59], v[96:99]
    ds_read_b64_tr_b16 v[46:47], v6 offset:36512
    s_waitcnt lgkmcnt(10)
    v_mfma_f32_16x16x32_bf16 v[100:103], v[20:23], v[52:55], v[100:103]
    ds_read_b64_tr_b16 v[48:49], v6 offset:49312
    v_mfma_f32_16x16x32_bf16 v[108:111], v[20:23], v[56:59], v[108:111]
    ds_read_b64_tr_b16 v[50:51], v6 offset:52896
    v_mfma_f32_16x16x32_bf16 v[104:107], v[24:27], v[52:55], v[104:107]
    ds_read_b64_tr_b16 v[20:21], v6 offset:32960
    v_mfma_f32_16x16x32_bf16 v[112:115], v[24:27], v[56:59], v[112:115]
    ds_read_b64_tr_b16 v[22:23], v6 offset:36544
    s_waitcnt lgkmcnt(10)
    v_mfma_f32_16x16x32_bf16 v[116:119], v[28:31], v[52:55], v[116:119]
    ds_read_b64_tr_b16 v[24:25], v6 offset:49344
    v_mfma_f32_16x16x32_bf16 v[124:127], v[28:31], v[56:59], v[124:127]
    ds_read_b64_tr_b16 v[26:27], v6 offset:52928
    v_mfma_f32_16x16x32_bf16 v[120:123], v[32:35], v[52:55], v[120:123]
    ds_read_b64_tr_b16 v[28:29], v6 offset:39936
    v_mfma_f32_16x16x32_bf16 v[128:131], v[32:35], v[56:59], v[128:131]
    ds_read_b64_tr_b16 v[30:31], v6 offset:43520
    s_waitcnt lgkmcnt(10)
    s_add_u32 m0, s40, 34816
    v_mfma_f32_16x16x32_bf16 v[132:135], v[36:39], v[52:55], v[132:135]
    buffer_load_dwordx4 v3, s[8:11], s41 offen lds
    ds_read_b64_tr_b16 v[32:33], v6 offset:56320
    v_mfma_f32_16x16x32_bf16 v[140:143], v[36:39], v[56:59], v[140:143]
    ds_read_b64_tr_b16 v[34:35], v6 offset:59904
    v_mfma_f32_16x16x32_bf16 v[136:139], v[40:43], v[52:55], v[136:139]
    ds_read_b64_tr_b16 v[36:37], v6 offset:39968
    v_mfma_f32_16x16x32_bf16 v[144:147], v[40:43], v[56:59], v[144:147]
    ds_read_b64_tr_b16 v[38:39], v6 offset:43552
    s_waitcnt lgkmcnt(10)
    v_mfma_f32_16x16x32_bf16 v[148:151], v[44:47], v[52:55], v[148:151]
    ds_read_b64_tr_b16 v[40:41], v6 offset:56352
    v_mfma_f32_16x16x32_bf16 v[156:159], v[44:47], v[56:59], v[156:159]
    ds_read_b64_tr_b16 v[42:43], v6 offset:59936
    v_mfma_f32_16x16x32_bf16 v[152:155], v[48:51], v[52:55], v[152:155]
    ds_read_b64_tr_b16 v[44:45], v6 offset:40000
    v_mfma_f32_16x16x32_bf16 v[160:163], v[48:51], v[56:59], v[160:163]
    ds_read_b64_tr_b16 v[46:47], v6 offset:43584
    s_waitcnt lgkmcnt(10)
    v_mfma_f32_16x16x32_bf16 v[164:167], v[20:23], v[52:55], v[164:167]
    ds_read_b64_tr_b16 v[48:49], v6 offset:56384
    v_mfma_f32_16x16x32_bf16 v[172:175], v[20:23], v[56:59], v[172:175]
    ds_read_b64_tr_b16 v[50:51], v6 offset:59968
    v_mfma_f32_16x16x32_bf16 v[168:171], v[24:27], v[52:55], v[168:171]
    ds_read_b64_tr_b16 v[20:21], v6 offset:40032
    buffer_load_dwordx4 v[52:55], v7, s[12:15], s42 offen sc1
    v_mfma_f32_16x16x32_bf16 v[176:179], v[24:27], v[56:59], v[176:179]
    ds_read_b64_tr_b16 v[22:23], v6 offset:43616
    buffer_load_dwordx4 v[56:59], v7, s[12:15], s42 offen offset:1024 sc1
    s_waitcnt vmcnt(5) lgkmcnt(10)
    v_mfma_f32_16x16x32_bf16 v[68:71], v[28:31], v[60:63], v[68:71]
    ds_read_b64_tr_b16 v[24:25], v6 offset:56416
    s_waitcnt vmcnt(4)
    v_mfma_f32_16x16x32_bf16 v[76:79], v[28:31], v[64:67], v[76:79]
    ds_read_b64_tr_b16 v[26:27], v6 offset:60000
    s_add_u32 m0, s40, 35840
    v_mfma_f32_16x16x32_bf16 v[72:75], v[32:35], v[60:63], v[72:75]
    buffer_load_dwordx4 v4, s[8:11], s41 offen lds
    ds_read_b64_tr_b16 v[28:29], v6 offset:40064
    v_mfma_f32_16x16x32_bf16 v[80:83], v[32:35], v[64:67], v[80:83]
    ds_read_b64_tr_b16 v[30:31], v6 offset:43648
    s_waitcnt lgkmcnt(10)
    v_mfma_f32_16x16x32_bf16 v[84:87], v[36:39], v[60:63], v[84:87]
    ds_read_b64_tr_b16 v[32:33], v6 offset:56448
    v_mfma_f32_16x16x32_bf16 v[92:95], v[36:39], v[64:67], v[92:95]
    ds_read_b64_tr_b16 v[34:35], v6 offset:60032
    v_mfma_f32_16x16x32_bf16 v[88:91], v[40:43], v[60:63], v[88:91]
    ds_read_b64_tr_b16 v[36:37], v6 offset:40096
    v_mfma_f32_16x16x32_bf16 v[96:99], v[40:43], v[64:67], v[96:99]
    ds_read_b64_tr_b16 v[38:39], v6 offset:43680
    s_waitcnt lgkmcnt(10)
    v_mfma_f32_16x16x32_bf16 v[100:103], v[44:47], v[60:63], v[100:103]
    ds_read_b64_tr_b16 v[40:41], v6 offset:56480
    v_mfma_f32_16x16x32_bf16 v[108:111], v[44:47], v[64:67], v[108:111]
    ds_read_b64_tr_b16 v[42:43], v6 offset:60064
    v_mfma_f32_16x16x32_bf16 v[104:107], v[48:51], v[60:63], v[104:107]
    ds_read_b64_tr_b16 v[44:45], v6 offset:40128
    v_mfma_f32_16x16x32_bf16 v[112:115], v[48:51], v[64:67], v[112:115]
    ds_read_b64_tr_b16 v[46:47], v6 offset:43712
    s_waitcnt lgkmcnt(10)
    v_mfma_f32_16x16x32_bf16 v[116:119], v[20:23], v[60:63], v[116:119]
    ds_read_b64_tr_b16 v[48:49], v6 offset:56512
    v_mfma_f32_16x16x32_bf16 v[124:127], v[20:23], v[64:67], v[124:127]
    ds_read_b64_tr_b16 v[50:51], v6 offset:60096
    v_mfma_f32_16x16x32_bf16 v[120:123], v[24:27], v[60:63], v[120:123]
    s_waitcnt vmcnt(8)
    s_barrier
    s_add_u32 s41, s41, 458752
    ds_read_b64_tr_b16 v[20:21], v5 offset:0
    v_mfma_f32_16x16x32_bf16 v[128:131], v[24:27], v[64:67], v[128:131]
    ds_read_b64_tr_b16 v[22:23], v5 offset:3584
    s_waitcnt lgkmcnt(10)
    s_add_u32 m0, s40, 65536
    v_mfma_f32_16x16x32_bf16 v[132:135], v[28:31], v[60:63], v[132:135]
    buffer_load_dwordx4 v1, s[8:11], s41 offen lds
    ds_read_b64_tr_b16 v[24:25], v5 offset:16384
    v_mfma_f32_16x16x32_bf16 v[140:143], v[28:31], v[64:67], v[140:143]
    ds_read_b64_tr_b16 v[26:27], v5 offset:19968
    v_mfma_f32_16x16x32_bf16 v[136:139], v[32:35], v[60:63], v[136:139]
    ds_read_b64_tr_b16 v[28:29], v5 offset:32
    v_mfma_f32_16x16x32_bf16 v[144:147], v[32:35], v[64:67], v[144:147]
    ds_read_b64_tr_b16 v[30:31], v5 offset:3616
    s_waitcnt lgkmcnt(10)
    v_mfma_f32_16x16x32_bf16 v[148:151], v[36:39], v[60:63], v[148:151]
    ds_read_b64_tr_b16 v[32:33], v5 offset:16416
    v_mfma_f32_16x16x32_bf16 v[156:159], v[36:39], v[64:67], v[156:159]
    ds_read_b64_tr_b16 v[34:35], v5 offset:20000
    v_mfma_f32_16x16x32_bf16 v[152:155], v[40:43], v[60:63], v[152:155]
    ds_read_b64_tr_b16 v[36:37], v5 offset:64
    v_mfma_f32_16x16x32_bf16 v[160:163], v[40:43], v[64:67], v[160:163]
    ds_read_b64_tr_b16 v[38:39], v5 offset:3648
    s_waitcnt lgkmcnt(10)
    v_mfma_f32_16x16x32_bf16 v[164:167], v[44:47], v[60:63], v[164:167]
    ds_read_b64_tr_b16 v[40:41], v5 offset:16448
    v_mfma_f32_16x16x32_bf16 v[172:175], v[44:47], v[64:67], v[172:175]
    ds_read_b64_tr_b16 v[42:43], v5 offset:20032
    v_mfma_f32_16x16x32_bf16 v[168:171], v[48:51], v[60:63], v[168:171]
    ds_read_b64_tr_b16 v[44:45], v5 offset:96
    buffer_load_dwordx4 v[60:63], v7, s[12:15], s42 offen offset:2048 sc1
    v_mfma_f32_16x16x32_bf16 v[176:179], v[48:51], v[64:67], v[176:179]
    ds_read_b64_tr_b16 v[46:47], v5 offset:3680
    buffer_load_dwordx4 v[64:67], v7, s[12:15], s42 offen offset:3072 sc1
    s_sub_u32 s43, s43, 1
    s_add_u32 s31, s30, 1
    s_cmp_lg_u32 s43, s31
    s_cbranch_scc1 pu_nold
    buffer_load_dwordx4 v[180:183], v7, s[20:23], 0 offen offset:0 sc1
    buffer_load_dwordx4 v[184:187], v7, s[20:23], 0 offen offset:1024 sc1
    buffer_load_dwordx4 v[188:191], v7, s[20:23], 0 offen offset:2048 sc1
    buffer_load_dwordx4 v[192:195], v7, s[20:23], 0 offen offset:3072 sc1
pu_nold:
    s_cmp_lg_u32 s43, s30
    s_cbranch_scc1 pu_nofix
    ds_read_b32 v196, v13 offset:0
    ds_read_b32 v200, v13 offset:256
    ds_read_b32 v204, v13 offset:512
    ds_read_b32 v208, v13 offset:768
    ds_read_b32 v212, v13 offset:1024
    ds_read_b32 v216, v13 offset:1280
    ds_read_b32 v220, v13 offset:1536
    v_pk_add_f32 v[180:181], v[180:181], v[188:189]
    v_pk_add_f32 v[182:183], v[182:183], v[190:191]
    v_pk_add_f32 v[184:185], v[184:185], v[192:193]
    v_pk_add_f32 v[186:187], v[186:187], v[194:195]
    v_pk_add_f32 v[180:181], v[180:181], v[184:185]
    v_pk_add_f32 v[182:183], v[182:183], v[186:187]
    v_and_b32 v16, 8, v12
    v_cmp_ne_u32 vcc, 0, v16
    v_permlane32_swap_b32 v180, v182
    v_permlane32_swap_b32 v181, v183
    s_nop 0
    v_pk_add_f32 v[180:181], v[180:181], v[182:183]
    s_nop 1
    v_permlane16_swap_b32 v180, v181
    s_nop 1
    v_add_f32 v180, v180, v181
    s_nop 1
    v_mov_b32_dpp v181, v180 row_ror:8 row_mask:0xf bank_mask:0xf
    v_cndmask_b32 v182, v180, v181, vcc
    v_cndmask_b32 v16, v181, v180, vcc
    v_mul_f32 v184, 0xba800000, v182
    v_mul_f32 v16, 0x3a800000, v16
    v_fma_f32 v16, -v184, v184, v16
    v_max_f32 v16, 0, v16
    v_add_f32 v16, 0x3727c5ac, v16
    v_rsq_f32 v185, v16
    s_nop 0
    ds_bpermute_b32 v10, v14, v185
    ds_bpermute_b32 v11, v14, v185 offset:16
    ds_bpermute_b32 v8, v15, v184
    s_waitcnt lgkmcnt(0)
    v_mfma_f32_16x16x1_4b_f32 v[68:83], v196, v8, v[68:83]
    v_mfma_f32_16x16x1_4b_f32 v[84:99], v200, v8, v[84:99]
    v_mfma_f32_16x16x1_4b_f32 v[100:115], v204, v8, v[100:115]
    v_mfma_f32_16x16x1_4b_f32 v[116:131], v208, v8, v[116:131]
    v_mfma_f32_16x16x1_4b_f32 v[132:147], v212, v8, v[132:147]
    v_mfma_f32_16x16x1_4b_f32 v[148:163], v216, v8, v[148:163]
    v_mfma_f32_16x16x1_4b_f32 v[164:179], v220, v8, v[164:179]
pu_nofix:
    s_cmp_lg_u32 s43, 1
    s_cbranch_scc1 pu_loop
    v_mul_f32 v196, 0xbfb8aa3b, v10
    v_mul_f32 v200, v10, v10
    v_rcp_f32 v200, v200
    v_mul_f32 v198, 0xbfb8aa3b, v11
    v_mul_f32 v202, v11, v11
    v_rcp_f32 v202, v202
    s_mul_i32 s36, s35, 229376
    s_add_u32 s36, s36, 12582912
    s_add_u32 s20, s28, s36
    s_addc_u32 s21, s29, 0
    s_mov_b32 s22, 229376
    s_mov_b32 s23, 0x00020000
    s_mul_i32 s38, s34, 7
    s_add_u32 s38, s38, s45
    s_lshl_b32 s38, s38, 10
    s_mul_i32 s39, s45, 8184
    s_add_u32 s46, s38, 6144
    s_sub_u32 s39, s46, s39
    s_add_u32 s46, s38, 2048
    s_cmp_lt_u32 s3, 4
    s_cbranch_scc1 pu_res
    s_load_dwordx2 s[4:5], s[0:1], 48
    s_and_b32 s18, s2, 7
    s_lshr_b32 s19, s2, 3
    s_lshr_b32 s16, s18, 1
    s_lshl_b32 s16, s16, 2
    s_lshr_b32 s17, s19, 3
    s_add_u32 s16, s16, s17
    s_and_b32 s17, s18, 1
    s_and_b32 s19, s19, 7
    s_lshl_b32 s19, s19, 1
    s_add_u32 s17, s17, s19
    v_and_b32 v230, 63, v0
    v_lshrrev_b32 v231, 3, v230
    v_mul_u32_u24 v224, 2048, v231
    v_and_b32 v232, 7, v230
    v_and_b32 v231, 6, v231
    v_xor_b32 v232, v232, v231
    v_lshl_add_u32 v224, v232, 4, v224
    s_and_b32 s19, s3, 3
    s_lshl_b32 s92, s19, 10
    s_add_u32 s92, s92, 98304
    s_mul_i32 s18, s19, 16384
    s_lshl_b32 s19, s17, 7
    s_add_u32 s18, s18, s19
    v_add_u32 v224, s18, v224
    v_add_u32 v225, 65536, v224
    v_xor_b32 v226, 0x80, v224
    v_xor_b32 v227, 0x80, v225
    s_lshr_b32 s96, s17, 1
    s_add_u32 s96, s96, s16
    s_and_b32 s96, s96, 3
    s_mov_b32 s94, 0
    s_mov_b32 s95, 32768
    s_and_b32 s18, s17, 1
    s_mul_i32 s18, s18, 3670016
    s_waitcnt lgkmcnt(0)
    s_add_u32 s88, s4, s18
    s_addc_u32 s89, s5, 0
    s_mov_b32 s90, 3670016
    s_mov_b32 s91, 0x00020000
    s_branch pu_nopre
pu_res:
    s_and_b32 s18, s2, 7
    s_lshr_b32 s19, s2, 3
    s_lshr_b32 s16, s18, 1
    s_lshl_b32 s16, s16, 2
    s_lshr_b32 s17, s19, 3
    s_add_u32 s16, s16, s17
    s_and_b32 s17, s18, 1
    s_and_b32 s19, s19, 7
    s_lshl_b32 s19, s19, 1
    s_add_u32 s17, s17, s19
    s_lshl_b32 s16, s16, 2
    s_add_u32 s16, s16, s3
    s_lshl_b32 s16, s16, 16
    s_lshl_b32 s17, s17, 12
    s_add_u32 s16, s16, s17
    s_add_u32 s16, s16, 8388608
    s_add_u32 s24, s28, s16
    s_addc_u32 s25, s29, 0
    s_mov_b32 s26, 4096
    s_mov_b32 s27, 0x00020000
    v_pk_mov_b32 v[224:225], 0, 0
    v_pk_mov_b32 v[226:227], 0, 0
pu_nopre:
    s_waitcnt vmcnt(5) lgkmcnt(10)
    v_mfma_f32_16x16x32_bf16 v[68:71], v[20:23], v[52:55], v[68:71]
    s_mov_b32 s42, 53248
    s_mov_b32 s31, 57344
    s_mov_b32 s32, 61440
    ds_read_b64_tr_b16 v[48:49], v5 offset:16480
    s_waitcnt vmcnt(4)
    v_mfma_f32_16x16x32_bf16 v[76:79], v[20:23], v[56:59], v[76:79]
    ds_read_b64_tr_b16 v[50:51], v5 offset:20064
    s_add_u32 m0, s40, 66560
    v_mfma_f32_16x16x32_bf16 v[72:75], v[24:27], v[52:55], v[72:75]
    buffer_load_dwordx4 v2, s[8:11], s41 offen lds
    ds_read_b64_tr_b16 v[20:21], v5 offset:128
    v_mfma_f32_16x16x32_bf16 v[80:83], v[24:27], v[56:59], v[80:83]
    ds_read_b64_tr_b16 v[22:23], v5 offset:3712
    s_waitcnt lgkmcnt(10)
    v_mfma_f32_16x16x32_bf16 v[84:87], v[28:31], v[52:55], v[84:87]
    ds_read_b64_tr_b16 v[24:25], v5 offset:16512
    v_mfma_f32_16x16x32_bf16 v[92:95], v[28:31], v[56:59], v[92:95]
    ds_read_b64_tr_b16 v[26:27], v5 offset:20096
    v_mfma_f32_16x16x32_bf16 v[88:91], v[32:35], v[52:55], v[88:91]
    ds_read_b64_tr_b16 v[28:29], v5 offset:160
    v_mfma_f32_16x16x32_bf16 v[96:99], v[32:35], v[56:59], v[96:99]
    ds_read_b64_tr_b16 v[30:31], v5 offset:3744
    s_waitcnt lgkmcnt(10)
    v_mfma_f32_16x16x32_bf16 v[100:103], v[36:39], v[52:55], v[100:103]
    ds_read_b64_tr_b16 v[32:33], v5 offset:16544
    v_mfma_f32_16x16x32_bf16 v[108:111], v[36:39], v[56:59], v[108:111]
    ds_read_b64_tr_b16 v[34:35], v5 offset:20128
    v_mfma_f32_16x16x32_bf16 v[104:107], v[40:43], v[52:55], v[104:107]
    ds_read_b64_tr_b16 v[36:37], v5 offset:192
    v_mfma_f32_16x16x32_bf16 v[112:115], v[40:43], v[56:59], v[112:115]
    ds_read_b64_tr_b16 v[38:39], v5 offset:3776
    s_waitcnt lgkmcnt(10)
    v_mfma_f32_16x16x32_bf16 v[116:119], v[44:47], v[52:55], v[116:119]
    ds_read_b64_tr_b16 v[40:41], v5 offset:16576
    v_mfma_f32_16x16x32_bf16 v[124:127], v[44:47], v[56:59], v[124:127]
    ds_read_b64_tr_b16 v[42:43], v5 offset:20160
    v_mfma_f32_16x16x32_bf16 v[120:123], v[48:51], v[52:55], v[120:123]
    ds_read_b64_tr_b16 v[44:45], v5 offset:7168
    v_mfma_f32_16x16x32_bf16 v[128:131], v[48:51], v[56:59], v[128:131]
    ds_read_b64_tr_b16 v[46:47], v5 offset:10752
    s_waitcnt lgkmcnt(10)
    s_add_u32 m0, s40, 67584
    v_mfma_f32_16x16x32_bf16 v[132:135], v[20:23], v[52:55], v[132:135]
    buffer_load_dwordx4 v3, s[8:11], s41 offen lds
    ds_read_b64_tr_b16 v[48:49], v5 offset:23552
    v_mfma_f32_16x16x32_bf16 v[140:143], v[20:23], v[56:59], v[140:143]
    ds_read_b64_tr_b16 v[50:51], v5 offset:27136
    v_mfma_f32_16x16x32_bf16 v[136:139], v[24:27], v[52:55], v[136:139]
    ds_read_b64_tr_b16 v[20:21], v5 offset:7200
    v_mfma_f32_16x16x32_bf16 v[144:147], v[24:27], v[56:59], v[144:147]
    ds_read_b64_tr_b16 v[22:23], v5 offset:10784
    s_waitcnt lgkmcnt(10)
    v_mfma_f32_16x16x32_bf16 v[148:151], v[28:31], v[52:55], v[148:151]
    ds_read_b64_tr_b16 v[24:25], v5 offset:23584
    v_mfma_f32_16x16x32_bf16 v[156:159], v[28:31], v[56:59], v[156:159]
    ds_read_b64_tr_b16 v[26:27], v5 offset:27168
    v_mfma_f32_16x16x32_bf16 v[152:155], v[32:35], v[52:55], v[152:155]
    ds_read_b64_tr_b16 v[28:29], v5 offset:7232
    v_mfma_f32_16x16x32_bf16 v[160:163], v[32:35], v[56:59], v[160:163]
    ds_read_b64_tr_b16 v[30:31], v5 offset:10816
    s_waitcnt lgkmcnt(10)
    v_mfma_f32_16x16x32_bf16 v[164:167], v[36:39], v[52:55], v[164:167]
    ds_read_b64_tr_b16 v[32:33], v5 offset:23616
    v_mfma_f32_16x16x32_bf16 v[172:175], v[36:39], v[56:59], v[172:175]
    ds_read_b64_tr_b16 v[34:35], v5 offset:27200
    v_mfma_f32_16x16x32_bf16 v[168:171], v[40:43], v[52:55], v[168:171]
    ds_read_b64_tr_b16 v[36:37], v5 offset:7264
    buffer_load_dwordx4 v[52:55], v7, s[12:15], s42 offen offset:0 sc1
    v_mfma_f32_16x16x32_bf16 v[176:179], v[40:43], v[56:59], v[176:179]
    ds_read_b64_tr_b16 v[38:39], v5 offset:10848
    buffer_load_dwordx4 v[56:59], v7, s[12:15], s42 offen offset:1024 sc1
    s_waitcnt vmcnt(5) lgkmcnt(10)
    v_mfma_f32_16x16x32_bf16 v[68:71], v[44:47], v[60:63], v[68:71]
    ds_read_b64_tr_b16 v[40:41], v5 offset:23648
    s_waitcnt vmcnt(4)
    v_mfma_f32_16x16x32_bf16 v[76:79], v[44:47], v[64:67], v[76:79]
    ds_read_b64_tr_b16 v[42:43], v5 offset:27232
    s_add_u32 m0, s40, 68608
    v_mfma_f32_16x16x32_bf16 v[72:75], v[48:51], v[60:63], v[72:75]
    buffer_load_dwordx4 v4, s[8:11], s41 offen lds
    ds_read_b64_tr_b16 v[44:45], v5 offset:7296
    v_mfma_f32_16x16x32_bf16 v[80:83], v[48:51], v[64:67], v[80:83]
    ds_read_b64_tr_b16 v[46:47], v5 offset:10880
    s_waitcnt lgkmcnt(10)
    v_mfma_f32_16x16x32_bf16 v[84:87], v[20:23], v[60:63], v[84:87]
    ds_read_b64_tr_b16 v[48:49], v5 offset:23680
    v_mfma_f32_16x16x32_bf16 v[92:95], v[20:23], v[64:67], v[92:95]
    ds_read_b64_tr_b16 v[50:51], v5 offset:27264
    v_mfma_f32_16x16x32_bf16 v[88:91], v[24:27], v[60:63], v[88:91]
    ds_read_b64_tr_b16 v[20:21], v5 offset:7328
    v_mfma_f32_16x16x32_bf16 v[96:99], v[24:27], v[64:67], v[96:99]
    ds_read_b64_tr_b16 v[22:23], v5 offset:10912
    s_waitcnt lgkmcnt(10)
    v_mfma_f32_16x16x32_bf16 v[100:103], v[28:31], v[60:63], v[100:103]
    ds_read_b64_tr_b16 v[24:25], v5 offset:23712
    v_mfma_f32_16x16x32_bf16 v[108:111], v[28:31], v[64:67], v[108:111]
    ds_read_b64_tr_b16 v[26:27], v5 offset:27296
    v_mfma_f32_16x16x32_bf16 v[104:107], v[32:35], v[60:63], v[104:107]
    ds_read_b64_tr_b16 v[28:29], v5 offset:7360
    v_mfma_f32_16x16x32_bf16 v[112:115], v[32:35], v[64:67], v[112:115]
    ds_read_b64_tr_b16 v[30:31], v5 offset:10944
    s_waitcnt lgkmcnt(10)
    v_mfma_f32_16x16x32_bf16 v[116:119], v[36:39], v[60:63], v[116:119]
    ds_read_b64_tr_b16 v[32:33], v5 offset:23744
    v_mfma_f32_16x16x32_bf16 v[124:127], v[36:39], v[64:67], v[124:127]
    ds_read_b64_tr_b16 v[34:35], v5 offset:27328
    v_mfma_f32_16x16x32_bf16 v[120:123], v[40:43], v[60:63], v[120:123]
    s_waitcnt vmcnt(8)
    s_barrier
    s_add_u32 s41, s41, 458752
    ds_read_b64_tr_b16 v[36:37], v5 offset:32768
    v_mfma_f32_16x16x32_bf16 v[128:131], v[40:43], v[64:67], v[128:131]
    ds_read_b64_tr_b16 v[38:39], v5 offset:36352
    s_waitcnt lgkmcnt(10)
    s_add_u32 m0, s40, 98304
    v_mfma_f32_16x16x32_bf16 v[132:135], v[44:47], v[60:63], v[132:135]
    buffer_load_dwordx4 v1, s[8:11], s41 offen lds
    ds_read_b64_tr_b16 v[40:41], v5 offset:49152
    v_mfma_f32_16x16x32_bf16 v[140:143], v[44:47], v[64:67], v[140:143]
    ds_read_b64_tr_b16 v[42:43], v5 offset:52736
    v_mfma_f32_16x16x32_bf16 v[136:139], v[48:51], v[60:63], v[136:139]
    ds_read_b64_tr_b16 v[44:45], v5 offset:32800
    s_add_u32 m0, s40, 99328
    v_mfma_f32_16x16x32_bf16 v[144:147], v[48:51], v[64:67], v[144:147]
    buffer_load_dwordx4 v2, s[8:11], s41 offen lds
    ds_read_b64_tr_b16 v[46:47], v5 offset:36384
    s_waitcnt lgkmcnt(10)
    v_mfma_f32_16x16x32_bf16 v[148:151], v[20:23], v[60:63], v[148:151]
    ds_read_b64_tr_b16 v[48:49], v5 offset:49184
    v_mfma_f32_16x16x32_bf16 v[156:159], v[20:23], v[64:67], v[156:159]
    ds_read_b64_tr_b16 v[50:51], v5 offset:52768
    s_add_u32 m0, s40, 100352
    v_mfma_f32_16x16x32_bf16 v[152:155], v[24:27], v[60:63], v[152:155]
    buffer_load_dwordx4 v3, s[8:11], s41 offen lds
    ds_read_b64_tr_b16 v[20:21], v5 offset:32832
    v_mfma_f32_16x16x32_bf16 v[160:163], v[24:27], v[64:67], v[160:163]
    ds_read_b64_tr_b16 v[22:23], v5 offset:36416
    s_waitcnt lgkmcnt(10)
    v_mfma_f32_16x16x32_bf16 v[164:167], v[28:31], v[60:63], v[164:167]
    ds_read_b64_tr_b16 v[24:25], v5 offset:49216
    s_add_u32 m0, s40, 101376
    v_mfma_f32_16x16x32_bf16 v[172:175], v[28:31], v[64:67], v[172:175]
    buffer_load_dwordx4 v4, s[8:11], s41 offen lds
    ds_read_b64_tr_b16 v[26:27], v5 offset:52800
    v_mfma_f32_16x16x32_bf16 v[168:171], v[32:35], v[60:63], v[168:171]
    ds_read_b64_tr_b16 v[28:29], v5 offset:32864
    buffer_load_dwordx4 v[60:63], v7, s[12:15], s42 offen offset:2048 sc1
    v_mfma_f32_16x16x32_bf16 v[176:179], v[32:35], v[64:67], v[176:179]
    ds_read_b64_tr_b16 v[30:31], v5 offset:36448
    buffer_load_dwordx4 v[64:67], v7, s[12:15], s42 offen offset:3072 sc1
    s_waitcnt vmcnt(8) lgkmcnt(10)
    v_mfma_f32_16x16x32_bf16 v[68:71], v[36:39], v[52:55], v[68:71]
    ds_read_b64_tr_b16 v[32:33], v5 offset:49248
    buffer_load_dwordx4 v[180:183], v7, s[12:15], s31 offen offset:0 sc1
    s_waitcnt vmcnt(8)
    v_mfma_f32_16x16x32_bf16 v[76:79], v[36:39], v[56:59], v[76:79]
    ds_read_b64_tr_b16 v[34:35], v5 offset:52832
    v_mfma_f32_16x16x32_bf16 v[72:75], v[40:43], v[52:55], v[72:75]
    ds_read_b64_tr_b16 v[36:37], v5 offset:32896
    v_mfma_f32_16x16x32_bf16 v[80:83], v[40:43], v[56:59], v[80:83]
    ds_read_b64_tr_b16 v[38:39], v5 offset:36480
    s_waitcnt lgkmcnt(10)
    v_mfma_f32_16x16x32_bf16 v[84:87], v[44:47], v[52:55], v[84:87]
    ds_read_b64_tr_b16 v[40:41], v5 offset:49280
    buffer_load_dwordx4 v[184:187], v7, s[12:15], s31 offen offset:1024 sc1
    v_mfma_f32_16x16x32_bf16 v[92:95], v[44:47], v[56:59], v[92:95]
    ds_read_b64_tr_b16 v[42:43], v5 offset:52864
    v_mfma_f32_16x16x32_bf16 v[88:91], v[48:51], v[52:55], v[88:91]
    ds_read_b64_tr_b16 v[44:45], v5 offset:32928
    v_mfma_f32_16x16x32_bf16 v[96:99], v[48:51], v[56:59], v[96:99]
    ds_read_b64_tr_b16 v[46:47], v5 offset:36512
    s_waitcnt lgkmcnt(10)
    v_mfma_f32_16x16x32_bf16 v[100:103], v[20:23], v[52:55], v[100:103]
    ds_read_b64_tr_b16 v[48:49], v5 offset:49312
    buffer_load_dwordx4 v[188:191], v7, s[12:15], s31 offen offset:2048 sc1
    v_mfma_f32_16x16x32_bf16 v[108:111], v[20:23], v[56:59], v[108:111]
    ds_read_b64_tr_b16 v[50:51], v5 offset:52896
    v_mfma_f32_16x16x32_bf16 v[104:107], v[24:27], v[52:55], v[104:107]
    ds_read_b64_tr_b16 v[20:21], v5 offset:32960
    v_mfma_f32_16x16x32_bf16 v[112:115], v[24:27], v[56:59], v[112:115]
    ds_read_b64_tr_b16 v[22:23], v5 offset:36544
    s_waitcnt lgkmcnt(10)
    v_mfma_f32_16x16x32_bf16 v[116:119], v[28:31], v[52:55], v[116:119]
    ds_read_b64_tr_b16 v[24:25], v5 offset:49344
    buffer_load_dwordx4 v[192:195], v7, s[12:15], s31 offen offset:3072 sc1
    v_mfma_f32_16x16x32_bf16 v[124:127], v[28:31], v[56:59], v[124:127]
    ds_read_b64_tr_b16 v[26:27], v5 offset:52928
    v_mfma_f32_16x16x32_bf16 v[120:123], v[32:35], v[52:55], v[120:123]
    ds_read_b64_tr_b16 v[28:29], v5 offset:39936
    v_mfma_f32_16x16x32_bf16 v[128:131], v[32:35], v[56:59], v[128:131]
    ds_read_b64_tr_b16 v[30:31], v5 offset:43520
    s_waitcnt lgkmcnt(10)
    v_mfma_f32_16x16x32_bf16 v[132:135], v[36:39], v[52:55], v[132:135]
    ds_read_b64_tr_b16 v[32:33], v5 offset:56320
    v_mfma_f32_16x16x32_bf16 v[140:143], v[36:39], v[56:59], v[140:143]
    ds_read_b64_tr_b16 v[34:35], v5 offset:59904
    v_mfma_f32_16x16x32_bf16 v[136:139], v[40:43], v[52:55], v[136:139]
    ds_read_b64_tr_b16 v[36:37], v5 offset:39968
    v_mfma_f32_16x16x32_bf16 v[144:147], v[40:43], v[56:59], v[144:147]
    ds_read_b64_tr_b16 v[38:39], v5 offset:43552
    s_waitcnt lgkmcnt(10)
    v_mfma_f32_16x16x32_bf16 v[148:151], v[44:47], v[52:55], v[148:151]
    ds_read_b64_tr_b16 v[40:41], v5 offset:56352
    v_mfma_f32_16x16x32_bf16 v[156:159], v[44:47], v[56:59], v[156:159]
    ds_read_b64_tr_b16 v[42:43], v5 offset:59936
    v_mfma_f32_16x16x32_bf16 v[152:155], v[48:51], v[52:55], v[152:155]
    ds_read_b64_tr_b16 v[44:45], v5 offset:40000
    v_mfma_f32_16x16x32_bf16 v[160:163], v[48:51], v[56:59], v[160:163]
    ds_read_b64_tr_b16 v[46:47], v5 offset:43584
    s_waitcnt lgkmcnt(10)
    v_mfma_f32_16x16x32_bf16 v[164:167], v[20:23], v[52:55], v[164:167]
    ds_read_b64_tr_b16 v[48:49], v5 offset:56384
    v_mfma_f32_16x16x32_bf16 v[172:175], v[20:23], v[56:59], v[172:175]
    ds_read_b64_tr_b16 v[50:51], v5 offset:59968
    v_mfma_f32_16x16x32_bf16 v[168:171], v[24:27], v[52:55], v[168:171]
    ds_read_b64_tr_b16 v[20:21], v5 offset:40032
    buffer_load_dwordx4 v[52:55], v7, s[12:15], s32 offen offset:0 sc1
    v_mfma_f32_16x16x32_bf16 v[176:179], v[24:27], v[56:59], v[176:179]
    ds_read_b64_tr_b16 v[22:23], v5 offset:43616
    buffer_load_dwordx4 v[56:59], v7, s[12:15], s32 offen offset:1024 sc1
    s_waitcnt vmcnt(7) lgkmcnt(10)
    v_mfma_f32_16x16x32_bf16 v[68:71], v[28:31], v[60:63], v[68:71]
    ds_read_b64_tr_b16 v[24:25], v5 offset:56416
    s_waitcnt vmcnt(6)
    v_mfma_f32_16x16x32_bf16 v[76:79], v[28:31], v[64:67], v[76:79]
    ds_read_b64_tr_b16 v[26:27], v5 offset:60000
    v_mfma_f32_16x16x32_bf16 v[72:75], v[32:35], v[60:63], v[72:75]
    ds_read_b64_tr_b16 v[28:29], v5 offset:40064
    v_mfma_f32_16x16x32_bf16 v[80:83], v[32:35], v[64:67], v[80:83]
    ds_read_b64_tr_b16 v[30:31], v5 offset:43648
    s_waitcnt lgkmcnt(10)
    v_mfma_f32_16x16x32_bf16 v[84:87], v[36:39], v[60:63], v[84:87]
    ds_read_b64_tr_b16 v[32:33], v5 offset:56448
    v_mfma_f32_16x16x32_bf16 v[92:95], v[36:39], v[64:67], v[92:95]
    ds_read_b64_tr_b16 v[34:35], v5 offset:60032
    v_mfma_f32_16x16x32_bf16 v[88:91], v[40:43], v[60:63], v[88:91]
    ds_read_b64_tr_b16 v[36:37], v5 offset:40096
    v_mfma_f32_16x16x32_bf16 v[96:99], v[40:43], v[64:67], v[96:99]
    ds_read_b64_tr_b16 v[38:39], v5 offset:43680
    s_waitcnt lgkmcnt(10)
    v_mfma_f32_16x16x32_bf16 v[100:103], v[44:47], v[60:63], v[100:103]
    ds_read_b64_tr_b16 v[40:41], v5 offset:56480
    v_mfma_f32_16x16x32_bf16 v[108:111], v[44:47], v[64:67], v[108:111]
    ds_read_b64_tr_b16 v[42:43], v5 offset:60064
    v_mfma_f32_16x16x32_bf16 v[104:107], v[48:51], v[60:63], v[104:107]
    ds_read_b64_tr_b16 v[44:45], v5 offset:40128
    v_mfma_f32_16x16x32_bf16 v[112:115], v[48:51], v[64:67], v[112:115]
    ds_read_b64_tr_b16 v[46:47], v5 offset:43712
    s_waitcnt lgkmcnt(10)
    v_mfma_f32_16x16x32_bf16 v[116:119], v[20:23], v[60:63], v[116:119]
    ds_read_b64_tr_b16 v[48:49], v5 offset:56512
    v_mfma_f32_16x16x32_bf16 v[124:127], v[20:23], v[64:67], v[124:127]
    ds_read_b64_tr_b16 v[50:51], v5 offset:60096
    v_mfma_f32_16x16x32_bf16 v[120:123], v[24:27], v[60:63], v[120:123]
    s_waitcnt vmcnt(8)
    s_barrier
    ds_read_b64_tr_b16 v[20:21], v6 offset:0
    v_mfma_f32_16x16x32_bf16 v[128:131], v[24:27], v[64:67], v[128:131]
    ds_read_b64_tr_b16 v[22:23], v6 offset:3584
    s_waitcnt lgkmcnt(10)
    v_mfma_f32_16x16x32_bf16 v[132:135], v[28:31], v[60:63], v[132:135]
    ds_read_b64_tr_b16 v[24:25], v6 offset:16384
    v_mfma_f32_16x16x32_bf16 v[140:143], v[28:31], v[64:67], v[140:143]
    ds_read_b64_tr_b16 v[26:27], v6 offset:19968
    v_mfma_f32_16x16x32_bf16 v[136:139], v[32:35], v[60:63], v[136:139]
    ds_read_b64_tr_b16 v[28:29], v6 offset:32
    v_mfma_f32_16x16x32_bf16 v[144:147], v[32:35], v[64:67], v[144:147]
    ds_read_b64_tr_b16 v[30:31], v6 offset:3616
    s_waitcnt lgkmcnt(10)
    v_mfma_f32_16x16x32_bf16 v[148:151], v[36:39], v[60:63], v[148:151]
    ds_read_b64_tr_b16 v[32:33], v6 offset:16416
    v_mfma_f32_16x16x32_bf16 v[156:159], v[36:39], v[64:67], v[156:159]
    ds_read_b64_tr_b16 v[34:35], v6 offset:20000
    v_mfma_f32_16x16x32_bf16 v[152:155], v[40:43], v[60:63], v[152:155]
    ds_read_b64_tr_b16 v[36:37], v6 offset:7168
    v_mfma_f32_16x16x32_bf16 v[160:163], v[40:43], v[64:67], v[160:163]
    ds_read_b64_tr_b16 v[38:39], v6 offset:10752
    s_waitcnt lgkmcnt(10)
    v_mfma_f32_16x16x32_bf16 v[164:167], v[44:47], v[60:63], v[164:167]
    ds_read_b64_tr_b16 v[40:41], v6 offset:23552
    v_mfma_f32_16x16x32_bf16 v[172:175], v[44:47], v[64:67], v[172:175]
    ds_read_b64_tr_b16 v[42:43], v6 offset:27136
    v_mfma_f32_16x16x32_bf16 v[168:171], v[48:51], v[60:63], v[168:171]
    ds_read_b64_tr_b16 v[44:45], v6 offset:7200
    buffer_load_dwordx4 v[60:63], v7, s[12:15], s32 offen offset:2048 sc1
    v_mfma_f32_16x16x32_bf16 v[176:179], v[48:51], v[64:67], v[176:179]
    ds_read_b64_tr_b16 v[46:47], v6 offset:10784
    buffer_load_dwordx4 v[64:67], v7, s[12:15], s32 offen offset:3072 sc1
    s_waitcnt vmcnt(7) lgkmcnt(10)
    v_mfma_f32_16x16x32_bf16 v[68:71], v[20:23], v[180:183], v[68:71]
    ds_read_b64_tr_b16 v[48:49], v6 offset:23584
    s_waitcnt vmcnt(6)
    v_mfma_f32_16x16x32_bf16 v[76:79], v[20:23], v[184:187], v[76:79]
    ds_read_b64_tr_b16 v[50:51], v6 offset:27168
    v_mfma_f32_16x16x32_bf16 v[72:75], v[24:27], v[180:183], v[72:75]
    ds_read_b64_tr_b16 v[20:21], v6 offset:32768
    v_mfma_f32_16x16x32_bf16 v[80:83], v[24:27], v[184:187], v[80:83]
    ds_read_b64_tr_b16 v[22:23], v6 offset:36352
    s_waitcnt lgkmcnt(10)
    v_mfma_f32_16x16x32_bf16 v[84:87], v[28:31], v[180:183], v[84:87]
    ds_read_b64_tr_b16 v[24:25], v6 offset:49152
    v_mfma_f32_16x16x32_bf16 v[92:95], v[28:31], v[184:187], v[92:95]
    ds_read_b64_tr_b16 v[26:27], v6 offset:52736
    v_mfma_f32_16x16x32_bf16 v[88:91], v[32:35], v[180:183], v[88:91]
    ds_read_b64_tr_b16 v[28:29], v6 offset:32800
    v_mfma_f32_16x16x32_bf16 v[96:99], v[32:35], v[184:187], v[96:99]
    ds_read_b64_tr_b16 v[30:31], v6 offset:36384
    s_waitcnt vmcnt(5) lgkmcnt(10)
    v_mfma_f32_16x16x32_bf16 v[68:71], v[36:39], v[188:191], v[68:71]
    ds_read_b64_tr_b16 v[32:33], v6 offset:49184
    s_waitcnt vmcnt(4)
    v_mfma_f32_16x16x32_bf16 v[76:79], v[36:39], v[192:195], v[76:79]
    ds_read_b64_tr_b16 v[34:35], v6 offset:52768
    v_mfma_f32_16x16x32_bf16 v[72:75], v[40:43], v[188:191], v[72:75]
    ds_read_b64_tr_b16 v[36:37], v6 offset:39936
    v_mfma_f32_16x16x32_bf16 v[80:83], v[40:43], v[192:195], v[80:83]
    ds_read_b64_tr_b16 v[38:39], v6 offset:43520
    s_waitcnt lgkmcnt(10)
    v_mfma_f32_16x16x32_bf16 v[84:87], v[44:47], v[188:191], v[84:87]
    ds_read_b64_tr_b16 v[40:41], v6 offset:56320
    v_mfma_f32_16x16x32_bf16 v[92:95], v[44:47], v[192:195], v[92:95]
    ds_read_b64_tr_b16 v[42:43], v6 offset:59904
    v_mfma_f32_16x16x32_bf16 v[88:91], v[48:51], v[188:191], v[88:91]
    ds_read_b64_tr_b16 v[44:45], v6 offset:39968
    v_mfma_f32_16x16x32_bf16 v[96:99], v[48:51], v[192:195], v[96:99]
    ds_read_b64_tr_b16 v[46:47], v6 offset:43552
    s_waitcnt vmcnt(3) lgkmcnt(10)
    v_mfma_f32_16x16x32_bf16 v[68:71], v[20:23], v[52:55], v[68:71]
    ds_read_b64_tr_b16 v[48:49], v6 offset:56352
    s_waitcnt vmcnt(2)
    v_mfma_f32_16x16x32_bf16 v[76:79], v[20:23], v[56:59], v[76:79]
    ds_read_b64_tr_b16 v[50:51], v6 offset:59936
    v_mfma_f32_16x16x32_bf16 v[72:75], v[24:27], v[52:55], v[72:75]
    ds_read_b64_tr_b16 v[20:21], v6 offset:64
    v_mfma_f32_16x16x32_bf16 v[80:83], v[24:27], v[56:59], v[80:83]
    ds_read_b64_tr_b16 v[22:23], v6 offset:3648
    s_waitcnt lgkmcnt(10)
    v_mfma_f32_16x16x32_bf16 v[84:87], v[28:31], v[52:55], v[84:87]
    ds_read_b64_tr_b16 v[24:25], v6 offset:16448
    v_mfma_f32_16x16x32_bf16 v[92:95], v[28:31], v[56:59], v[92:95]
    ds_read_b64_tr_b16 v[26:27], v6 offset:20032
    v_mfma_f32_16x16x32_bf16 v[88:91], v[32:35], v[52:55], v[88:91]
    ds_read_b64_tr_b16 v[28:29], v6 offset:96
    v_mfma_f32_16x16x32_bf16 v[96:99], v[32:35], v[56:59], v[96:99]
    ds_read_b64_tr_b16 v[30:31], v6 offset:3680
    s_waitcnt vmcnt(1) lgkmcnt(10)
    v_mfma_f32_16x16x32_bf16 v[68:71], v[36:39], v[60:63], v[68:71]
    ds_read_b64_tr_b16 v[32:33], v6 offset:16480
    s_waitcnt vmcnt(0)
    v_mfma_f32_16x16x32_bf16 v[76:79], v[36:39], v[64:67], v[76:79]
    ds_read_b64_tr_b16 v[34:35], v6 offset:20064
    s_cmp_lt_u32 s3, 4
    s_cbranch_scc1 pu_res2
    s_and_b32 s18, s94, 3
    s_cmp_eq_u32 s18, s96
    s_cselect_b32 s18, 3, -1
    s_add_u32 s93, s94, s18
    s_add_u32 s18, s93, 28
    s_min_u32 s93, s93, s18
    s_sub_u32 s18, s93, 28
    s_min_u32 s93, s93, s18
    s_mul_i32 s93, s93, 131072
    s_add_u32 s18, s92, s95
    s_add_u32 m0, s18, 0
    s_nop 0
    buffer_load_dwordx4 v224, s[88:91], s93 offen lds
    s_add_u32 m0, s18, 4096
    s_nop 0
    buffer_load_dwordx4 v225, s[88:91], s93 offen lds
    s_add_u32 m0, s18, 8192
    s_nop 0
    buffer_load_dwordx4 v226, s[88:91], s93 offen lds
    s_add_u32 m0, s18, 12288
    s_nop 0
    buffer_load_dwordx4 v227, s[88:91], s93 offen lds
    s_add_u32 s95, s95, 16384
    s_cmp_eq_u32 s95, 65536
    s_cselect_b32 s95, 0, s95
    s_add_u32 s94, s94, 1
    s_and_b32 s18, s94, 3
    s_cmp_eq_u32 s18, s96
    s_cselect_b32 s18, 3, -1
    s_add_u32 s93, s94, s18
    s_add_u32 s18, s93, 28
    s_min_u32 s93, s93, s18
    s_sub_u32 s18, s93, 28
    s_min_u32 s93, s93, s18
    s_mul_i32 s93, s93, 131072
    s_add_u32 s18, s92, s95
    s_add_u32 m0, s18, 0
    s_nop 0
    buffer_load_dwordx4 v224, s[88:91], s93 offen lds
    s_add_u32 m0, s18, 4096
    s_nop 0
    buffer_load_dwordx4 v225, s[88:91], s93 offen lds
    s_add_u32 m0, s18, 8192
    s_nop 0
    buffer_load_dwordx4 v226, s[88:91], s93 offen lds
    s_add_u32 m0, s18, 12288
    s_nop 0
    buffer_load_dwordx4 v227, s[88:91], s93 offen lds
    s_add_u32 s95, s95, 16384
    s_cmp_eq_u32 s95, 65536
    s_cselect_b32 s95, 0, s95
    s_add_u32 s94, s94, 1
    s_branch pu_nopre2
pu_res2:
    buffer_load_dwordx4 v[228:231], v7, s[24:27], 0 offen offset:0 sc1
    buffer_load_dwordx4 v[232:235], v7, s[24:27], 0 offen offset:1024 sc1
    buffer_load_dwordx4 v[236:239], v7, s[24:27], 0 offen offset:2048 sc1
    buffer_load_dwordx4 v[240:243], v7, s[24:27], 0 offen offset:3072 sc1
pu_nopre2:
    v_mfma_f32_16x16x32_bf16 v[72:75], v[40:43], v[60:63], v[72:75]
    ds_read_b64_tr_b16 v[36:37], v6 offset:7232
    v_mfma_f32_16x16x32_bf16 v[80:83], v[40:43], v[64:67], v[80:83]
    ds_read_b64_tr_b16 v[38:39], v6 offset:10816
    s_waitcnt lgkmcnt(10)
    v_mfma_f32_16x16x32_bf16 v[84:87], v[44:47], v[60:63], v[84:87]
    ds_read_b64_tr_b16 v[40:41], v6 offset:23616
    v_mfma_f32_16x16x32_bf16 v[92:95], v[44:47], v[64:67], v[92:95]
    ds_read_b64_tr_b16 v[42:43], v6 offset:27200
    v_mfma_f32_16x16x32_bf16 v[88:91], v[48:51], v[60:63], v[88:91]
    ds_read_b64_tr_b16 v[44:45], v6 offset:7264
    v_mfma_f32_16x16x32_bf16 v[96:99], v[48:51], v[64:67], v[96:99]
    ds_read_b64_tr_b16 v[46:47], v6 offset:10848
    s_waitcnt lgkmcnt(10)
    v_mfma_f32_16x16x32_bf16 v[100:103], v[20:23], v[180:183], v[100:103]
    ds_read_b64_tr_b16 v[48:49], v6 offset:23648
    v_mfma_f32_16x16x32_bf16 v[108:111], v[20:23], v[184:187], v[108:111]
    ds_read_b64_tr_b16 v[50:51], v6 offset:27232
    v_mfma_f32_16x16x32_bf16 v[104:107], v[24:27], v[180:183], v[104:107]
    ds_read_b64_tr_b16 v[20:21], v6 offset:32832
    v_mfma_f32_16x16x32_bf16 v[112:115], v[24:27], v[184:187], v[112:115]
    ds_read_b64_tr_b16 v[22:23], v6 offset:36416
    s_waitcnt lgkmcnt(10)
    v_mfma_f32_16x16x32_bf16 v[116:119], v[28:31], v[180:183], v[116:119]
    ds_read_b64_tr_b16 v[24:25], v6 offset:49216
    v_mul_f32 v204, v68, v196
    v_mul_f32 v205, v69, v196
    v_mul_f32 v206, v70, v196
    v_mul_f32 v207, v71, v196
    v_mfma_f32_16x16x32_bf16 v[124:127], v[28:31], v[184:187], v[124:127]
    ds_read_b64_tr_b16 v[26:27], v6 offset:52800
    v_mul_f32 v208, v84, v196
    v_mul_f32 v209, v85, v196
    v_mul_f32 v210, v86, v196
    v_mul_f32 v211, v87, v196
    v_mfma_f32_16x16x32_bf16 v[120:123], v[32:35], v[180:183], v[120:123]
    ds_read_b64_tr_b16 v[28:29], v6 offset:32864
    v_exp_f32 v204, v204
    v_exp_f32 v205, v205
    v_exp_f32 v206, v206
    v_exp_f32 v207, v207
    v_mfma_f32_16x16x32_bf16 v[128:131], v[32:35], v[184:187], v[128:131]
    ds_read_b64_tr_b16 v[30:31], v6 offset:36448
    v_exp_f32 v208, v208
    v_exp_f32 v209, v209
    v_exp_f32 v210, v210
    v_exp_f32 v211, v211
    s_waitcnt lgkmcnt(10)
    v_mfma_f32_16x16x32_bf16 v[100:103], v[36:39], v[188:191], v[100:103]
    ds_read_b64_tr_b16 v[32:33], v6 offset:49248
    v_mul_f32 v68, v68, v72
    v_mul_f32 v69, v69, v73
    v_mul_f32 v70, v70, v74
    v_mul_f32 v71, v71, v75
    v_mfma_f32_16x16x32_bf16 v[108:111], v[36:39], v[192:195], v[108:111]
    ds_read_b64_tr_b16 v[34:35], v6 offset:52832
    v_mul_f32 v84, v84, v88
    v_mul_f32 v85, v85, v89
    v_mul_f32 v86, v86, v90
    v_mul_f32 v87, v87, v91
    v_mfma_f32_16x16x32_bf16 v[104:107], v[40:43], v[188:191], v[104:107]
    ds_read_b64_tr_b16 v[36:37], v6 offset:40000
    v_fma_f32 v204, v204, v200, v200
    v_fma_f32 v205, v205, v200, v200
    v_fma_f32 v206, v206, v200, v200
    v_fma_f32 v207, v207, v200, v200
    v_mfma_f32_16x16x32_bf16 v[112:115], v[40:43], v[192:195], v[112:115]
    ds_read_b64_tr_b16 v[38:39], v6 offset:43584
    v_fma_f32 v208, v208, v200, v200
    v_fma_f32 v209, v209, v200, v200
    v_fma_f32 v210, v210, v200, v200
    v_fma_f32 v211, v211, v200, v200
    s_waitcnt lgkmcnt(10)
    v_mfma_f32_16x16x32_bf16 v[116:119], v[44:47], v[188:191], v[116:119]
    ds_read_b64_tr_b16 v[40:41], v6 offset:56384
    v_rcp_f32 v204, v204
    v_rcp_f32 v205, v205
    v_rcp_f32 v206, v206
    v_rcp_f32 v207, v207
    v_mfma_f32_16x16x32_bf16 v[124:127], v[44:47], v[192:195], v[124:127]
    ds_read_b64_tr_b16 v[42:43], v6 offset:59968
    v_rcp_f32 v208, v208
    v_rcp_f32 v209, v209
    v_rcp_f32 v210, v210
    v_rcp_f32 v211, v211
    v_mfma_f32_16x16x32_bf16 v[120:123], v[48:51], v[188:191], v[120:123]
    ds_read_b64_tr_b16 v[44:45], v6 offset:40032
    v_mul_f32 v68, v68, v204
    v_mul_f32 v69, v69, v205
    v_mul_f32 v70, v70, v206
    v_mul_f32 v71, v71, v207
    v_mfma_f32_16x16x32_bf16 v[128:131], v[48:51], v[192:195], v[128:131]
    ds_read_b64_tr_b16 v[46:47], v6 offset:43616
    v_mul_f32 v84, v84, v208
    v_mul_f32 v85, v85, v209
    v_mul_f32 v86, v86, v210
    v_mul_f32 v87, v87, v211
    s_waitcnt lgkmcnt(10)
    v_mfma_f32_16x16x32_bf16 v[100:103], v[20:23], v[52:55], v[100:103]
    ds_read_b64_tr_b16 v[48:49], v6 offset:56416
    v_cvt_pk_bf16_f32 v212, v68, v69
    v_cvt_pk_bf16_f32 v213, v70, v71
    v_cvt_pk_bf16_f32 v214, v84, v85
    v_cvt_pk_bf16_f32 v215, v86, v87
    v_mfma_f32_16x16x32_bf16 v[108:111], v[20:23], v[56:59], v[108:111]
    ds_read_b64_tr_b16 v[50:51], v6 offset:60000
    buffer_store_dwordx4 v[212:215], v7, s[20:23], s38 offen offset:0 sc1
    v_mul_f32 v204, v76, v198
    v_mul_f32 v205, v77, v198
    v_mul_f32 v206, v78, v198
    v_mfma_f32_16x16x32_bf16 v[104:107], v[24:27], v[52:55], v[104:107]
    ds_read_b64_tr_b16 v[20:21], v6 offset:128
    v_mul_f32 v207, v79, v198
    v_mul_f32 v208, v92, v198
    v_mul_f32 v209, v93, v198
    v_mul_f32 v210, v94, v198
    v_mfma_f32_16x16x32_bf16 v[112:115], v[24:27], v[56:59], v[112:115]
    ds_read_b64_tr_b16 v[22:23], v6 offset:3712
    v_mul_f32 v211, v95, v198
    v_exp_f32 v204, v204
    v_exp_f32 v205, v205
    v_exp_f32 v206, v206
    s_waitcnt lgkmcnt(10)
    v_mfma_f32_16x16x32_bf16 v[116:119], v[28:31], v[52:55], v[116:119]
    ds_read_b64_tr_b16 v[24:25], v6 offset:16512
    v_exp_f32 v207, v207
    v_exp_f32 v208, v208
    v_exp_f32 v209, v209
    v_exp_f32 v210, v210
    v_mfma_f32_16x16x32_bf16 v[124:127], v[28:31], v[56:59], v[124:127]
    ds_read_b64_tr_b16 v[26:27], v6 offset:20096
    v_exp_f32 v211, v211
    v_mul_f32 v76, v76, v80
    v_mul_f32 v77, v77, v81
    v_mul_f32 v78, v78, v82
    v_mfma_f32_16x16x32_bf16 v[120:123], v[32:35], v[52:55], v[120:123]
    ds_read_b64_tr_b16 v[28:29], v6 offset:160
    v_mul_f32 v79, v79, v83
    v_mul_f32 v92, v92, v96
    v_mul_f32 v93, v93, v97
    v_mul_f32 v94, v94, v98
    v_mfma_f32_16x16x32_bf16 v[128:131], v[32:35], v[56:59], v[128:131]
    ds_read_b64_tr_b16 v[30:31], v6 offset:3744
    v_mul_f32 v95, v95, v99
    v_fma_f32 v204, v204, v202, v202
    v_fma_f32 v205, v205, v202, v202
    v_fma_f32 v206, v206, v202, v202
    s_waitcnt lgkmcnt(10)
    v_mfma_f32_16x16x32_bf16 v[100:103], v[36:39], v[60:63], v[100:103]
    ds_read_b64_tr_b16 v[32:33], v6 offset:16544
    v_fma_f32 v207, v207, v202, v202
    v_fma_f32 v208, v208, v202, v202
    v_fma_f32 v209, v209, v202, v202
    v_fma_f32 v210, v210, v202, v202
    v_mfma_f32_16x16x32_bf16 v[108:111], v[36:39], v[64:67], v[108:111]
    ds_read_b64_tr_b16 v[34:35], v6 offset:20128
    v_fma_f32 v211, v211, v202, v202
    v_rcp_f32 v204, v204
    v_rcp_f32 v205, v205
    v_rcp_f32 v206, v206
    v_mfma_f32_16x16x32_bf16 v[104:107], v[40:43], v[60:63], v[104:107]
    ds_read_b64_tr_b16 v[36:37], v6 offset:7296
    v_rcp_f32 v207, v207
    v_rcp_f32 v208, v208
    v_rcp_f32 v209, v209
    v_mfma_f32_16x16x32_bf16 v[112:115], v[40:43], v[64:67], v[112:115]
    ds_read_b64_tr_b16 v[38:39], v6 offset:10880
    v_rcp_f32 v210, v210
    v_rcp_f32 v211, v211
    v_mul_f32 v76, v76, v204
    s_waitcnt lgkmcnt(10)
    v_mfma_f32_16x16x32_bf16 v[116:119], v[44:47], v[60:63], v[116:119]
    ds_read_b64_tr_b16 v[40:41], v6 offset:23680
    v_mul_f32 v77, v77, v205
    v_mul_f32 v78, v78, v206
    v_mul_f32 v79, v79, v207
    v_mfma_f32_16x16x32_bf16 v[124:127], v[44:47], v[64:67], v[124:127]
    ds_read_b64_tr_b16 v[42:43], v6 offset:27264
    v_mul_f32 v92, v92, v208
    v_mul_f32 v93, v93, v209
    v_mul_f32 v94, v94, v210
    v_mfma_f32_16x16x32_bf16 v[120:123], v[48:51], v[60:63], v[120:123]
    ds_read_b64_tr_b16 v[44:45], v6 offset:7328
    v_mul_f32 v95, v95, v211
    v_cvt_pk_bf16_f32 v216, v76, v77
    v_cvt_pk_bf16_f32 v217, v78, v79
    v_mfma_f32_16x16x32_bf16 v[128:131], v[48:51], v[64:67], v[128:131]
    ds_read_b64_tr_b16 v[46:47], v6 offset:10912
    v_cvt_pk_bf16_f32 v218, v92, v93
    v_cvt_pk_bf16_f32 v219, v94, v95
    buffer_store_dwordx4 v[216:219], v7, s[20:23], s38 offen offset:1024 sc1
    s_waitcnt lgkmcnt(10)
    v_mfma_f32_16x16x32_bf16 v[132:135], v[20:23], v[180:183], v[132:135]
    ds_read_b64_tr_b16 v[48:49], v6 offset:23712
    v_mfma_f32_16x16x32_bf16 v[140:143], v[20:23], v[184:187], v[140:143]
    ds_read_b64_tr_b16 v[50:51], v6 offset:27296
    v_mfma_f32_16x16x32_bf16 v[136:139], v[24:27], v[180:183], v[136:139]
    ds_read_b64_tr_b16 v[20:21], v6 offset:32896
    v_mfma_f32_16x16x32_bf16 v[144:147], v[24:27], v[184:187], v[144:147]
    ds_read_b64_tr_b16 v[22:23], v6 offset:36480
    s_waitcnt lgkmcnt(10)
    v_mfma_f32_16x16x32_bf16 v[148:151], v[28:31], v[180:183], v[148:151]
    ds_read_b64_tr_b16 v[24:25], v6 offset:49280
    v_mul_f32 v204, v100, v196
    v_mul_f32 v205, v101, v196
    v_mul_f32 v206, v102, v196
    v_mul_f32 v207, v103, v196
    v_mfma_f32_16x16x32_bf16 v[156:159], v[28:31], v[184:187], v[156:159]
    ds_read_b64_tr_b16 v[26:27], v6 offset:52864
    v_mul_f32 v208, v116, v196
    v_mul_f32 v209, v117, v196
    v_mul_f32 v210, v118, v196
    v_mul_f32 v211, v119, v196
    v_mfma_f32_16x16x32_bf16 v[152:155], v[32:35], v[180:183], v[152:155]
    ds_read_b64_tr_b16 v[28:29], v6 offset:32928
    v_exp_f32 v204, v204
    v_exp_f32 v205, v205
    v_exp_f32 v206, v206
    v_exp_f32 v207, v207
    v_mfma_f32_16x16x32_bf16 v[160:163], v[32:35], v[184:187], v[160:163]
    ds_read_b64_tr_b16 v[30:31], v6 offset:36512
    v_exp_f32 v208, v208
    v_exp_f32 v209, v209
    v_exp_f32 v210, v210
    v_exp_f32 v211, v211
    s_waitcnt lgkmcnt(10)
    v_mfma_f32_16x16x32_bf16 v[132:135], v[36:39], v[188:191], v[132:135]
    ds_read_b64_tr_b16 v[32:33], v6 offset:49312
    v_mul_f32 v100, v100, v104
    v_mul_f32 v101, v101, v105
    v_mul_f32 v102, v102, v106
    v_mul_f32 v103, v103, v107
    v_mfma_f32_16x16x32_bf16 v[140:143], v[36:39], v[192:195], v[140:143]
    ds_read_b64_tr_b16 v[34:35], v6 offset:52896
    v_mul_f32 v116, v116, v120
    v_mul_f32 v117, v117, v121
    v_mul_f32 v118, v118, v122
    v_mul_f32 v119, v119, v123
    v_mfma_f32_16x16x32_bf16 v[136:139], v[40:43], v[188:191], v[136:139]
    ds_read_b64_tr_b16 v[36:37], v6 offset:40064
    v_fma_f32 v204, v204, v200, v200
    v_fma_f32 v205, v205, v200, v200
    v_fma_f32 v206, v206, v200, v200
    v_fma_f32 v207, v207, v200, v200
    v_mfma_f32_16x16x32_bf16 v[144:147], v[40:43], v[192:195], v[144:147]
    ds_read_b64_tr_b16 v[38:39], v6 offset:43648
    v_fma_f32 v208, v208, v200, v200
    v_fma_f32 v209, v209, v200, v200
    v_fma_f32 v210, v210, v200, v200
    v_fma_f32 v211, v211, v200, v200
    s_waitcnt lgkmcnt(10)
    v_mfma_f32_16x16x32_bf16 v[148:151], v[44:47], v[188:191], v[148:151]
    ds_read_b64_tr_b16 v[40:41], v6 offset:56448
    v_rcp_f32 v204, v204
    v_rcp_f32 v205, v205
    v_rcp_f32 v206, v206
    v_rcp_f32 v207, v207
    v_mfma_f32_16x16x32_bf16 v[156:159], v[44:47], v[192:195], v[156:159]
    ds_read_b64_tr_b16 v[42:43], v6 offset:60032
    v_rcp_f32 v208, v208
    v_rcp_f32 v209, v209
    v_rcp_f32 v210, v210
    v_rcp_f32 v211, v211
    v_mfma_f32_16x16x32_bf16 v[152:155], v[48:51], v[188:191], v[152:155]
    ds_read_b64_tr_b16 v[44:45], v6 offset:40096
    v_mul_f32 v100, v100, v204
    v_mul_f32 v101, v101, v205
    v_mul_f32 v102, v102, v206
    v_mul_f32 v103, v103, v207
    v_mfma_f32_16x16x32_bf16 v[160:163], v[48:51], v[192:195], v[160:163]
    ds_read_b64_tr_b16 v[46:47], v6 offset:43680
    v_mul_f32 v116, v116, v208
    v_mul_f32 v117, v117, v209
    v_mul_f32 v118, v118, v210
    v_mul_f32 v119, v119, v211
    s_waitcnt lgkmcnt(10)
    v_mfma_f32_16x16x32_bf16 v[132:135], v[20:23], v[52:55], v[132:135]
    ds_read_b64_tr_b16 v[48:49], v6 offset:56480
    v_cvt_pk_bf16_f32 v220, v100, v101
    v_cvt_pk_bf16_f32 v221, v102, v103
    v_cvt_pk_bf16_f32 v222, v116, v117
    v_cvt_pk_bf16_f32 v223, v118, v119
    v_mfma_f32_16x16x32_bf16 v[140:143], v[20:23], v[56:59], v[140:143]
    ds_read_b64_tr_b16 v[50:51], v6 offset:60064
    buffer_store_dwordx4 v[220:223], v7, s[20:23], s46 offen offset:0 sc1
    v_mul_f32 v204, v108, v198
    v_mul_f32 v205, v109, v198
    v_mul_f32 v206, v110, v198
    v_mfma_f32_16x16x32_bf16 v[136:139], v[24:27], v[52:55], v[136:139]
    ds_read_b64_tr_b16 v[20:21], v6 offset:192
    v_mul_f32 v207, v111, v198
    v_mul_f32 v208, v124, v198
    v_mul_f32 v209, v125, v198
    v_mul_f32 v210, v126, v198
    v_mfma_f32_16x16x32_bf16 v[144:147], v[24:27], v[56:59], v[144:147]
    ds_read_b64_tr_b16 v[22:23], v6 offset:3776
    v_mul_f32 v211, v127, v198
    v_exp_f32 v204, v204
    v_exp_f32 v205, v205
    v_exp_f32 v206, v206
    s_waitcnt lgkmcnt(10)
    v_mfma_f32_16x16x32_bf16 v[148:151], v[28:31], v[52:55], v[148:151]
    ds_read_b64_tr_b16 v[24:25], v6 offset:16576
    v_exp_f32 v207, v207
    v_exp_f32 v208, v208
    v_exp_f32 v209, v209
    v_exp_f32 v210, v210
    v_mfma_f32_16x16x32_bf16 v[156:159], v[28:31], v[56:59], v[156:159]
    ds_read_b64_tr_b16 v[26:27], v6 offset:20160
    v_exp_f32 v211, v211
    v_mul_f32 v108, v108, v112
    v_mul_f32 v109, v109, v113
    v_mul_f32 v110, v110, v114
    v_mfma_f32_16x16x32_bf16 v[152:155], v[32:35], v[52:55], v[152:155]
    ds_read_b64_tr_b16 v[28:29], v6 offset:7360
    v_mul_f32 v111, v111, v115
    v_mul_f32 v124, v124, v128
    v_mul_f32 v125, v125, v129
    v_mul_f32 v126, v126, v130
    v_mfma_f32_16x16x32_bf16 v[160:163], v[32:35], v[56:59], v[160:163]
    ds_read_b64_tr_b16 v[30:31], v6 offset:10944
    v_mul_f32 v127, v127, v131
    v_fma_f32 v204, v204, v202, v202
    v_fma_f32 v205, v205, v202, v202
    v_fma_f32 v206, v206, v202, v202
    s_waitcnt lgkmcnt(10)
    v_mfma_f32_16x16x32_bf16 v[132:135], v[36:39], v[60:63], v[132:135]
    ds_read_b64_tr_b16 v[32:33], v6 offset:23744
    v_fma_f32 v207, v207, v202, v202
    v_fma_f32 v208, v208, v202, v202
    v_fma_f32 v209, v209, v202, v202
    v_fma_f32 v210, v210, v202, v202
    v_mfma_f32_16x16x32_bf16 v[140:143], v[36:39], v[64:67], v[140:143]
    ds_read_b64_tr_b16 v[34:35], v6 offset:27328
    v_fma_f32 v211, v211, v202, v202
    v_rcp_f32 v204, v204
    v_rcp_f32 v205, v205
    v_rcp_f32 v206, v206
    v_mfma_f32_16x16x32_bf16 v[136:139], v[40:43], v[60:63], v[136:139]
    ds_read_b64_tr_b16 v[36:37], v6 offset:32960
    v_rcp_f32 v207, v207
    v_rcp_f32 v208, v208
    v_rcp_f32 v209, v209
    v_mfma_f32_16x16x32_bf16 v[144:147], v[40:43], v[64:67], v[144:147]
    ds_read_b64_tr_b16 v[38:39], v6 offset:36544
    v_rcp_f32 v210, v210
    v_rcp_f32 v211, v211
    v_mul_f32 v108, v108, v204
    s_waitcnt lgkmcnt(10)
    v_mfma_f32_16x16x32_bf16 v[148:151], v[44:47], v[60:63], v[148:151]
    ds_read_b64_tr_b16 v[40:41], v6 offset:49344
    v_mul_f32 v109, v109, v205
    v_mul_f32 v110, v110, v206
    v_mul_f32 v111, v111, v207
    v_mfma_f32_16x16x32_bf16 v[156:159], v[44:47], v[64:67], v[156:159]
    ds_read_b64_tr_b16 v[42:43], v6 offset:52928
    v_mul_f32 v124, v124, v208
    v_mul_f32 v125, v125, v209
    v_mul_f32 v126, v126, v210
    v_mfma_f32_16x16x32_bf16 v[152:155], v[48:51], v[60:63], v[152:155]
    ds_read_b64_tr_b16 v[44:45], v6 offset:40128
    v_mul_f32 v127, v127, v211
    v_cvt_pk_bf16_f32 v212, v108, v109
    v_cvt_pk_bf16_f32 v213, v110, v111
    v_mfma_f32_16x16x32_bf16 v[160:163], v[48:51], v[64:67], v[160:163]
    ds_read_b64_tr_b16 v[46:47], v6 offset:43712
    v_cvt_pk_bf16_f32 v214, v124, v125
    v_cvt_pk_bf16_f32 v215, v126, v127
    buffer_store_dwordx4 v[212:215], v7, s[20:23], s46 offen offset:1024 sc1
    s_waitcnt lgkmcnt(10)
    v_mfma_f32_16x16x32_bf16 v[164:167], v[20:23], v[180:183], v[164:167]
    ds_read_b64_tr_b16 v[48:49], v6 offset:56512
    v_mfma_f32_16x16x32_bf16 v[172:175], v[20:23], v[184:187], v[172:175]
    ds_read_b64_tr_b16 v[50:51], v6 offset:60096
    v_mfma_f32_16x16x32_bf16 v[168:171], v[24:27], v[180:183], v[168:171]
    v_mfma_f32_16x16x32_bf16 v[176:179], v[24:27], v[184:187], v[176:179]
    s_waitcnt lgkmcnt(8)
    v_mfma_f32_16x16x32_bf16 v[164:167], v[28:31], v[188:191], v[164:167]
    v_mul_f32 v204, v132, v196
    v_mul_f32 v205, v133, v196
    v_mul_f32 v206, v134, v196
    v_mul_f32 v207, v135, v196
    v_mul_f32 v208, v148, v196
    v_mul_f32 v209, v149, v196
    v_mul_f32 v210, v150, v196
    v_mul_f32 v211, v151, v196
    v_exp_f32 v204, v204
    v_mfma_f32_16x16x32_bf16 v[172:175], v[28:31], v[192:195], v[172:175]
    v_exp_f32 v205, v205
    v_exp_f32 v206, v206
    v_exp_f32 v207, v207
    v_exp_f32 v208, v208
    v_exp_f32 v209, v209
    v_exp_f32 v210, v210
    v_exp_f32 v211, v211
    v_mul_f32 v132, v132, v136
    v_mul_f32 v133, v133, v137
    v_mfma_f32_16x16x32_bf16 v[168:171], v[32:35], v[188:191], v[168:171]
    v_mul_f32 v134, v134, v138
    v_mul_f32 v135, v135, v139
    v_mul_f32 v148, v148, v152
    v_mul_f32 v149, v149, v153
    v_mul_f32 v150, v150, v154
    v_mul_f32 v151, v151, v155
    v_fma_f32 v204, v204, v200, v200
    v_fma_f32 v205, v205, v200, v200
    v_fma_f32 v206, v206, v200, v200
    v_mfma_f32_16x16x32_bf16 v[176:179], v[32:35], v[192:195], v[176:179]
    v_fma_f32 v207, v207, v200, v200
    v_fma_f32 v208, v208, v200, v200
    v_fma_f32 v209, v209, v200, v200
    v_fma_f32 v210, v210, v200, v200
    v_fma_f32 v211, v211, v200, v200
    v_rcp_f32 v204, v204
    v_rcp_f32 v205, v205
    v_rcp_f32 v206, v206
    v_rcp_f32 v207, v207
    s_waitcnt lgkmcnt(4)
    v_mfma_f32_16x16x32_bf16 v[164:167], v[36:39], v[52:55], v[164:167]
    v_rcp_f32 v208, v208
    v_rcp_f32 v209, v209
    v_rcp_f32 v210, v210
    v_rcp_f32 v211, v211
    v_mul_f32 v132, v132, v204
    v_mul_f32 v133, v133, v205
    v_mul_f32 v134, v134, v206
    v_mul_f32 v135, v135, v207
    v_mul_f32 v148, v148, v208
    v_mfma_f32_16x16x32_bf16 v[172:175], v[36:39], v[56:59], v[172:175]
    v_mul_f32 v149, v149, v209
    v_mul_f32 v150, v150, v210
    v_mul_f32 v151, v151, v211
    v_cvt_pk_bf16_f32 v216, v132, v133
    v_cvt_pk_bf16_f32 v217, v134, v135
    v_cvt_pk_bf16_f32 v218, v148, v149
    v_cvt_pk_bf16_f32 v219, v150, v151
    buffer_store_dwordx4 v[216:219], v7, s[20:23], s46 offen offset:2048 sc1
    v_mul_f32 v204, v140, v198
    v_mfma_f32_16x16x32_bf16 v[168:171], v[40:43], v[52:55], v[168:171]
    v_mul_f32 v205, v141, v198
    v_mul_f32 v206, v142, v198
    v_mul_f32 v207, v143, v198
    v_mul_f32 v208, v156, v198
    v_mul_f32 v209, v157, v198
    v_mul_f32 v210, v158, v198
    v_mul_f32 v211, v159, v198
    v_exp_f32 v204, v204
    v_exp_f32 v205, v205
    v_mfma_f32_16x16x32_bf16 v[176:179], v[40:43], v[56:59], v[176:179]
    v_exp_f32 v206, v206
    v_exp_f32 v207, v207
    v_exp_f32 v208, v208
    v_exp_f32 v209, v209
    v_exp_f32 v210, v210
    v_exp_f32 v211, v211
    v_mul_f32 v140, v140, v144
    v_mul_f32 v141, v141, v145
    v_mul_f32 v142, v142, v146
    s_waitcnt lgkmcnt(0)
    v_mfma_f32_16x16x32_bf16 v[164:167], v[44:47], v[60:63], v[164:167]
    v_mul_f32 v143, v143, v147
    v_mul_f32 v156, v156, v160
    v_mul_f32 v157, v157, v161
    v_mul_f32 v158, v158, v162
    v_mul_f32 v159, v159, v163
    v_fma_f32 v204, v204, v202, v202
    v_fma_f32 v205, v205, v202, v202
    v_fma_f32 v206, v206, v202, v202
    v_fma_f32 v207, v207, v202, v202
    v_mfma_f32_16x16x32_bf16 v[172:175], v[44:47], v[64:67], v[172:175]
    v_fma_f32 v208, v208, v202, v202
    v_fma_f32 v209, v209, v202, v202
    v_fma_f32 v210, v210, v202, v202
    v_fma_f32 v211, v211, v202, v202
    v_rcp_f32 v204, v204
    v_rcp_f32 v205, v205
    v_rcp_f32 v206, v206
    v_rcp_f32 v207, v207
    v_rcp_f32 v208, v208
    v_mfma_f32_16x16x32_bf16 v[168:171], v[48:51], v[60:63], v[168:171]
    v_rcp_f32 v209, v209
    v_rcp_f32 v210, v210
    v_rcp_f32 v211, v211
    v_mul_f32 v140, v140, v204
    v_mul_f32 v141, v141, v205
    v_mul_f32 v142, v142, v206
    v_mul_f32 v143, v143, v207
    v_mul_f32 v156, v156, v208
    v_mfma_f32_16x16x32_bf16 v[176:179], v[48:51], v[64:67], v[176:179]
    v_mul_f32 v157, v157, v209
    v_mul_f32 v158, v158, v210
    v_mul_f32 v159, v159, v211
    v_cvt_pk_bf16_f32 v220, v140, v141
    v_cvt_pk_bf16_f32 v221, v142, v143
    v_cvt_pk_bf16_f32 v222, v156, v157
    v_cvt_pk_bf16_f32 v223, v158, v159
    buffer_store_dwordx4 v[220:223], v7, s[20:23], s46 offen offset:3072 sc1
    s_nop 7
    v_pk_mul_f32 v[204:205], v[164:165], v[196:197] op_sel_hi:[1,0]
    v_pk_mul_f32 v[206:207], v[166:167], v[196:197] op_sel_hi:[1,0]
    v_exp_f32 v204, v204
    v_exp_f32 v205, v205
    v_exp_f32 v206, v206
    v_exp_f32 v207, v207
    v_pk_mul_f32 v[164:165], v[164:165], v[168:169]
    v_pk_mul_f32 v[166:167], v[166:167], v[170:171]
    v_pk_fma_f32 v[204:205], v[204:205], v[200:201], v[200:201] op_sel_hi:[1,0,0]
    v_pk_fma_f32 v[206:207], v[206:207], v[200:201], v[200:201] op_sel_hi:[1,0,0]
    v_rcp_f32 v204, v204
    v_rcp_f32 v205, v205
    v_rcp_f32 v206, v206
    v_rcp_f32 v207, v207
    v_pk_mul_f32 v[164:165], v[164:165], v[204:205]
    v_pk_mul_f32 v[166:167], v[166:167], v[206:207]
    v_cvt_pk_bf16_f32 v212, v164, v165
    v_cvt_pk_bf16_f32 v213, v166, v167
    buffer_store_dwordx2 v[212:213], v7, s[20:23], s39 offen offset:0 sc1
    v_pk_mul_f32 v[204:205], v[172:173], v[198:199] op_sel_hi:[1,0]
    v_pk_mul_f32 v[206:207], v[174:175], v[198:199] op_sel_hi:[1,0]
    v_exp_f32 v204, v204
    v_exp_f32 v205, v205
    v_exp_f32 v206, v206
    v_exp_f32 v207, v207
    v_pk_mul_f32 v[172:173], v[172:173], v[176:177]
    v_pk_mul_f32 v[174:175], v[174:175], v[178:179]
    v_pk_fma_f32 v[204:205], v[204:205], v[202:203], v[202:203] op_sel_hi:[1,0,0]
    v_pk_fma_f32 v[206:207], v[206:207], v[202:203], v[202:203] op_sel_hi:[1,0,0]
    v_rcp_f32 v204, v204
    v_rcp_f32 v205, v205
    v_rcp_f32 v206, v206
    v_rcp_f32 v207, v207
    v_pk_mul_f32 v[172:173], v[172:173], v[204:205]
    v_pk_mul_f32 v[174:175], v[174:175], v[206:207]
    v_cvt_pk_bf16_f32 v216, v172, v173
    v_cvt_pk_bf16_f32 v217, v174, v175
    buffer_store_dwordx2 v[216:217], v7, s[20:23], s39 offen offset:1024 sc1
    s_setprio 0
    s_lshl_b32 s31, s33, 1
    s_lshr_b32 s32, s34, 4
    s_add_u32 s31, s31, s32
    s_lshl_b32 s99, s98, 6
    s_add_u32 s99, s99, s31
    s_add_u32 s99, s99, 40
    s_mul_i32 s99, s99, 256
    s_branch pd
pd:
    s_load_dwordx2 s[6:7], s[0:1], 56
    s_and_b32 s31, s2, 7
    s_lshr_b32 s32, s2, 3
    s_lshr_b32 s33, s31, 1
    s_lshl_b32 s33, s33, 2
    s_lshr_b32 s34, s32, 3
    s_add_u32 s33, s33, s34
    s_and_b32 s34, s31, 1
    s_and_b32 s32, s32, 7
    s_lshl_b32 s32, s32, 1
    s_add_u32 s34, s34, s32
    s_lshr_b32 s45, s33, 1
    s_and_b32 s31, s33, 14
    s_and_b32 s32, s34, 1
    s_add_u32 s31, s31, s32
    s_lshl_b32 s100, s98, 6
    s_add_u32 s100, s100, s31
    s_add_u32 s100, s100, 40
    s_mov_b32 s101, 16
    s_mul_i32 s100, s100, 256
    s_cmp_ge_u32 s3, 4
    s_cbranch_scc1 pd_idle
    v_and_b32 v9, 63, v0
    v_lshlrev_b32 v9, 4, v9
    s_lshl_b32 s35, s33, 2
    s_add_u32 s35, s35, s3
    s_lshl_b32 s37, s35, 16
    s_lshl_b32 s38, s34, 12
    s_add_u32 s37, s37, s38
    s_add_u32 s20, s28, s37
    s_addc_u32 s21, s29, 0
    s_mov_b32 s22, 4096
    s_mov_b32 s23, 0x00020000
    v_and_b32 v10, 63, v0
    v_lshrrev_b32 v11, 3, v10
    v_mul_u32_u24 v1, 2048, v11
    v_and_b32 v12, 7, v10
    v_and_b32 v11, 6, v11
    v_xor_b32 v12, v12, v11
    v_lshl_add_u32 v1, v12, 4, v1
    v_and_b32 v11, 3, v10
    v_lshlrev_b32 v5, 3, v11
    v_lshrrev_b32 v11, 2, v10
    v_lshl_add_u32 v5, v11, 7, v5
    v_bfe_u32 v11, v10, 3, 2
    v_lshl_add_u32 v5, v11, 5, v5
    v_xor_b32 v6, 32, v5
    v_xor_b32 v7, 64, v5
    v_xor_b32 v8, 96, v5
    s_lshr_b32 s36, s34, 1
    s_add_u32 s36, s36, s33
    s_and_b32 s36, s36, 3
    s_mov_b32 s96, 0
    s_cmp_eq_u32 s36, 0
    s_cselect_b32 s92, 3, -1
    s_cmp_eq_u32 s36, 1
    s_cselect_b32 s93, 3, -1
    s_cmp_eq_u32 s36, 2
    s_cselect_b32 s94, 3, -1
    s_cmp_eq_u32 s36, 3
    s_cselect_b32 s95, 3, -1
    s_add_u32 s84, s96, s92
    s_add_u32 s97, s84, 28
    s_min_u32 s84, s84, s97
    s_sub_u32 s97, s84, 28
    s_min_u32 s84, s84, s97
    s_cmp_ge_u32 s96, 28
    s_cselect_b32 s84, 28, s84
    s_add_u32 s96, s96, 1
    s_add_u32 s85, s96, s93
    s_add_u32 s97, s85, 28
    s_min_u32 s85, s85, s97
    s_sub_u32 s97, s85, 28
    s_min_u32 s85, s85, s97
    s_cmp_ge_u32 s96, 28
    s_cselect_b32 s85, 28, s85
    s_add_u32 s96, s96, 1
    v_add_u32 v5, 98304, v5
    v_add_u32 v6, 98304, v6
    v_add_u32 v7, 98304, v7
    v_add_u32 v8, 98304, v8
    s_mul_i32 s36, s35, 229376
    s_add_u32 s36, s36, 12582912
    s_and_b32 s37, s34, 1
    s_mul_i32 s37, s37, 114688
    s_add_u32 s36, s36, s37
    s_add_u32 s12, s28, s36
    s_addc_u32 s13, s29, 0
    s_mov_b32 s14, 114688
    s_mov_b32 s15, 0x00020000
    s_waitcnt lgkmcnt(0)
    s_waitcnt vmcnt(0)
    s_barrier
    ds_read_b64_tr_b16 v[80:81], v5 offset:32768
    ds_read_b64_tr_b16 v[82:83], v5 offset:34816
    ds_read_b64_tr_b16 v[84:85], v6 offset:32768
    ds_read_b64_tr_b16 v[86:87], v6 offset:34816
    ds_read_b64_tr_b16 v[88:89], v7 offset:32768
    ds_read_b64_tr_b16 v[90:91], v7 offset:34816
    ds_read_b64_tr_b16 v[92:93], v8 offset:32768
    ds_read_b64_tr_b16 v[94:95], v8 offset:34816
    ds_read_b64_tr_b16 v[96:97], v5 offset:40960
    ds_read_b64_tr_b16 v[98:99], v5 offset:43008
    ds_read_b64_tr_b16 v[100:101], v6 offset:40960
    ds_read_b64_tr_b16 v[102:103], v6 offset:43008
    v_lshlrev_b32 v16, 16, v228
    v_and_b32 v17, 0xffff0000, v228
    v_lshlrev_b32 v18, 16, v229
    v_and_b32 v19, 0xffff0000, v229
    v_lshlrev_b32 v20, 16, v230
    v_and_b32 v21, 0xffff0000, v230
    v_lshlrev_b32 v22, 16, v231
    v_and_b32 v23, 0xffff0000, v231
    v_lshlrev_b32 v24, 16, v232
    v_and_b32 v25, 0xffff0000, v232
    v_lshlrev_b32 v26, 16, v233
    v_and_b32 v27, 0xffff0000, v233
    v_lshlrev_b32 v28, 16, v234
    v_and_b32 v29, 0xffff0000, v234
    v_lshlrev_b32 v30, 16, v235
    v_and_b32 v31, 0xffff0000, v235
    v_lshlrev_b32 v32, 16, v236
    v_and_b32 v33, 0xffff0000, v236
    v_lshlrev_b32 v34, 16, v237
    v_and_b32 v35, 0xffff0000, v237
    v_lshlrev_b32 v36, 16, v238
    v_and_b32 v37, 0xffff0000, v238
    v_lshlrev_b32 v38, 16, v239
    v_and_b32 v39, 0xffff0000, v239
    v_lshlrev_b32 v40, 16, v240
    v_and_b32 v41, 0xffff0000, v240
    v_lshlrev_b32 v42, 16, v241
    v_and_b32 v43, 0xffff0000, v241
    v_lshlrev_b32 v44, 16, v242
    v_and_b32 v45, 0xffff0000, v242
    v_lshlrev_b32 v46, 16, v243
    v_and_b32 v47, 0xffff0000, v243
    v_pk_mov_b32 v[48:49], 0, 0
    v_pk_mov_b32 v[50:51], 0, 0
    v_pk_mov_b32 v[52:53], 0, 0
    v_pk_mov_b32 v[54:55], 0, 0
    v_pk_mov_b32 v[56:57], 0, 0
    v_pk_mov_b32 v[58:59], 0, 0
    v_pk_mov_b32 v[60:61], 0, 0
    v_pk_mov_b32 v[62:63], 0, 0
    v_pk_mov_b32 v[64:65], 0, 0
    v_pk_mov_b32 v[66:67], 0, 0
    v_pk_mov_b32 v[68:69], 0, 0
    v_pk_mov_b32 v[70:71], 0, 0
    v_pk_mov_b32 v[72:73], 0, 0
    v_pk_mov_b32 v[74:75], 0, 0
    v_pk_mov_b32 v[76:77], 0, 0
    v_pk_mov_b32 v[78:79], 0, 0
    s_barrier
    s_mul_i32 s42, s84, 4096
    buffer_load_dwordx4 v[112:115], v9, s[12:15], s42 offen sc1
    buffer_load_dwordx4 v[116:119], v9, s[12:15], s42 offen offset:1024 sc1
    buffer_load_dwordx4 v[120:123], v9, s[12:15], s42 offen offset:2048 sc1
    buffer_load_dwordx4 v[124:127], v9, s[12:15], s42 offen offset:3072 sc1
    s_mul_i32 s42, s85, 4096
    buffer_load_dwordx4 v[128:131], v9, s[12:15], s42 offen sc1
    buffer_load_dwordx4 v[132:135], v9, s[12:15], s42 offen offset:1024 sc1
    buffer_load_dwordx4 v[136:139], v9, s[12:15], s42 offen offset:2048 sc1
    buffer_load_dwordx4 v[140:143], v9, s[12:15], s42 offen offset:3072 sc1
    s_mov_b32 s43, 7
    .p2align 6
pd_loop:
    s_waitcnt vmcnt(7) lgkmcnt(8)
    v_mfma_f32_16x16x32_bf16 v[16:19], v[80:83], v[112:115], v[16:19]
    s_add_u32 s86, s96, s94
    ds_read_b64_tr_b16 v[104:105], v7 offset:40960
    s_waitcnt vmcnt(6)
    v_mfma_f32_16x16x32_bf16 v[24:27], v[80:83], v[116:119], v[24:27]
    s_add_u32 s97, s86, 28
    ds_read_b64_tr_b16 v[106:107], v7 offset:43008
    v_mfma_f32_16x16x32_bf16 v[20:23], v[84:87], v[112:115], v[20:23]
    s_min_u32 s86, s86, s97
    ds_read_b64_tr_b16 v[108:109], v8 offset:40960
    v_mfma_f32_16x16x32_bf16 v[28:31], v[84:87], v[116:119], v[28:31]
    s_sub_u32 s97, s86, 28
    ds_read_b64_tr_b16 v[110:111], v8 offset:43008
    s_waitcnt lgkmcnt(8)
    v_mfma_f32_16x16x32_bf16 v[32:35], v[88:91], v[112:115], v[32:35]
    s_min_u32 s86, s86, s97
    ds_read_b64_tr_b16 v[80:81], v5 offset:36864
    v_mfma_f32_16x16x32_bf16 v[40:43], v[88:91], v[116:119], v[40:43]
    s_cmp_ge_u32 s96, 28
    s_cselect_b32 s86, 28, s86
    ds_read_b64_tr_b16 v[82:83], v5 offset:38912
    v_mfma_f32_16x16x32_bf16 v[36:39], v[92:95], v[112:115], v[36:39]
    s_add_u32 s96, s96, 1
    s_mul_i32 s42, s86, 4096
    ds_read_b64_tr_b16 v[84:85], v6 offset:36864
    v_mfma_f32_16x16x32_bf16 v[44:47], v[92:95], v[116:119], v[44:47]
    ds_read_b64_tr_b16 v[86:87], v6 offset:38912
    s_waitcnt lgkmcnt(8)
    v_mfma_f32_16x16x32_bf16 v[48:51], v[96:99], v[112:115], v[48:51]
    ds_read_b64_tr_b16 v[88:89], v7 offset:36864
    v_mfma_f32_16x16x32_bf16 v[56:59], v[96:99], v[116:119], v[56:59]
    ds_read_b64_tr_b16 v[90:91], v7 offset:38912
    v_mfma_f32_16x16x32_bf16 v[52:55], v[100:103], v[112:115], v[52:55]
    ds_read_b64_tr_b16 v[92:93], v8 offset:36864
    v_mfma_f32_16x16x32_bf16 v[60:63], v[100:103], v[116:119], v[60:63]
    ds_read_b64_tr_b16 v[94:95], v8 offset:38912
    s_waitcnt lgkmcnt(8)
    v_mfma_f32_16x16x32_bf16 v[64:67], v[104:107], v[112:115], v[64:67]
    ds_read_b64_tr_b16 v[96:97], v5 offset:45056
    v_mfma_f32_16x16x32_bf16 v[72:75], v[104:107], v[116:119], v[72:75]
    ds_read_b64_tr_b16 v[98:99], v5 offset:47104
    v_mfma_f32_16x16x32_bf16 v[68:71], v[108:111], v[112:115], v[68:71]
    ds_read_b64_tr_b16 v[100:101], v6 offset:45056
    buffer_load_dwordx4 v[112:115], v9, s[12:15], s42 offen sc1
    v_mfma_f32_16x16x32_bf16 v[76:79], v[108:111], v[116:119], v[76:79]
    ds_read_b64_tr_b16 v[102:103], v6 offset:47104
    buffer_load_dwordx4 v[116:119], v9, s[12:15], s42 offen offset:1024 sc1
    s_waitcnt vmcnt(7) lgkmcnt(8)
    v_mfma_f32_16x16x32_bf16 v[16:19], v[80:83], v[120:123], v[16:19]
    ds_read_b64_tr_b16 v[104:105], v7 offset:45056
    s_waitcnt vmcnt(6)
    v_mfma_f32_16x16x32_bf16 v[24:27], v[80:83], v[124:127], v[24:27]
    ds_read_b64_tr_b16 v[106:107], v7 offset:47104
    v_mfma_f32_16x16x32_bf16 v[20:23], v[84:87], v[120:123], v[20:23]
    ds_read_b64_tr_b16 v[108:109], v8 offset:45056
    v_mfma_f32_16x16x32_bf16 v[28:31], v[84:87], v[124:127], v[28:31]
    ds_read_b64_tr_b16 v[110:111], v8 offset:47104
    s_waitcnt lgkmcnt(8)
    v_mfma_f32_16x16x32_bf16 v[32:35], v[88:91], v[120:123], v[32:35]
    s_barrier
    ds_read_b64_tr_b16 v[80:81], v5 offset:49152
    v_mfma_f32_16x16x32_bf16 v[40:43], v[88:91], v[124:127], v[40:43]
    ds_read_b64_tr_b16 v[82:83], v5 offset:51200
    v_mfma_f32_16x16x32_bf16 v[36:39], v[92:95], v[120:123], v[36:39]
    ds_read_b64_tr_b16 v[84:85], v6 offset:49152
    v_mfma_f32_16x16x32_bf16 v[44:47], v[92:95], v[124:127], v[44:47]
    ds_read_b64_tr_b16 v[86:87], v6 offset:51200
    s_waitcnt lgkmcnt(8)
    v_mfma_f32_16x16x32_bf16 v[48:51], v[96:99], v[120:123], v[48:51]
    ds_read_b64_tr_b16 v[88:89], v7 offset:49152
    v_mfma_f32_16x16x32_bf16 v[56:59], v[96:99], v[124:127], v[56:59]
    ds_read_b64_tr_b16 v[90:91], v7 offset:51200
    v_mfma_f32_16x16x32_bf16 v[52:55], v[100:103], v[120:123], v[52:55]
    ds_read_b64_tr_b16 v[92:93], v8 offset:49152
    v_mfma_f32_16x16x32_bf16 v[60:63], v[100:103], v[124:127], v[60:63]
    ds_read_b64_tr_b16 v[94:95], v8 offset:51200
    s_waitcnt lgkmcnt(8)
    v_mfma_f32_16x16x32_bf16 v[64:67], v[104:107], v[120:123], v[64:67]
    ds_read_b64_tr_b16 v[96:97], v5 offset:57344
    v_mfma_f32_16x16x32_bf16 v[72:75], v[104:107], v[124:127], v[72:75]
    ds_read_b64_tr_b16 v[98:99], v5 offset:59392
    v_mfma_f32_16x16x32_bf16 v[68:71], v[108:111], v[120:123], v[68:71]
    ds_read_b64_tr_b16 v[100:101], v6 offset:57344
    buffer_load_dwordx4 v[120:123], v9, s[12:15], s42 offen offset:2048 sc1
    v_mfma_f32_16x16x32_bf16 v[76:79], v[108:111], v[124:127], v[76:79]
    ds_read_b64_tr_b16 v[102:103], v6 offset:59392
    buffer_load_dwordx4 v[124:127], v9, s[12:15], s42 offen offset:3072 sc1
    s_waitcnt vmcnt(7) lgkmcnt(8)
    v_mfma_f32_16x16x32_bf16 v[16:19], v[80:83], v[128:131], v[16:19]
    s_add_u32 s87, s96, s95
    ds_read_b64_tr_b16 v[104:105], v7 offset:57344
    s_waitcnt vmcnt(6)
    v_mfma_f32_16x16x32_bf16 v[24:27], v[80:83], v[132:135], v[24:27]
    s_add_u32 s97, s87, 28
    ds_read_b64_tr_b16 v[106:107], v7 offset:59392
    v_mfma_f32_16x16x32_bf16 v[20:23], v[84:87], v[128:131], v[20:23]
    s_min_u32 s87, s87, s97
    ds_read_b64_tr_b16 v[108:109], v8 offset:57344
    v_mfma_f32_16x16x32_bf16 v[28:31], v[84:87], v[132:135], v[28:31]
    s_sub_u32 s97, s87, 28
    ds_read_b64_tr_b16 v[110:111], v8 offset:59392
    s_waitcnt lgkmcnt(8)
    v_mfma_f32_16x16x32_bf16 v[32:35], v[88:91], v[128:131], v[32:35]
    s_min_u32 s87, s87, s97
    ds_read_b64_tr_b16 v[80:81], v5 offset:53248
    v_mfma_f32_16x16x32_bf16 v[40:43], v[88:91], v[132:135], v[40:43]
    s_cmp_ge_u32 s96, 28
    s_cselect_b32 s87, 28, s87
    ds_read_b64_tr_b16 v[82:83], v5 offset:55296
    v_mfma_f32_16x16x32_bf16 v[36:39], v[92:95], v[128:131], v[36:39]
    s_add_u32 s96, s96, 1
    s_mul_i32 s42, s87, 4096
    ds_read_b64_tr_b16 v[84:85], v6 offset:53248
    v_mfma_f32_16x16x32_bf16 v[44:47], v[92:95], v[132:135], v[44:47]
    ds_read_b64_tr_b16 v[86:87], v6 offset:55296
    s_waitcnt lgkmcnt(8)
    v_mfma_f32_16x16x32_bf16 v[48:51], v[96:99], v[128:131], v[48:51]
    ds_read_b64_tr_b16 v[88:89], v7 offset:53248
    v_mfma_f32_16x16x32_bf16 v[56:59], v[96:99], v[132:135], v[56:59]
    ds_read_b64_tr_b16 v[90:91], v7 offset:55296
    v_mfma_f32_16x16x32_bf16 v[52:55], v[100:103], v[128:131], v[52:55]
    ds_read_b64_tr_b16 v[92:93], v8 offset:53248
    v_mfma_f32_16x16x32_bf16 v[60:63], v[100:103], v[132:135], v[60:63]
    ds_read_b64_tr_b16 v[94:95], v8 offset:55296
    s_waitcnt lgkmcnt(8)
    v_mfma_f32_16x16x32_bf16 v[64:67], v[104:107], v[128:131], v[64:67]
    ds_read_b64_tr_b16 v[96:97], v5 offset:61440
    v_mfma_f32_16x16x32_bf16 v[72:75], v[104:107], v[132:135], v[72:75]
    ds_read_b64_tr_b16 v[98:99], v5 offset:63488
    v_mfma_f32_16x16x32_bf16 v[68:71], v[108:111], v[128:131], v[68:71]
    ds_read_b64_tr_b16 v[100:101], v6 offset:61440
    buffer_load_dwordx4 v[128:131], v9, s[12:15], s42 offen sc1
    v_mfma_f32_16x16x32_bf16 v[76:79], v[108:111], v[132:135], v[76:79]
    ds_read_b64_tr_b16 v[102:103], v6 offset:63488
    buffer_load_dwordx4 v[132:135], v9, s[12:15], s42 offen offset:1024 sc1
    s_waitcnt vmcnt(7) lgkmcnt(8)
    v_mfma_f32_16x16x32_bf16 v[16:19], v[80:83], v[136:139], v[16:19]
    ds_read_b64_tr_b16 v[104:105], v7 offset:61440
    s_waitcnt vmcnt(6)
    v_mfma_f32_16x16x32_bf16 v[24:27], v[80:83], v[140:143], v[24:27]
    ds_read_b64_tr_b16 v[106:107], v7 offset:63488
    v_mfma_f32_16x16x32_bf16 v[20:23], v[84:87], v[136:139], v[20:23]
    ds_read_b64_tr_b16 v[108:109], v8 offset:61440
    v_mfma_f32_16x16x32_bf16 v[28:31], v[84:87], v[140:143], v[28:31]
    ds_read_b64_tr_b16 v[110:111], v8 offset:63488
    s_waitcnt lgkmcnt(8)
    v_mfma_f32_16x16x32_bf16 v[32:35], v[88:91], v[136:139], v[32:35]
    s_barrier
    ds_read_b64_tr_b16 v[80:81], v5 offset:0
    v_mfma_f32_16x16x32_bf16 v[40:43], v[88:91], v[140:143], v[40:43]
    ds_read_b64_tr_b16 v[82:83], v5 offset:2048
    v_mfma_f32_16x16x32_bf16 v[36:39], v[92:95], v[136:139], v[36:39]
    ds_read_b64_tr_b16 v[84:85], v6 offset:0
    v_mfma_f32_16x16x32_bf16 v[44:47], v[92:95], v[140:143], v[44:47]
    ds_read_b64_tr_b16 v[86:87], v6 offset:2048
    s_waitcnt lgkmcnt(8)
    v_mfma_f32_16x16x32_bf16 v[48:51], v[96:99], v[136:139], v[48:51]
    ds_read_b64_tr_b16 v[88:89], v7 offset:0
    v_mfma_f32_16x16x32_bf16 v[56:59], v[96:99], v[140:143], v[56:59]
    ds_read_b64_tr_b16 v[90:91], v7 offset:2048
    v_mfma_f32_16x16x32_bf16 v[52:55], v[100:103], v[136:139], v[52:55]
    ds_read_b64_tr_b16 v[92:93], v8 offset:0
    v_mfma_f32_16x16x32_bf16 v[60:63], v[100:103], v[140:143], v[60:63]
    ds_read_b64_tr_b16 v[94:95], v8 offset:2048
    s_waitcnt lgkmcnt(8)
    v_mfma_f32_16x16x32_bf16 v[64:67], v[104:107], v[136:139], v[64:67]
    ds_read_b64_tr_b16 v[96:97], v5 offset:8192
    v_mfma_f32_16x16x32_bf16 v[72:75], v[104:107], v[140:143], v[72:75]
    ds_read_b64_tr_b16 v[98:99], v5 offset:10240
    v_mfma_f32_16x16x32_bf16 v[68:71], v[108:111], v[136:139], v[68:71]
    ds_read_b64_tr_b16 v[100:101], v6 offset:8192
    buffer_load_dwordx4 v[136:139], v9, s[12:15], s42 offen offset:2048 sc1
    v_mfma_f32_16x16x32_bf16 v[76:79], v[108:111], v[140:143], v[76:79]
    ds_read_b64_tr_b16 v[102:103], v6 offset:10240
    buffer_load_dwordx4 v[140:143], v9, s[12:15], s42 offen offset:3072 sc1
    s_waitcnt vmcnt(7) lgkmcnt(8)
    v_mfma_f32_16x16x32_bf16 v[16:19], v[80:83], v[112:115], v[16:19]
    s_add_u32 s84, s96, s92
    ds_read_b64_tr_b16 v[104:105], v7 offset:8192
    s_waitcnt vmcnt(6)
    v_mfma_f32_16x16x32_bf16 v[24:27], v[80:83], v[116:119], v[24:27]
    s_add_u32 s97, s84, 28
    ds_read_b64_tr_b16 v[106:107], v7 offset:10240
    v_mfma_f32_16x16x32_bf16 v[20:23], v[84:87], v[112:115], v[20:23]
    s_min_u32 s84, s84, s97
    ds_read_b64_tr_b16 v[108:109], v8 offset:8192
    v_mfma_f32_16x16x32_bf16 v[28:31], v[84:87], v[116:119], v[28:31]
    s_sub_u32 s97, s84, 28
    ds_read_b64_tr_b16 v[110:111], v8 offset:10240
    s_waitcnt lgkmcnt(8)
    v_mfma_f32_16x16x32_bf16 v[32:35], v[88:91], v[112:115], v[32:35]
    s_min_u32 s84, s84, s97
    ds_read_b64_tr_b16 v[80:81], v5 offset:4096
    v_mfma_f32_16x16x32_bf16 v[40:43], v[88:91], v[116:119], v[40:43]
    s_cmp_ge_u32 s96, 28
    s_cselect_b32 s84, 28, s84
    ds_read_b64_tr_b16 v[82:83], v5 offset:6144
    v_mfma_f32_16x16x32_bf16 v[36:39], v[92:95], v[112:115], v[36:39]
    s_add_u32 s96, s96, 1
    s_mul_i32 s42, s84, 4096
    ds_read_b64_tr_b16 v[84:85], v6 offset:4096
    v_mfma_f32_16x16x32_bf16 v[44:47], v[92:95], v[116:119], v[44:47]
    ds_read_b64_tr_b16 v[86:87], v6 offset:6144
    s_waitcnt lgkmcnt(8)
    v_mfma_f32_16x16x32_bf16 v[48:51], v[96:99], v[112:115], v[48:51]
    ds_read_b64_tr_b16 v[88:89], v7 offset:4096
    v_mfma_f32_16x16x32_bf16 v[56:59], v[96:99], v[116:119], v[56:59]
    ds_read_b64_tr_b16 v[90:91], v7 offset:6144
    v_mfma_f32_16x16x32_bf16 v[52:55], v[100:103], v[112:115], v[52:55]
    ds_read_b64_tr_b16 v[92:93], v8 offset:4096
    v_mfma_f32_16x16x32_bf16 v[60:63], v[100:103], v[116:119], v[60:63]
    ds_read_b64_tr_b16 v[94:95], v8 offset:6144
    s_waitcnt lgkmcnt(8)
    v_mfma_f32_16x16x32_bf16 v[64:67], v[104:107], v[112:115], v[64:67]
    ds_read_b64_tr_b16 v[96:97], v5 offset:12288
    v_mfma_f32_16x16x32_bf16 v[72:75], v[104:107], v[116:119], v[72:75]
    ds_read_b64_tr_b16 v[98:99], v5 offset:14336
    v_mfma_f32_16x16x32_bf16 v[68:71], v[108:111], v[112:115], v[68:71]
    ds_read_b64_tr_b16 v[100:101], v6 offset:12288
    buffer_load_dwordx4 v[112:115], v9, s[12:15], s42 offen sc1
    v_mfma_f32_16x16x32_bf16 v[76:79], v[108:111], v[116:119], v[76:79]
    ds_read_b64_tr_b16 v[102:103], v6 offset:14336
    buffer_load_dwordx4 v[116:119], v9, s[12:15], s42 offen offset:1024 sc1
    s_waitcnt vmcnt(7) lgkmcnt(8)
    v_mfma_f32_16x16x32_bf16 v[16:19], v[80:83], v[120:123], v[16:19]
    ds_read_b64_tr_b16 v[104:105], v7 offset:12288
    s_waitcnt vmcnt(6)
    v_mfma_f32_16x16x32_bf16 v[24:27], v[80:83], v[124:127], v[24:27]
    ds_read_b64_tr_b16 v[106:107], v7 offset:14336
    v_mfma_f32_16x16x32_bf16 v[20:23], v[84:87], v[120:123], v[20:23]
    ds_read_b64_tr_b16 v[108:109], v8 offset:12288
    v_mfma_f32_16x16x32_bf16 v[28:31], v[84:87], v[124:127], v[28:31]
    ds_read_b64_tr_b16 v[110:111], v8 offset:14336
    s_waitcnt lgkmcnt(8)
    v_mfma_f32_16x16x32_bf16 v[32:35], v[88:91], v[120:123], v[32:35]
    s_barrier
    ds_read_b64_tr_b16 v[80:81], v5 offset:16384
    v_mfma_f32_16x16x32_bf16 v[40:43], v[88:91], v[124:127], v[40:43]
    ds_read_b64_tr_b16 v[82:83], v5 offset:18432
    v_mfma_f32_16x16x32_bf16 v[36:39], v[92:95], v[120:123], v[36:39]
    ds_read_b64_tr_b16 v[84:85], v6 offset:16384
    v_mfma_f32_16x16x32_bf16 v[44:47], v[92:95], v[124:127], v[44:47]
    ds_read_b64_tr_b16 v[86:87], v6 offset:18432
    s_waitcnt lgkmcnt(8)
    v_mfma_f32_16x16x32_bf16 v[48:51], v[96:99], v[120:123], v[48:51]
    ds_read_b64_tr_b16 v[88:89], v7 offset:16384
    v_mfma_f32_16x16x32_bf16 v[56:59], v[96:99], v[124:127], v[56:59]
    ds_read_b64_tr_b16 v[90:91], v7 offset:18432
    v_mfma_f32_16x16x32_bf16 v[52:55], v[100:103], v[120:123], v[52:55]
    ds_read_b64_tr_b16 v[92:93], v8 offset:16384
    v_mfma_f32_16x16x32_bf16 v[60:63], v[100:103], v[124:127], v[60:63]
    ds_read_b64_tr_b16 v[94:95], v8 offset:18432
    s_waitcnt lgkmcnt(8)
    v_mfma_f32_16x16x32_bf16 v[64:67], v[104:107], v[120:123], v[64:67]
    ds_read_b64_tr_b16 v[96:97], v5 offset:24576
    v_mfma_f32_16x16x32_bf16 v[72:75], v[104:107], v[124:127], v[72:75]
    ds_read_b64_tr_b16 v[98:99], v5 offset:26624
    v_mfma_f32_16x16x32_bf16 v[68:71], v[108:111], v[120:123], v[68:71]
    ds_read_b64_tr_b16 v[100:101], v6 offset:24576
    buffer_load_dwordx4 v[120:123], v9, s[12:15], s42 offen offset:2048 sc1
    v_mfma_f32_16x16x32_bf16 v[76:79], v[108:111], v[124:127], v[76:79]
    ds_read_b64_tr_b16 v[102:103], v6 offset:26624
    buffer_load_dwordx4 v[124:127], v9, s[12:15], s42 offen offset:3072 sc1
    s_waitcnt vmcnt(7) lgkmcnt(8)
    v_mfma_f32_16x16x32_bf16 v[16:19], v[80:83], v[128:131], v[16:19]
    s_add_u32 s85, s96, s93
    ds_read_b64_tr_b16 v[104:105], v7 offset:24576
    s_waitcnt vmcnt(6)
    v_mfma_f32_16x16x32_bf16 v[24:27], v[80:83], v[132:135], v[24:27]
    s_add_u32 s97, s85, 28
    ds_read_b64_tr_b16 v[106:107], v7 offset:26624
    v_mfma_f32_16x16x32_bf16 v[20:23], v[84:87], v[128:131], v[20:23]
    s_min_u32 s85, s85, s97
    ds_read_b64_tr_b16 v[108:109], v8 offset:24576
    v_mfma_f32_16x16x32_bf16 v[28:31], v[84:87], v[132:135], v[28:31]
    s_sub_u32 s97, s85, 28
    ds_read_b64_tr_b16 v[110:111], v8 offset:26624
    s_waitcnt lgkmcnt(8)
    v_mfma_f32_16x16x32_bf16 v[32:35], v[88:91], v[128:131], v[32:35]
    s_min_u32 s85, s85, s97
    ds_read_b64_tr_b16 v[80:81], v5 offset:20480
    v_mfma_f32_16x16x32_bf16 v[40:43], v[88:91], v[132:135], v[40:43]
    s_cmp_ge_u32 s96, 28
    s_cselect_b32 s85, 28, s85
    ds_read_b64_tr_b16 v[82:83], v5 offset:22528
    v_mfma_f32_16x16x32_bf16 v[36:39], v[92:95], v[128:131], v[36:39]
    s_add_u32 s96, s96, 1
    s_mul_i32 s42, s85, 4096
    ds_read_b64_tr_b16 v[84:85], v6 offset:20480
    v_mfma_f32_16x16x32_bf16 v[44:47], v[92:95], v[132:135], v[44:47]
    ds_read_b64_tr_b16 v[86:87], v6 offset:22528
    s_waitcnt lgkmcnt(8)
    v_mfma_f32_16x16x32_bf16 v[48:51], v[96:99], v[128:131], v[48:51]
    ds_read_b64_tr_b16 v[88:89], v7 offset:20480
    v_mfma_f32_16x16x32_bf16 v[56:59], v[96:99], v[132:135], v[56:59]
    ds_read_b64_tr_b16 v[90:91], v7 offset:22528
    v_mfma_f32_16x16x32_bf16 v[52:55], v[100:103], v[128:131], v[52:55]
    ds_read_b64_tr_b16 v[92:93], v8 offset:20480
    v_mfma_f32_16x16x32_bf16 v[60:63], v[100:103], v[132:135], v[60:63]
    ds_read_b64_tr_b16 v[94:95], v8 offset:22528
    s_waitcnt lgkmcnt(8)
    v_mfma_f32_16x16x32_bf16 v[64:67], v[104:107], v[128:131], v[64:67]
    ds_read_b64_tr_b16 v[96:97], v5 offset:28672
    v_mfma_f32_16x16x32_bf16 v[72:75], v[104:107], v[132:135], v[72:75]
    ds_read_b64_tr_b16 v[98:99], v5 offset:30720
    v_mfma_f32_16x16x32_bf16 v[68:71], v[108:111], v[128:131], v[68:71]
    ds_read_b64_tr_b16 v[100:101], v6 offset:28672
    buffer_load_dwordx4 v[128:131], v9, s[12:15], s42 offen sc1
    v_mfma_f32_16x16x32_bf16 v[76:79], v[108:111], v[132:135], v[76:79]
    ds_read_b64_tr_b16 v[102:103], v6 offset:30720
    buffer_load_dwordx4 v[132:135], v9, s[12:15], s42 offen offset:1024 sc1
    s_waitcnt vmcnt(7) lgkmcnt(8)
    v_mfma_f32_16x16x32_bf16 v[16:19], v[80:83], v[136:139], v[16:19]
    ds_read_b64_tr_b16 v[104:105], v7 offset:28672
    s_waitcnt vmcnt(6)
    v_mfma_f32_16x16x32_bf16 v[24:27], v[80:83], v[140:143], v[24:27]
    ds_read_b64_tr_b16 v[106:107], v7 offset:30720
    v_mfma_f32_16x16x32_bf16 v[20:23], v[84:87], v[136:139], v[20:23]
    ds_read_b64_tr_b16 v[108:109], v8 offset:28672
    v_mfma_f32_16x16x32_bf16 v[28:31], v[84:87], v[140:143], v[28:31]
    ds_read_b64_tr_b16 v[110:111], v8 offset:30720
    s_waitcnt lgkmcnt(8)
    v_mfma_f32_16x16x32_bf16 v[32:35], v[88:91], v[136:139], v[32:35]
    s_barrier
    ds_read_b64_tr_b16 v[80:81], v5 offset:32768
    v_mfma_f32_16x16x32_bf16 v[40:43], v[88:91], v[140:143], v[40:43]
    ds_read_b64_tr_b16 v[82:83], v5 offset:34816
    v_mfma_f32_16x16x32_bf16 v[36:39], v[92:95], v[136:139], v[36:39]
    ds_read_b64_tr_b16 v[84:85], v6 offset:32768
    v_mfma_f32_16x16x32_bf16 v[44:47], v[92:95], v[140:143], v[44:47]
    ds_read_b64_tr_b16 v[86:87], v6 offset:34816
    s_waitcnt lgkmcnt(8)
    v_mfma_f32_16x16x32_bf16 v[48:51], v[96:99], v[136:139], v[48:51]
    ds_read_b64_tr_b16 v[88:89], v7 offset:32768
    v_mfma_f32_16x16x32_bf16 v[56:59], v[96:99], v[140:143], v[56:59]
    ds_read_b64_tr_b16 v[90:91], v7 offset:34816
    v_mfma_f32_16x16x32_bf16 v[52:55], v[100:103], v[136:139], v[52:55]
    ds_read_b64_tr_b16 v[92:93], v8 offset:32768
    v_mfma_f32_16x16x32_bf16 v[60:63], v[100:103], v[140:143], v[60:63]
    ds_read_b64_tr_b16 v[94:95], v8 offset:34816
    s_waitcnt lgkmcnt(8)
    v_mfma_f32_16x16x32_bf16 v[64:67], v[104:107], v[136:139], v[64:67]
    ds_read_b64_tr_b16 v[96:97], v5 offset:40960
    v_mfma_f32_16x16x32_bf16 v[72:75], v[104:107], v[140:143], v[72:75]
    ds_read_b64_tr_b16 v[98:99], v5 offset:43008
    v_mfma_f32_16x16x32_bf16 v[68:71], v[108:111], v[136:139], v[68:71]
    ds_read_b64_tr_b16 v[100:101], v6 offset:40960
    buffer_load_dwordx4 v[136:139], v9, s[12:15], s42 offen offset:2048 sc1
    v_mfma_f32_16x16x32_bf16 v[76:79], v[108:111], v[140:143], v[76:79]
    ds_read_b64_tr_b16 v[102:103], v6 offset:43008
    buffer_load_dwordx4 v[140:143], v9, s[12:15], s42 offen offset:3072 sc1
    s_sub_u32 s43, s43, 1
    s_cmp_lg_u32 s43, 1
    s_cbranch_scc1 pd_loop
    s_waitcnt vmcnt(7) lgkmcnt(8)
    v_mfma_f32_16x16x32_bf16 v[16:19], v[80:83], v[112:115], v[16:19]
    s_add_u32 s86, s96, s94
    ds_read_b64_tr_b16 v[104:105], v7 offset:40960
    s_waitcnt vmcnt(6)
    v_mfma_f32_16x16x32_bf16 v[24:27], v[80:83], v[116:119], v[24:27]
    s_add_u32 s97, s86, 28
    ds_read_b64_tr_b16 v[106:107], v7 offset:43008
    v_mfma_f32_16x16x32_bf16 v[20:23], v[84:87], v[112:115], v[20:23]
    s_min_u32 s86, s86, s97
    ds_read_b64_tr_b16 v[108:109], v8 offset:40960
    v_mfma_f32_16x16x32_bf16 v[28:31], v[84:87], v[116:119], v[28:31]
    s_sub_u32 s97, s86, 28
    ds_read_b64_tr_b16 v[110:111], v8 offset:43008
    s_waitcnt lgkmcnt(8)
    v_mfma_f32_16x16x32_bf16 v[32:35], v[88:91], v[112:115], v[32:35]
    s_min_u32 s86, s86, s97
    ds_read_b64_tr_b16 v[80:81], v5 offset:36864
    v_mfma_f32_16x16x32_bf16 v[40:43], v[88:91], v[116:119], v[40:43]
    s_cmp_ge_u32 s96, 28
    s_cselect_b32 s86, 28, s86
    ds_read_b64_tr_b16 v[82:83], v5 offset:38912
    v_mfma_f32_16x16x32_bf16 v[36:39], v[92:95], v[112:115], v[36:39]
    s_add_u32 s96, s96, 1
    ds_read_b64_tr_b16 v[84:85], v6 offset:36864
    v_mfma_f32_16x16x32_bf16 v[44:47], v[92:95], v[116:119], v[44:47]
    s_mul_i32 s42, s86, 4096
    ds_read_b64_tr_b16 v[86:87], v6 offset:38912
    s_waitcnt lgkmcnt(8)
    v_mfma_f32_16x16x32_bf16 v[48:51], v[96:99], v[112:115], v[48:51]
    ds_read_b64_tr_b16 v[88:89], v7 offset:36864
    v_mfma_f32_16x16x32_bf16 v[56:59], v[96:99], v[116:119], v[56:59]
    ds_read_b64_tr_b16 v[90:91], v7 offset:38912
    v_mfma_f32_16x16x32_bf16 v[52:55], v[100:103], v[112:115], v[52:55]
    ds_read_b64_tr_b16 v[92:93], v8 offset:36864
    v_mfma_f32_16x16x32_bf16 v[60:63], v[100:103], v[116:119], v[60:63]
    ds_read_b64_tr_b16 v[94:95], v8 offset:38912
    s_waitcnt lgkmcnt(8)
    v_mfma_f32_16x16x32_bf16 v[64:67], v[104:107], v[112:115], v[64:67]
    ds_read_b64_tr_b16 v[96:97], v5 offset:45056
    v_mfma_f32_16x16x32_bf16 v[72:75], v[104:107], v[116:119], v[72:75]
    ds_read_b64_tr_b16 v[98:99], v5 offset:47104
    v_mfma_f32_16x16x32_bf16 v[68:71], v[108:111], v[112:115], v[68:71]
    ds_read_b64_tr_b16 v[100:101], v6 offset:45056
    buffer_load_dwordx4 v[112:115], v9, s[12:15], s42 offen sc1
    v_mfma_f32_16x16x32_bf16 v[76:79], v[108:111], v[116:119], v[76:79]
    ds_read_b64_tr_b16 v[102:103], v6 offset:47104
    buffer_load_dwordx4 v[116:119], v9, s[12:15], s42 offen offset:1024 sc1
    s_waitcnt vmcnt(7) lgkmcnt(8)
    v_mfma_f32_16x16x32_bf16 v[16:19], v[80:83], v[120:123], v[16:19]
    ds_read_b64_tr_b16 v[104:105], v7 offset:45056
    s_waitcnt vmcnt(6)
    v_mfma_f32_16x16x32_bf16 v[24:27], v[80:83], v[124:127], v[24:27]
    ds_read_b64_tr_b16 v[106:107], v7 offset:47104
    v_mfma_f32_16x16x32_bf16 v[20:23], v[84:87], v[120:123], v[20:23]
    ds_read_b64_tr_b16 v[108:109], v8 offset:45056
    v_mfma_f32_16x16x32_bf16 v[28:31], v[84:87], v[124:127], v[28:31]
    ds_read_b64_tr_b16 v[110:111], v8 offset:47104
    s_waitcnt lgkmcnt(8)
    v_mfma_f32_16x16x32_bf16 v[32:35], v[88:91], v[120:123], v[32:35]
    s_barrier
    ds_read_b64_tr_b16 v[80:81], v5 offset:49152
    v_mfma_f32_16x16x32_bf16 v[40:43], v[88:91], v[124:127], v[40:43]
    ds_read_b64_tr_b16 v[82:83], v5 offset:51200
    v_mfma_f32_16x16x32_bf16 v[36:39], v[92:95], v[120:123], v[36:39]
    ds_read_b64_tr_b16 v[84:85], v6 offset:49152
    v_mfma_f32_16x16x32_bf16 v[44:47], v[92:95], v[124:127], v[44:47]
    ds_read_b64_tr_b16 v[86:87], v6 offset:51200
    s_waitcnt lgkmcnt(8)
    v_mfma_f32_16x16x32_bf16 v[48:51], v[96:99], v[120:123], v[48:51]
    ds_read_b64_tr_b16 v[88:89], v7 offset:49152
    v_mfma_f32_16x16x32_bf16 v[56:59], v[96:99], v[124:127], v[56:59]
    ds_read_b64_tr_b16 v[90:91], v7 offset:51200
    v_mfma_f32_16x16x32_bf16 v[52:55], v[100:103], v[120:123], v[52:55]
    ds_read_b64_tr_b16 v[92:93], v8 offset:49152
    v_mfma_f32_16x16x32_bf16 v[60:63], v[100:103], v[124:127], v[60:63]
    ds_read_b64_tr_b16 v[94:95], v8 offset:51200
    s_waitcnt lgkmcnt(8)
    v_mfma_f32_16x16x32_bf16 v[64:67], v[104:107], v[120:123], v[64:67]
    ds_read_b64_tr_b16 v[96:97], v5 offset:57344
    v_mfma_f32_16x16x32_bf16 v[72:75], v[104:107], v[124:127], v[72:75]
    ds_read_b64_tr_b16 v[98:99], v5 offset:59392
    v_mfma_f32_16x16x32_bf16 v[68:71], v[108:111], v[120:123], v[68:71]
    ds_read_b64_tr_b16 v[100:101], v6 offset:57344
    buffer_load_dwordx4 v[120:123], v9, s[12:15], s42 offen offset:2048 sc1
    v_mfma_f32_16x16x32_bf16 v[76:79], v[108:111], v[124:127], v[76:79]
    ds_read_b64_tr_b16 v[102:103], v6 offset:59392
    buffer_load_dwordx4 v[124:127], v9, s[12:15], s42 offen offset:3072 sc1
    s_waitcnt vmcnt(7) lgkmcnt(8)
    v_mfma_f32_16x16x32_bf16 v[16:19], v[80:83], v[128:131], v[16:19]
    s_add_u32 s87, s96, s95
    ds_read_b64_tr_b16 v[104:105], v7 offset:57344
    s_waitcnt vmcnt(6)
    v_mfma_f32_16x16x32_bf16 v[24:27], v[80:83], v[132:135], v[24:27]
    s_add_u32 s97, s87, 28
    ds_read_b64_tr_b16 v[106:107], v7 offset:59392
    v_mfma_f32_16x16x32_bf16 v[20:23], v[84:87], v[128:131], v[20:23]
    s_min_u32 s87, s87, s97
    ds_read_b64_tr_b16 v[108:109], v8 offset:57344
    v_mfma_f32_16x16x32_bf16 v[28:31], v[84:87], v[132:135], v[28:31]
    s_sub_u32 s97, s87, 28
    ds_read_b64_tr_b16 v[110:111], v8 offset:59392
    s_waitcnt lgkmcnt(8)
    v_mfma_f32_16x16x32_bf16 v[32:35], v[88:91], v[128:131], v[32:35]
    s_min_u32 s87, s87, s97
    ds_read_b64_tr_b16 v[80:81], v5 offset:53248
    v_mfma_f32_16x16x32_bf16 v[40:43], v[88:91], v[132:135], v[40:43]
    s_cmp_ge_u32 s96, 28
    s_cselect_b32 s87, 28, s87
    ds_read_b64_tr_b16 v[82:83], v5 offset:55296
    v_mfma_f32_16x16x32_bf16 v[36:39], v[92:95], v[128:131], v[36:39]
    s_add_u32 s96, s96, 1
    ds_read_b64_tr_b16 v[84:85], v6 offset:53248
    v_mfma_f32_16x16x32_bf16 v[44:47], v[92:95], v[132:135], v[44:47]
    s_mul_i32 s42, s87, 4096
    ds_read_b64_tr_b16 v[86:87], v6 offset:55296
    s_waitcnt lgkmcnt(8)
    v_mfma_f32_16x16x32_bf16 v[48:51], v[96:99], v[128:131], v[48:51]
    ds_read_b64_tr_b16 v[88:89], v7 offset:53248
    v_mfma_f32_16x16x32_bf16 v[56:59], v[96:99], v[132:135], v[56:59]
    ds_read_b64_tr_b16 v[90:91], v7 offset:55296
    v_mfma_f32_16x16x32_bf16 v[52:55], v[100:103], v[128:131], v[52:55]
    ds_read_b64_tr_b16 v[92:93], v8 offset:53248
    v_mfma_f32_16x16x32_bf16 v[60:63], v[100:103], v[132:135], v[60:63]
    ds_read_b64_tr_b16 v[94:95], v8 offset:55296
    s_waitcnt lgkmcnt(8)
    v_mfma_f32_16x16x32_bf16 v[64:67], v[104:107], v[128:131], v[64:67]
    ds_read_b64_tr_b16 v[96:97], v5 offset:61440
    v_mfma_f32_16x16x32_bf16 v[72:75], v[104:107], v[132:135], v[72:75]
    ds_read_b64_tr_b16 v[98:99], v5 offset:63488
    v_mfma_f32_16x16x32_bf16 v[68:71], v[108:111], v[128:131], v[68:71]
    ds_read_b64_tr_b16 v[100:101], v6 offset:61440
    buffer_load_dwordx4 v[128:131], v9, s[12:15], s42 offen sc1
    v_mfma_f32_16x16x32_bf16 v[76:79], v[108:111], v[132:135], v[76:79]
    ds_read_b64_tr_b16 v[102:103], v6 offset:63488
    buffer_load_dwordx4 v[132:135], v9, s[12:15], s42 offen offset:1024 sc1
    s_waitcnt vmcnt(7) lgkmcnt(8)
    v_mfma_f32_16x16x32_bf16 v[16:19], v[80:83], v[136:139], v[16:19]
    ds_read_b64_tr_b16 v[104:105], v7 offset:61440
    s_waitcnt vmcnt(6)
    v_mfma_f32_16x16x32_bf16 v[24:27], v[80:83], v[140:143], v[24:27]
    ds_read_b64_tr_b16 v[106:107], v7 offset:63488
    v_mfma_f32_16x16x32_bf16 v[20:23], v[84:87], v[136:139], v[20:23]
    ds_read_b64_tr_b16 v[108:109], v8 offset:61440
    v_mfma_f32_16x16x32_bf16 v[28:31], v[84:87], v[140:143], v[28:31]
    ds_read_b64_tr_b16 v[110:111], v8 offset:63488
    s_waitcnt lgkmcnt(8)
    v_mfma_f32_16x16x32_bf16 v[32:35], v[88:91], v[136:139], v[32:35]
    s_barrier
    ds_read_b64_tr_b16 v[80:81], v5 offset:8192
    v_mfma_f32_16x16x32_bf16 v[40:43], v[88:91], v[140:143], v[40:43]
    ds_read_b64_tr_b16 v[82:83], v5 offset:10240
    v_mfma_f32_16x16x32_bf16 v[36:39], v[92:95], v[136:139], v[36:39]
    ds_read_b64_tr_b16 v[84:85], v6 offset:8192
    v_mfma_f32_16x16x32_bf16 v[44:47], v[92:95], v[140:143], v[44:47]
    ds_read_b64_tr_b16 v[86:87], v6 offset:10240
    s_waitcnt lgkmcnt(8)
    v_mfma_f32_16x16x32_bf16 v[48:51], v[96:99], v[136:139], v[48:51]
    ds_read_b64_tr_b16 v[88:89], v7 offset:8192
    v_mfma_f32_16x16x32_bf16 v[56:59], v[96:99], v[140:143], v[56:59]
    ds_read_b64_tr_b16 v[90:91], v7 offset:10240
    v_mfma_f32_16x16x32_bf16 v[52:55], v[100:103], v[136:139], v[52:55]
    ds_read_b64_tr_b16 v[92:93], v8 offset:8192
    v_mfma_f32_16x16x32_bf16 v[60:63], v[100:103], v[140:143], v[60:63]
    ds_read_b64_tr_b16 v[94:95], v8 offset:10240
    s_waitcnt lgkmcnt(8)
    v_mfma_f32_16x16x32_bf16 v[64:67], v[104:107], v[136:139], v[64:67]
    ds_read_b64_tr_b16 v[96:97], v5 offset:12288
    v_mfma_f32_16x16x32_bf16 v[72:75], v[104:107], v[140:143], v[72:75]
    ds_read_b64_tr_b16 v[98:99], v5 offset:14336
    v_mfma_f32_16x16x32_bf16 v[68:71], v[108:111], v[136:139], v[68:71]
    ds_read_b64_tr_b16 v[100:101], v6 offset:12288
    buffer_load_dwordx4 v[136:139], v9, s[12:15], s42 offen offset:2048 sc1
    v_mfma_f32_16x16x32_bf16 v[76:79], v[108:111], v[140:143], v[76:79]
    ds_read_b64_tr_b16 v[102:103], v6 offset:14336
    buffer_load_dwordx4 v[140:143], v9, s[12:15], s42 offen offset:3072 sc1
    s_waitcnt vmcnt(7) lgkmcnt(8)
    v_mfma_f32_16x16x32_bf16 v[48:51], v[80:83], v[112:115], v[48:51]
    ds_read_b64_tr_b16 v[104:105], v7 offset:12288
    s_waitcnt vmcnt(6)
    v_mfma_f32_16x16x32_bf16 v[56:59], v[80:83], v[116:119], v[56:59]
    ds_read_b64_tr_b16 v[106:107], v7 offset:14336
    v_mfma_f32_16x16x32_bf16 v[52:55], v[84:87], v[112:115], v[52:55]
    ds_read_b64_tr_b16 v[108:109], v8 offset:12288
    v_mfma_f32_16x16x32_bf16 v[60:63], v[84:87], v[116:119], v[60:63]
    ds_read_b64_tr_b16 v[110:111], v8 offset:14336
    s_waitcnt lgkmcnt(8)
    v_mfma_f32_16x16x32_bf16 v[64:67], v[88:91], v[112:115], v[64:67]
    s_barrier
    ds_read_b64_tr_b16 v[80:81], v5 offset:24576
    v_mfma_f32_16x16x32_bf16 v[72:75], v[88:91], v[116:119], v[72:75]
    ds_read_b64_tr_b16 v[82:83], v5 offset:26624
    v_mfma_f32_16x16x32_bf16 v[68:71], v[92:95], v[112:115], v[68:71]
    ds_read_b64_tr_b16 v[84:85], v6 offset:24576
    v_mfma_f32_16x16x32_bf16 v[76:79], v[92:95], v[116:119], v[76:79]
    ds_read_b64_tr_b16 v[86:87], v6 offset:26624
    s_waitcnt vmcnt(5) lgkmcnt(8)
    v_mfma_f32_16x16x32_bf16 v[48:51], v[96:99], v[120:123], v[48:51]
    ds_read_b64_tr_b16 v[88:89], v7 offset:24576
    s_waitcnt vmcnt(4)
    v_mfma_f32_16x16x32_bf16 v[56:59], v[96:99], v[124:127], v[56:59]
    ds_read_b64_tr_b16 v[90:91], v7 offset:26624
    v_mfma_f32_16x16x32_bf16 v[52:55], v[100:103], v[120:123], v[52:55]
    ds_read_b64_tr_b16 v[92:93], v8 offset:24576
    v_mfma_f32_16x16x32_bf16 v[60:63], v[100:103], v[124:127], v[60:63]
    ds_read_b64_tr_b16 v[94:95], v8 offset:26624
    s_waitcnt lgkmcnt(8)
    v_mfma_f32_16x16x32_bf16 v[64:67], v[104:107], v[120:123], v[64:67]
    ds_read_b64_tr_b16 v[96:97], v5 offset:28672
    v_mfma_f32_16x16x32_bf16 v[72:75], v[104:107], v[124:127], v[72:75]
    ds_read_b64_tr_b16 v[98:99], v5 offset:30720
    v_mfma_f32_16x16x32_bf16 v[68:71], v[108:111], v[120:123], v[68:71]
    ds_read_b64_tr_b16 v[100:101], v6 offset:28672
    v_mfma_f32_16x16x32_bf16 v[76:79], v[108:111], v[124:127], v[76:79]
    ds_read_b64_tr_b16 v[102:103], v6 offset:30720
    s_waitcnt vmcnt(3) lgkmcnt(8)
    v_mfma_f32_16x16x32_bf16 v[48:51], v[80:83], v[128:131], v[48:51]
    ds_read_b64_tr_b16 v[104:105], v7 offset:28672
    s_waitcnt vmcnt(2)
    v_mfma_f32_16x16x32_bf16 v[56:59], v[80:83], v[132:135], v[56:59]
    ds_read_b64_tr_b16 v[106:107], v7 offset:30720
    v_mfma_f32_16x16x32_bf16 v[52:55], v[84:87], v[128:131], v[52:55]
    ds_read_b64_tr_b16 v[108:109], v8 offset:28672
    v_mfma_f32_16x16x32_bf16 v[60:63], v[84:87], v[132:135], v[60:63]
    ds_read_b64_tr_b16 v[110:111], v8 offset:30720
    s_waitcnt lgkmcnt(8)
    v_mfma_f32_16x16x32_bf16 v[64:67], v[88:91], v[128:131], v[64:67]
    s_barrier
    v_mfma_f32_16x16x32_bf16 v[72:75], v[88:91], v[132:135], v[72:75]
    v_mfma_f32_16x16x32_bf16 v[68:71], v[92:95], v[128:131], v[68:71]
    v_mfma_f32_16x16x32_bf16 v[76:79], v[92:95], v[132:135], v[76:79]
    s_waitcnt vmcnt(1) lgkmcnt(4)
    v_mfma_f32_16x16x32_bf16 v[48:51], v[96:99], v[136:139], v[48:51]
    s_waitcnt vmcnt(0)
    v_mfma_f32_16x16x32_bf16 v[56:59], v[96:99], v[140:143], v[56:59]
    v_mfma_f32_16x16x32_bf16 v[52:55], v[100:103], v[136:139], v[52:55]
    v_mfma_f32_16x16x32_bf16 v[60:63], v[100:103], v[140:143], v[60:63]
    s_waitcnt lgkmcnt(0)
    v_mfma_f32_16x16x32_bf16 v[64:67], v[104:107], v[136:139], v[64:67]
    v_mfma_f32_16x16x32_bf16 v[72:75], v[104:107], v[140:143], v[72:75]
    v_mfma_f32_16x16x32_bf16 v[68:71], v[108:111], v[136:139], v[68:71]
    v_mfma_f32_16x16x32_bf16 v[76:79], v[108:111], v[140:143], v[76:79]
    ds_read_b64_tr_b16 v[144:145], v5 offset:0
    ds_read_b64_tr_b16 v[146:147], v5 offset:2048
    ds_read_b64_tr_b16 v[148:149], v6 offset:0
    ds_read_b64_tr_b16 v[150:151], v6 offset:2048
    ds_read_b64_tr_b16 v[152:153], v7 offset:0
    ds_read_b64_tr_b16 v[154:155], v7 offset:2048
    ds_read_b64_tr_b16 v[156:157], v8 offset:0
    ds_read_b64_tr_b16 v[158:159], v8 offset:2048
    ds_read_b64_tr_b16 v[160:161], v5 offset:4096
    ds_read_b64_tr_b16 v[162:163], v5 offset:6144
    ds_read_b64_tr_b16 v[164:165], v6 offset:4096
    ds_read_b64_tr_b16 v[166:167], v6 offset:6144
    ds_read_b64_tr_b16 v[168:169], v7 offset:4096
    ds_read_b64_tr_b16 v[170:171], v7 offset:6144
    ds_read_b64_tr_b16 v[172:173], v8 offset:4096
    ds_read_b64_tr_b16 v[174:175], v8 offset:6144
    ds_read_b64_tr_b16 v[176:177], v5 offset:16384
    ds_read_b64_tr_b16 v[178:179], v5 offset:18432
    ds_read_b64_tr_b16 v[180:181], v6 offset:16384
    ds_read_b64_tr_b16 v[182:183], v6 offset:18432
    ds_read_b64_tr_b16 v[184:185], v7 offset:16384
    ds_read_b64_tr_b16 v[186:187], v7 offset:18432
    ds_read_b64_tr_b16 v[188:189], v8 offset:16384
    ds_read_b64_tr_b16 v[190:191], v8 offset:18432
    ds_read_b64_tr_b16 v[192:193], v5 offset:20480
    ds_read_b64_tr_b16 v[194:195], v5 offset:22528
    ds_read_b64_tr_b16 v[196:197], v6 offset:20480
    ds_read_b64_tr_b16 v[198:199], v6 offset:22528
    ds_read_b64_tr_b16 v[200:201], v7 offset:20480
    ds_read_b64_tr_b16 v[202:203], v7 offset:22528
    ds_read_b64_tr_b16 v[204:205], v8 offset:20480
    ds_read_b64_tr_b16 v[206:207], v8 offset:22528
    s_lshl_b32 s36, s2, 2
    s_add_u32 s36, s36, s3
    s_lshl_b32 s36, s36, 12
    s_xor_b32 s37, s36, 0x4000
    s_add_u32 s16, s28, 4194304
    s_addc_u32 s17, s29, 0
    s_mov_b32 s18, 4194304
    s_mov_b32 s19, 0x00020000
    s_mov_b32 s50, 0x40000
    v_cvt_pk_bf16_f32 v228, v48, v49
    v_cvt_pk_bf16_f32 v229, v50, v51
    v_cvt_pk_bf16_f32 v230, v52, v53
    v_cvt_pk_bf16_f32 v231, v54, v55
    buffer_store_dwordx4 v[228:231], v9, s[16:19], s37 offen offset:0 sc1
    v_cvt_pk_bf16_f32 v232, v56, v57
    v_cvt_pk_bf16_f32 v233, v58, v59
    v_cvt_pk_bf16_f32 v234, v60, v61
    v_cvt_pk_bf16_f32 v235, v62, v63
    buffer_store_dwordx4 v[232:235], v9, s[16:19], s37 offen offset:1024 sc1
    v_cvt_pk_bf16_f32 v236, v64, v65
    v_cvt_pk_bf16_f32 v237, v66, v67
    v_cvt_pk_bf16_f32 v238, v68, v69
    v_cvt_pk_bf16_f32 v239, v70, v71
    buffer_store_dwordx4 v[236:239], v9, s[16:19], s37 offen offset:2048 sc1
    v_cvt_pk_bf16_f32 v240, v72, v73
    v_cvt_pk_bf16_f32 v241, v74, v75
    v_cvt_pk_bf16_f32 v242, v76, v77
    v_cvt_pk_bf16_f32 v243, v78, v79
    buffer_store_dwordx4 v[240:243], v9, s[16:19], s37 offen offset:3072 sc1
    s_waitcnt lgkmcnt(15)
    v_mfma_f32_16x16x32_bf16 v[16:19], v[144:147], v[112:115], v[16:19]
    v_mfma_f32_16x16x32_bf16 v[24:27], v[144:147], v[116:119], v[24:27]
    v_mfma_f32_16x16x32_bf16 v[20:23], v[148:151], v[112:115], v[20:23]
    v_mfma_f32_16x16x32_bf16 v[28:31], v[148:151], v[116:119], v[28:31]
    v_mfma_f32_16x16x32_bf16 v[32:35], v[152:155], v[112:115], v[32:35]
    v_mfma_f32_16x16x32_bf16 v[40:43], v[152:155], v[116:119], v[40:43]
    v_mfma_f32_16x16x32_bf16 v[36:39], v[156:159], v[112:115], v[36:39]
    v_mfma_f32_16x16x32_bf16 v[44:47], v[156:159], v[116:119], v[44:47]
    s_waitcnt lgkmcnt(15)
    v_mfma_f32_16x16x32_bf16 v[16:19], v[160:163], v[120:123], v[16:19]
    v_mfma_f32_16x16x32_bf16 v[24:27], v[160:163], v[124:127], v[24:27]
    v_mfma_f32_16x16x32_bf16 v[20:23], v[164:167], v[120:123], v[20:23]
    v_mfma_f32_16x16x32_bf16 v[28:31], v[164:167], v[124:127], v[28:31]
    v_mfma_f32_16x16x32_bf16 v[32:35], v[168:171], v[120:123], v[32:35]
    v_mfma_f32_16x16x32_bf16 v[40:43], v[168:171], v[124:127], v[40:43]
    v_mfma_f32_16x16x32_bf16 v[36:39], v[172:175], v[120:123], v[36:39]
    v_mfma_f32_16x16x32_bf16 v[44:47], v[172:175], v[124:127], v[44:47]
    s_waitcnt lgkmcnt(8)
    v_mfma_f32_16x16x32_bf16 v[16:19], v[176:179], v[128:131], v[16:19]
    v_mfma_f32_16x16x32_bf16 v[24:27], v[176:179], v[132:135], v[24:27]
    v_mfma_f32_16x16x32_bf16 v[20:23], v[180:183], v[128:131], v[20:23]
    v_mfma_f32_16x16x32_bf16 v[28:31], v[180:183], v[132:135], v[28:31]
    v_mfma_f32_16x16x32_bf16 v[32:35], v[184:187], v[128:131], v[32:35]
    v_mfma_f32_16x16x32_bf16 v[40:43], v[184:187], v[132:135], v[40:43]
    v_mfma_f32_16x16x32_bf16 v[36:39], v[188:191], v[128:131], v[36:39]
    v_mfma_f32_16x16x32_bf16 v[44:47], v[188:191], v[132:135], v[44:47]
    s_waitcnt lgkmcnt(0)
    v_mfma_f32_16x16x32_bf16 v[16:19], v[192:195], v[136:139], v[16:19]
    v_mfma_f32_16x16x32_bf16 v[24:27], v[192:195], v[140:143], v[24:27]
    v_mfma_f32_16x16x32_bf16 v[20:23], v[196:199], v[136:139], v[20:23]
    v_mfma_f32_16x16x32_bf16 v[28:31], v[196:199], v[140:143], v[28:31]
    v_mfma_f32_16x16x32_bf16 v[32:35], v[200:203], v[136:139], v[32:35]
    v_mfma_f32_16x16x32_bf16 v[40:43], v[200:203], v[140:143], v[40:43]
    v_mfma_f32_16x16x32_bf16 v[36:39], v[204:207], v[136:139], v[36:39]
    v_mfma_f32_16x16x32_bf16 v[44:47], v[204:207], v[140:143], v[44:47]
    s_waitcnt vmcnt(0)
    s_branch pd_xp
pd_xr:
    s_mov_b64 exec, 1
pd_xl:
    v_mov_b32 v48, 0
    buffer_atomic_add v48, v9, s[16:19], s36 offen offset:4092 sc0 sc1
    s_sub_u32 s50, s50, 1
    s_cbranch_scc1 pd_xm
    s_waitcnt vmcnt(0)
    v_readfirstlane_b32 s51, v48
    s_cmp_eq_u32 s51, -1
    s_cbranch_scc1 pd_xl
pd_xm:
    s_mov_b64 exec, -1
    s_max_i32 s50, s50, 0
pd_xp:
    buffer_load_dwordx4 v[48:51], v9, s[16:19], s36 offen offset:0 sc1
    buffer_load_dwordx4 v[52:55], v9, s[16:19], s36 offen offset:1024 sc1
    buffer_load_dwordx4 v[56:59], v9, s[16:19], s36 offen offset:2048 sc1
    buffer_load_dwordx4 v[60:63], v9, s[16:19], s36 offen offset:3072 sc1
    s_sub_u32 s50, s50, 1
    s_cbranch_scc1 pd_xd
    s_waitcnt vmcnt(0)
    v_max3_u32 v10, v48, v49, v50
    v_max3_u32 v11, v51, v52, v53
    v_max3_u32 v10, v10, v54, v55
    v_max3_u32 v11, v11, v56, v57
    v_max3_u32 v10, v10, v58, v59
    v_max3_u32 v11, v11, v60, v61
    v_max3_u32 v10, v10, v62, v63
    v_max_u32 v10, v10, v11
    v_cmp_eq_u32 vcc, -1, v10
    s_nop 4
    s_cbranch_vccnz pd_xr
pd_xd:
    s_waitcnt vmcnt(0)
    v_lshlrev_b32 v64, 16, v48
    v_and_b32 v65, 0xffff0000, v48
    v_pk_add_f32 v[16:17], v[16:17], v[64:65]
    v_lshlrev_b32 v66, 16, v49
    v_and_b32 v67, 0xffff0000, v49
    v_pk_add_f32 v[18:19], v[18:19], v[66:67]
    v_lshlrev_b32 v68, 16, v50
    v_and_b32 v69, 0xffff0000, v50
    v_pk_add_f32 v[20:21], v[20:21], v[68:69]
    v_lshlrev_b32 v70, 16, v51
    v_and_b32 v71, 0xffff0000, v51
    v_pk_add_f32 v[22:23], v[22:23], v[70:71]
    v_lshlrev_b32 v72, 16, v52
    v_and_b32 v73, 0xffff0000, v52
    v_pk_add_f32 v[24:25], v[24:25], v[72:73]
    v_lshlrev_b32 v74, 16, v53
    v_and_b32 v75, 0xffff0000, v53
    v_pk_add_f32 v[26:27], v[26:27], v[74:75]
    v_lshlrev_b32 v76, 16, v54
    v_and_b32 v77, 0xffff0000, v54
    v_pk_add_f32 v[28:29], v[28:29], v[76:77]
    v_lshlrev_b32 v78, 16, v55
    v_and_b32 v79, 0xffff0000, v55
    v_pk_add_f32 v[30:31], v[30:31], v[78:79]
    v_lshlrev_b32 v64, 16, v56
    v_and_b32 v65, 0xffff0000, v56
    v_pk_add_f32 v[32:33], v[32:33], v[64:65]
    v_lshlrev_b32 v66, 16, v57
    v_and_b32 v67, 0xffff0000, v57
    v_pk_add_f32 v[34:35], v[34:35], v[66:67]
    v_lshlrev_b32 v68, 16, v58
    v_and_b32 v69, 0xffff0000, v58
    v_pk_add_f32 v[36:37], v[36:37], v[68:69]
    v_lshlrev_b32 v70, 16, v59
    v_and_b32 v71, 0xffff0000, v59
    v_pk_add_f32 v[38:39], v[38:39], v[70:71]
    v_lshlrev_b32 v72, 16, v60
    v_and_b32 v73, 0xffff0000, v60
    v_pk_add_f32 v[40:41], v[40:41], v[72:73]
    v_lshlrev_b32 v74, 16, v61
    v_and_b32 v75, 0xffff0000, v61
    v_pk_add_f32 v[42:43], v[42:43], v[74:75]
    v_lshlrev_b32 v76, 16, v62
    v_and_b32 v77, 0xffff0000, v62
    v_pk_add_f32 v[44:45], v[44:45], v[76:77]
    v_lshlrev_b32 v78, 16, v63
    v_and_b32 v79, 0xffff0000, v63
    v_pk_add_f32 v[46:47], v[46:47], v[78:79]
    s_cmp_lg_u32 s98, 0
    s_cbranch_scc1 pd_final
    s_lshl_b32 s36, s35, 12
    s_lshl_b32 s37, s34, 8
    s_add_u32 s36, s36, s37
    s_add_u32 s24, s28, 32505856
    s_addc_u32 s25, s29, 0
    s_mov_b32 s26, 262144
    s_mov_b32 s27, 0x00020000
    v_cvt_pk_bf16_f32 v228, v16, v17
    v_cvt_pk_bf16_f32 v229, v18, v19
    v_cvt_pk_bf16_f32 v230, v20, v21
    v_cvt_pk_bf16_f32 v231, v22, v23
    buffer_store_dwordx4 v[228:231], v9, s[20:23], 0 offen offset:0 sc1
    v_cvt_pk_bf16_f32 v232, v24, v25
    v_cvt_pk_bf16_f32 v233, v26, v27
    v_cvt_pk_bf16_f32 v234, v28, v29
    v_cvt_pk_bf16_f32 v235, v30, v31
    buffer_store_dwordx4 v[232:235], v9, s[20:23], 0 offen offset:1024 sc1
    v_cvt_pk_bf16_f32 v236, v32, v33
    v_cvt_pk_bf16_f32 v237, v34, v35
    v_cvt_pk_bf16_f32 v238, v36, v37
    v_cvt_pk_bf16_f32 v239, v38, v39
    buffer_store_dwordx4 v[236:239], v9, s[20:23], 0 offen offset:2048 sc1
    v_cvt_pk_bf16_f32 v240, v40, v41
    v_cvt_pk_bf16_f32 v241, v42, v43
    v_cvt_pk_bf16_f32 v242, v44, v45
    v_cvt_pk_bf16_f32 v243, v46, v47
    buffer_store_dwordx4 v[240:243], v9, s[20:23], 0 offen offset:3072 sc1
    v_mov_b32 v14, 0x3f803f80
    v_mov_b32 v10, 0
    v_mov_b32 v11, 0
    v_mov_b32 v12, 0
    v_mov_b32 v13, 0
    v_dot2_f32_bf16 v10, v228, v14, v10
    v_dot2_f32_bf16 v11, v228, v228, v11
    v_dot2_f32_bf16 v10, v229, v14, v10
    v_dot2_f32_bf16 v11, v229, v229, v11
    v_dot2_f32_bf16 v10, v230, v14, v10
    v_dot2_f32_bf16 v11, v230, v230, v11
    v_dot2_f32_bf16 v10, v231, v14, v10
    v_dot2_f32_bf16 v11, v231, v231, v11
    v_dot2_f32_bf16 v12, v232, v14, v12
    v_dot2_f32_bf16 v13, v232, v232, v13
    v_dot2_f32_bf16 v12, v233, v14, v12
    v_dot2_f32_bf16 v13, v233, v233, v13
    v_dot2_f32_bf16 v12, v234, v14, v12
    v_dot2_f32_bf16 v13, v234, v234, v13
    v_dot2_f32_bf16 v12, v235, v14, v12
    v_dot2_f32_bf16 v13, v235, v235, v13
    v_dot2_f32_bf16 v10, v236, v14, v10
    v_dot2_f32_bf16 v11, v236, v236, v11
    v_dot2_f32_bf16 v10, v237, v14, v10
    v_dot2_f32_bf16 v11, v237, v237, v11
    v_dot2_f32_bf16 v10, v238, v14, v10
    v_dot2_f32_bf16 v11, v238, v238, v11
    v_dot2_f32_bf16 v10, v239, v14, v10
    v_dot2_f32_bf16 v11, v239, v239, v11
    v_dot2_f32_bf16 v12, v240, v14, v12
    v_dot2_f32_bf16 v13, v240, v240, v13
    v_dot2_f32_bf16 v12, v241, v14, v12
    v_dot2_f32_bf16 v13, v241, v241, v13
    v_dot2_f32_bf16 v12, v242, v14, v12
    v_dot2_f32_bf16 v13, v242, v242, v13
    v_dot2_f32_bf16 v12, v243, v14, v12
    v_dot2_f32_bf16 v13, v243, v243, v13
    s_nop 3
    v_permlane32_swap_b32 v10, v11
    v_permlane32_swap_b32 v12, v13
    s_nop 1
    v_add_f32 v10, v10, v11
    v_add_f32 v12, v12, v13
    s_nop 1
    v_permlane16_swap_b32 v10, v12
    s_nop 1
    v_add_f32 v10, v10, v12
    v_lshrrev_b32 v9, 2, v9
    buffer_store_dword v10, v9, s[24:27], s36 offen sc1
pd_out:
    s_and_b32 s31, s33, 7
    s_and_b32 s32, s33, 8
    s_lshl_b32 s32, s32, 3
    s_add_u32 s31, s31, s32
    s_lshl_b32 s99, s98, 6
    s_add_u32 s99, s99, s31
    s_add_u32 s99, s99, 56
    s_mul_i32 s99, s99, 256
    s_cmp_lg_u32 s98, 0
    s_cbranch_scc1 interleave_layers__linear_attn_block__swiglu_ffn__prompt_kernel_end
    s_mov_b32 s98, 1
    s_branch pq
pd_final:
    s_mov_b32 s24, s6
    s_mov_b32 s25, s7
    s_mov_b32 s26, 4194304
    s_mov_b32 s27, 0x00020000
    v_and_b32 v10, 15, v0
    v_lshlrev_b32 v10, 11, v10
    v_bfe_u32 v11, v0, 5, 1
    v_lshl_add_u32 v10, v11, 4, v10
    v_bfe_u32 v11, v0, 4, 1
    v_lshl_add_u32 v10, v11, 5, v10
    s_lshl_b32 s36, s35, 16
    s_lshl_b32 s37, s34, 7
    s_add_u32 s36, s36, s37
    s_add_u32 s37, s36, 32768
    v_cvt_pk_bf16_f32 v228, v16, v17
    v_cvt_pk_bf16_f32 v229, v18, v19
    v_cvt_pk_bf16_f32 v230, v20, v21
    v_cvt_pk_bf16_f32 v231, v22, v23
    v_cvt_pk_bf16_f32 v232, v24, v25
    v_cvt_pk_bf16_f32 v233, v26, v27
    v_cvt_pk_bf16_f32 v234, v28, v29
    v_cvt_pk_bf16_f32 v235, v30, v31
    v_cvt_pk_bf16_f32 v236, v32, v33
    v_cvt_pk_bf16_f32 v237, v34, v35
    v_cvt_pk_bf16_f32 v238, v36, v37
    v_cvt_pk_bf16_f32 v239, v38, v39
    v_cvt_pk_bf16_f32 v240, v40, v41
    v_cvt_pk_bf16_f32 v241, v42, v43
    v_cvt_pk_bf16_f32 v242, v44, v45
    v_cvt_pk_bf16_f32 v243, v46, v47
    s_nop 0
    v_permlane16_swap_b32 v228, v230
    v_permlane16_swap_b32 v229, v231
    v_permlane16_swap_b32 v232, v234
    v_permlane16_swap_b32 v233, v235
    v_permlane16_swap_b32 v236, v238
    v_permlane16_swap_b32 v237, v239
    v_permlane16_swap_b32 v240, v242
    v_permlane16_swap_b32 v241, v243
    s_nop 1
    buffer_store_dwordx4 v[228:231], v10, s[24:27], s36 offen offset:0 nt
    buffer_store_dwordx4 v[232:235], v10, s[24:27], s37 offen offset:0 nt
    buffer_store_dwordx4 v[236:239], v10, s[24:27], s36 offen offset:64 nt
    buffer_store_dwordx4 v[240:243], v10, s[24:27], s37 offen offset:64 nt
    s_branch interleave_layers__linear_attn_block__swiglu_ffn__prompt_kernel_end
pd_idle:
    s_waitcnt vmcnt(0)
    s_barrier
    s_cmp_lg_u32 s3, 4
    s_cbranch_scc1 pd_i1
    s_mov_b64 exec, 1
    v_mov_b32 v1, 0
    v_mov_b32 v2, 1
    buffer_atomic_add v2, v1, s[80:83], s99 offen sc1
    s_mov_b64 exec, -1
pd_i1:
    s_load_dwordx2 s[4:5], s[0:1], 8
    s_and_b32 s31, s2, 7
    s_lshr_b32 s32, s2, 3
    s_and_b32 s16, s31, 1
    s_lshl_b32 s16, s16, 3
    s_lshr_b32 s17, s32, 2
    s_add_u32 s16, s16, s17
    s_lshr_b32 s17, s31, 1
    s_lshl_b32 s17, s17, 2
    s_and_b32 s32, s32, 3
    s_add_u32 s17, s17, s32
    v_and_b32 v136, 63, v0
    v_lshrrev_b32 v137, 3, v136
    v_mul_u32_u24 v130, 6144, v137
    v_and_b32 v138, 7, v136
    v_and_b32 v137, 6, v137
    v_xor_b32 v138, v138, v137
    v_lshl_add_u32 v130, v138, 4, v130
    s_and_b32 s32, s3, 3
    s_lshl_b32 s40, s32, 10
    s_mul_i32 s31, s32, 49152
    s_lshl_b32 s32, s17, 7
    s_add_u32 s31, s31, s32
    v_add_u32 v130, s31, v130
    v_add_u32 v131, 198656, v130
    v_add_u32 v132, 4096, v130
    v_add_u32 v133, 200704, v130
    v_mov_b32 v134, v130
    v_add_u32 v135, 196608, v130
    v_add_u32 v130, 2048, v130
    s_add_u32 s35, s16, s17
    s_and_b32 s35, s35, 3
    s_mov_b32 s39, 0
    s_mov_b32 s38, 0
    s_waitcnt lgkmcnt(0)
    s_mov_b32 s8, s4
    s_mov_b32 s9, s5
    s_mov_b32 s10, 6291456
    s_mov_b32 s11, 0x00020000
    s_cmp_lg_u32 s3, 4
    s_cbranch_scc1 pd_i2
    s_waitcnt vmcnt(0)
    s_mov_b64 exec, 1
    v_mov_b32 v1, 0
    s_mov_b32 s50, 0x40000
    s_branch pd_pgo
pd_poll:
pd_pgo:
    v_mov_b32 v3, 0
    buffer_atomic_add v3, v1, s[80:83], s100 offen sc0 sc1
    s_sub_u32 s50, s50, 1
    s_cbranch_scc1 pd_pdone
    s_waitcnt vmcnt(0)
    v_readfirstlane_b32 s51, v3
    s_cmp_lt_u32 s51, s101
    s_cbranch_scc1 pd_poll
pd_pdone:
    s_mov_b64 exec, -1
pd_i2:
    s_barrier
    s_and_b32 s18, s94, 3
    s_cmp_eq_u32 s18, s96
    s_cselect_b32 s18, 3, -1
    s_add_u32 s93, s94, s18
    s_add_u32 s18, s93, 28
    s_min_u32 s93, s93, s18
    s_sub_u32 s18, s93, 28
    s_min_u32 s93, s93, s18
    s_mul_i32 s93, s93, 131072
    s_add_u32 s18, s92, s95
    s_add_u32 m0, s18, 0
    s_nop 0
    buffer_load_dwordx4 v224, s[88:91], s93 offen lds
    s_add_u32 m0, s18, 4096
    s_nop 0
    buffer_load_dwordx4 v225, s[88:91], s93 offen lds
    s_add_u32 m0, s18, 8192
    s_nop 0
    buffer_load_dwordx4 v226, s[88:91], s93 offen lds
    s_add_u32 m0, s18, 12288
    s_nop 0
    buffer_load_dwordx4 v227, s[88:91], s93 offen lds
    s_add_u32 s95, s95, 16384
    s_cmp_eq_u32 s95, 65536
    s_cselect_b32 s95, 0, s95
    s_add_u32 s94, s94, 1
    s_mov_b32 s43, 26
pd_i3:
    s_waitcnt vmcnt(4)
    s_cmp_le_u32 s94, 28
    s_cbranch_scc1 st27
    s_waitcnt vmcnt(0)
st27:
    s_barrier
    s_cmp_ge_u32 s94, 28
    s_cbranch_scc1 ld28
    s_and_b32 s18, s94, 3
    s_cmp_eq_u32 s18, s96
    s_cselect_b32 s18, 3, -1
    s_add_u32 s93, s94, s18
    s_add_u32 s18, s93, 28
    s_min_u32 s93, s93, s18
    s_sub_u32 s18, s93, 28
    s_min_u32 s93, s93, s18
    s_mul_i32 s93, s93, 131072
    s_add_u32 s18, s92, s95
    s_add_u32 m0, s18, 0
    s_nop 0
    buffer_load_dwordx4 v224, s[88:91], s93 offen lds
    s_add_u32 m0, s18, 4096
    s_nop 0
    buffer_load_dwordx4 v225, s[88:91], s93 offen lds
    s_add_u32 m0, s18, 8192
    s_nop 0
    buffer_load_dwordx4 v226, s[88:91], s93 offen lds
    s_add_u32 m0, s18, 12288
    s_nop 0
    buffer_load_dwordx4 v227, s[88:91], s93 offen lds
    s_add_u32 s95, s95, 16384
    s_cmp_eq_u32 s95, 65536
    s_cselect_b32 s95, 0, s95
ld28:
    s_add_u32 s94, s94, 1
    s_sub_u32 s43, s43, 1
    s_cmp_lg_u32 s43, 0
    s_cbranch_scc1 pd_i3
pd_i3x:
    s_cmp_lg_u32 s98, 0
    s_cbranch_scc1 pd_i5
    s_and_b32 s31, s39, 3
    s_cmp_eq_u32 s31, s35
    s_cselect_b32 s31, 3, -1
    s_add_u32 s41, s39, s31
    s_add_u32 s31, s41, 16
    s_min_u32 s41, s41, s31
    s_sub_u32 s31, s41, 16
    s_min_u32 s41, s41, s31
    s_mul_i32 s41, s41, 393216
    s_add_u32 s31, s40, s38
    s_add_u32 m0, s31, 0
    s_nop 0
    buffer_load_dwordx4 v130, s[8:11], s41 offen lds
    s_add_u32 m0, s31, 4096
    s_nop 0
    buffer_load_dwordx4 v131, s[8:11], s41 offen lds
    s_add_u32 m0, s31, 8192
    s_nop 0
    buffer_load_dwordx4 v132, s[8:11], s41 offen lds
    s_add_u32 m0, s31, 12288
    s_nop 0
    buffer_load_dwordx4 v133, s[8:11], s41 offen lds
    s_add_u32 m0, s31, 16384
    s_nop 0
    buffer_load_dwordx4 v134, s[8:11], s41 offen lds
    s_add_u32 m0, s31, 20480
    s_nop 0
    buffer_load_dwordx4 v135, s[8:11], s41 offen lds
    s_add_u32 s38, s38, 24576
    s_cmp_eq_u32 s38, 98304
    s_cselect_b32 s38, 0, s38
    s_add_u32 s39, s39, 1
    s_waitcnt vmcnt(6)
    s_barrier
    s_and_b32 s31, s39, 3
    s_cmp_eq_u32 s31, s35
    s_cselect_b32 s31, 3, -1
    s_add_u32 s41, s39, s31
    s_add_u32 s31, s41, 16
    s_min_u32 s41, s41, s31
    s_sub_u32 s31, s41, 16
    s_min_u32 s41, s41, s31
    s_mul_i32 s41, s41, 393216
    s_add_u32 s31, s40, s38
    s_add_u32 m0, s31, 0
    s_nop 0
    buffer_load_dwordx4 v130, s[8:11], s41 offen lds
    s_add_u32 m0, s31, 4096
    s_nop 0
    buffer_load_dwordx4 v131, s[8:11], s41 offen lds
    s_add_u32 m0, s31, 8192
    s_nop 0
    buffer_load_dwordx4 v132, s[8:11], s41 offen lds
    s_add_u32 m0, s31, 12288
    s_nop 0
    buffer_load_dwordx4 v133, s[8:11], s41 offen lds
    s_add_u32 m0, s31, 16384
    s_nop 0
    buffer_load_dwordx4 v134, s[8:11], s41 offen lds
    s_add_u32 m0, s31, 20480
    s_nop 0
    buffer_load_dwordx4 v135, s[8:11], s41 offen lds
    s_add_u32 s38, s38, 24576
    s_cmp_eq_u32 s38, 98304
    s_cselect_b32 s38, 0, s38
    s_add_u32 s39, s39, 1
    s_and_b32 s31, s39, 3
    s_cmp_eq_u32 s31, s35
    s_cselect_b32 s31, 3, -1
    s_add_u32 s41, s39, s31
    s_add_u32 s31, s41, 16
    s_min_u32 s41, s41, s31
    s_sub_u32 s31, s41, 16
    s_min_u32 s41, s41, s31
    s_mul_i32 s41, s41, 393216
    s_add_u32 s31, s40, s38
    s_add_u32 m0, s31, 0
    s_nop 0
    buffer_load_dwordx4 v130, s[8:11], s41 offen lds
    s_add_u32 m0, s31, 4096
    s_nop 0
    buffer_load_dwordx4 v131, s[8:11], s41 offen lds
    s_add_u32 m0, s31, 8192
    s_nop 0
    buffer_load_dwordx4 v132, s[8:11], s41 offen lds
    s_add_u32 m0, s31, 12288
    s_nop 0
    buffer_load_dwordx4 v133, s[8:11], s41 offen lds
    s_add_u32 m0, s31, 16384
    s_nop 0
    buffer_load_dwordx4 v134, s[8:11], s41 offen lds
    s_add_u32 m0, s31, 20480
    s_nop 0
    buffer_load_dwordx4 v135, s[8:11], s41 offen lds
    s_add_u32 s38, s38, 24576
    s_cmp_eq_u32 s38, 98304
    s_cselect_b32 s38, 0, s38
    s_add_u32 s39, s39, 1
    s_branch pd_i6
pd_i5:
    s_waitcnt vmcnt(0)
    s_barrier
pd_i6:
    s_barrier
    s_branch pd_out
interleave_layers__linear_attn_block__swiglu_ffn__prompt_kernel_end:
    s_endpgm

.section .rodata,"a"
.p2align 6
.amdhsa_kernel interleave_layers__linear_attn_block__swiglu_ffn__prompt_kernel
  .amdhsa_next_free_vgpr 256
  .amdhsa_next_free_sgpr 102
  .amdhsa_accum_offset 256
  .amdhsa_group_segment_fixed_size 0
  .amdhsa_kernarg_size 80
  .amdhsa_user_sgpr_count 2
  .amdhsa_user_sgpr_kernarg_segment_ptr 1
  .amdhsa_system_sgpr_workgroup_id_x 1
.end_amdhsa_kernel
```
